```python
import torch

def _softmax(x, axis=-1):
    return torch.softmax(x, dim=axis)
def _gelu(x):
    return torch.nn.functional.gelu(x, approximate="tanh")
def _silu(x):
    return torch.nn.functional.silu(x)
def _sigmoid(x):
    return torch.sigmoid(x)
def _layernorm(x, axis=-1, eps=1e-5):
    m = x.mean(dim=axis, keepdim=True)
    v = x.var(dim=axis, keepdim=True, unbiased=False)
    return (x - m) / torch.sqrt(v + eps)
def _scatter_add(tgt, idx, src, axis=0):
    return tgt.clone().index_add_(axis, idx, src)
def _segment_sum(src, seg, n):
    out = torch.zeros((n,) + src.shape[1:], dtype=src.dtype)
    return out.index_add_(0, seg, src)
def _pad(x, pw):
    flat = tuple(v for pair in reversed(pw) for v in pair)
    return torch.nn.functional.pad(x, flat)

kernel_name = 'interleave_layers__grouped_kv_mqa__moe_arch_mod__prompt'

def setup_inputs():

    _w = (lambda a: (lambda t: t.to(torch.bfloat16) if t.is_floating_point() else t)(torch.as_tensor(a)))
    def _A_setup():
        B, S, D, H = 1, 2048, 576, 32
        Dh = D // H
        return {
            "x": _w((lambda *s: torch.randn(*s, dtype=torch.bfloat16) * 0.05)(B, S, D)),
            "wq": _w((lambda *s: torch.randn(*s, dtype=torch.bfloat16) * 0.05)(D, H * Dh)),
            "wk": _w((lambda *s: torch.randn(*s, dtype=torch.bfloat16) * 0.05)(D, Dh)),
            "wv": _w((lambda *s: torch.randn(*s, dtype=torch.bfloat16) * 0.05)(D, Dh)),
            "wo": _w((lambda *s: torch.randn(*s, dtype=torch.bfloat16) * 0.05)(H * Dh, D)),
        }
    _A_in = _A_setup()

    def _B_setup():
        B, S, D, F, C = 1, 2048, 576, 4608, 1
        return {
            "x": _w((lambda *s: torch.randn(*s, dtype=torch.bfloat16) * 0.05)(B, S, D)),
            "w_r": _w((lambda *s: torch.randn(*s, dtype=torch.bfloat16) * 0.05)(D)),
            "w_gate": _w((lambda *s: torch.randn(*s, dtype=torch.bfloat16) * 0.05)(D, F)),
            "w_up": _w((lambda *s: torch.randn(*s, dtype=torch.bfloat16) * 0.05)(D, F)),
            "w_down": _w((lambda *s: torch.randn(*s, dtype=torch.bfloat16) * 0.05)(F, D)),
        }
    _B_in = _B_setup()

    return {
        "A_x": _A_in["x"],
        "A_wq": _A_in["wq"],
        "A_wk": _A_in["wk"],
        "A_wv": _A_in["wv"],
        "A_wo": _A_in["wo"],
        "B_x": _B_in["x"],
        "B_w_r": _B_in["w_r"],
        "B_w_gate": _B_in["w_gate"],
        "B_w_up": _B_in["w_up"],
        "B_w_down": _B_in["w_down"],
    }

def reference(A_x, A_wq, A_wk, A_wv, A_wo, B_x, B_w_r, B_w_gate, B_w_up, B_w_down):
    def _A_ref(x, wq, wk, wv, wo):
        B, S, D = x.shape
        H = 32
        Dh = D // H
        q = (lambda x, *d: x.permute(*d))((x @ wq).reshape(B, S, H, Dh), 0, 2, 1, 3)
        k = x @ wk
        v = x @ wv
        scores = torch.einsum("bhqd,bkd->bhqk", q, k) * (Dh ** -0.5)
        p = _softmax(scores, axis=-1)
        o = torch.einsum("bhqk,bkd->bhqd", p, v)
        return (lambda x, *d: x.permute(*d))(o, 0, 2, 1, 3).reshape(B, S, H * Dh) @ wo

    def _B_ref(x, w_r, w_gate, w_up, w_down):
        B, S, D = x.shape
        C = 1
        r = x @ w_r
        idx = torch.argsort(-r, axis=-1)[:, :C]
        idx_e = (lambda x, n, axis: torch.repeat_interleave(x, n, dim=axis))(idx.reshape(B, C, 1), D, axis=2)
        x_sel = (lambda x, i, axis: torch.take_along_dim(x, i, dim=axis))(x, idx_e, axis=1)
        g = _silu(x_sel @ w_gate)
        u = x_sel @ w_up
        y = (g * u) @ w_down
        r_sel = _sigmoid((lambda x, i, axis: torch.take_along_dim(x, i, dim=axis))(r, idx, axis=1))
        y = y * r_sel.reshape(B, C, 1)
        b_off = (torch.arange(B) * S).reshape(B, 1)
        flat_idx = (idx + b_off).reshape(B * C)
        zero = (x * 0.0).reshape(B * S, D)
        upd = _scatter_add(zero, flat_idx, y.reshape(B * C, D), axis=0)
        return x + upd.reshape(B, S, D)

    x = A_x
    x = x + _A_ref(_layernorm(x, axis=-1), A_wq, A_wk, A_wv, A_wo)
    x = x + _B_ref(_layernorm(x, axis=-1), B_w_r, B_w_gate, B_w_up, B_w_down)
    x = x + _A_ref(_layernorm(x, axis=-1), A_wq, A_wk, A_wv, A_wo)
    x = x + _B_ref(_layernorm(x, axis=-1), B_w_r, B_w_gate, B_w_up, B_w_down)
    return x
```

```asm
; @launch kernel=interleave_layers__grouped_kv_mqa__moe_arch_mod__prompt_kernel grid=(256,1,1) block=(512,1,1) lds=163840
.amdgcn_target "amdgcn-amd-amdhsa--gfx950"
.text
.globl interleave_layers__grouped_kv_mqa__moe_arch_mod__prompt_kernel
.p2align 8
.type interleave_layers__grouped_kv_mqa__moe_arch_mod__prompt_kernel,@function
interleave_layers__grouped_kv_mqa__moe_arch_mod__prompt_kernel:
    s_cmp_ge_u32 s2, 256
    s_cbranch_scc1 L_quit
    s_load_dwordx4 s[8:11], s[0:1], 0
    s_load_dwordx2 s[16:17], s[0:1], 96
    v_lshrrev_b32 v2, 6, v0
    v_and_b32 v1, 63, v0
    v_readfirstlane_b32 s5, v2
    s_and_b32 s3, s2, 31
    s_lshr_b32 s4, s2, 5
    s_lshr_b32 s49, s3, 3
    s_lshl_b32 s49, s49, 1
    s_and_b32 s31, s4, 1
    s_add_u32 s49, s49, s31
    s_cmp_ge_u32 s3, 30
    s_cselect_b32 s49, 0, s49
    v_lshrrev_b32 v2, 4, v1
    v_and_b32 v3, 15, v1
    s_cmp_ge_u32 s5, 4
    s_cbranch_scc1 L_helper
    s_load_dwordx2 s[18:19], s[0:1], 48
    s_load_dwordx2 s[22:23], s[0:1], 88
    s_lshl_b32 s24, s3, 6
    s_lshl_b32 s25, s5, 4
    s_add_u32 s32, s24, s25
    s_lshr_b32 s38, s32, 4
    s_mul_i32 s24, s4, 144
    v_lshl_add_u32 v7, v2, 4, s24
    v_min_u32 v6, 1, v2
    v_lshl_add_u32 v8, v6, 3, s24
    v_add_u32 v6, s32, v3
    v_mul_u32_u24 v6, 1152, v6
    v_add_u32 v9, v6, v8
    v_add_u32 v6, v6, v7
    s_lshl_b32 s36, s3, 1
    s_add_u32 s36, s36, s4
    s_sub_u32 s36, s36, 38
    s_cmp_eq_u32 s5, 3
    s_cselect_b32 s36, s36, 32
    s_cmp_ge_u32 s4, 6
    s_cselect_b32 s36, s36, 32
    s_lshr_b32 s24, s2, 3
    s_mul_i32 s24, s24, 34
    v_min_u32 v4, 33, v1
    v_add_u32 v4, s24, v4
    v_subrev_u32 v5, 576, v4
    v_cmp_gt_u32 vcc, 576, v4
    v_add_u32 v4, 4608, v4
    v_bfe_u32 v10, v5, 6, 1
    v_mul_u32_u24 v5, 9, v5
    v_lshlrev_b32 v10, 3, v10
    v_sub_u32 v5, v5, v10
    v_add_u32 v5, 8, v5
    v_cndmask_b32 v10, v5, v4, vcc
    v_lshlrev_b32 v10, 7, v10
    s_cmp_lg_u32 s5, 0
    s_waitcnt lgkmcnt(0)
    s_cbranch_scc1 L_nlt
    global_load_dword v179, v10, s[10:11]
L_nlt:
    s_cmp_ge_u32 s36, 32
    s_cbranch_scc1 L_nb1
    s_mul_i32 s24, s36, 9872
    s_add_u32 s24, s24, 10489856
    v_lshl_add_u32 v4, v1, 4, s24
    v_add_u32 v5, 4096, v4
    v_mov_b32 v160, -1
    v_mov_b32 v161, -1
    v_mov_b32 v162, -1
    v_mov_b32 v163, -1
    global_store_dwordx4 v4, v[160:163], s[16:17] offset:-4096 sc1
    global_store_dwordx4 v4, v[160:163], s[16:17] offset:-3072 sc1
    global_store_dwordx4 v4, v[160:163], s[16:17] offset:-2048 sc1
    global_store_dwordx4 v4, v[160:163], s[16:17] offset:-1024 sc1
    global_store_dwordx4 v4, v[160:163], s[16:17] offset:0 sc1
    global_store_dwordx4 v4, v[160:163], s[16:17] offset:1024 sc1
    global_store_dwordx4 v4, v[160:163], s[16:17] offset:2048 sc1
    global_store_dwordx4 v4, v[160:163], s[16:17] offset:3072 sc1
    global_store_dwordx4 v5, v[160:163], s[16:17] sc1
    global_store_dwordx4 v5, v[160:163], s[16:17] offset:656 sc1
L_nb1:
    global_load_dwordx4 v[236:239], v6, s[8:9]
    global_load_dwordx2 v[244:245], v9, s[8:9] offset:128
    global_load_dwordx4 v[240:243], v6, s[8:9] offset:64
    global_load_dwordx4 v[246:249], v7, s[18:19]
    global_load_dwordx4 v[250:253], v7, s[18:19] offset:64
    global_load_dwordx2 v[254:255], v8, s[18:19] offset:128
    s_load_dwordx2 s[8:9], s[0:1], 80
    s_lshl_b32 s29, s5, 10
    s_add_u32 s29, s29, 87040
    v_lshrrev_b32 v4, 3, v3
    v_lshlrev_b32 v4, 1, v4
    v_lshl_add_u32 v5, v3, 6, s29
    v_xor_b32 v10, v2, v4
    v_lshl_add_u32 v10, v10, 4, v5
    v_add_u32 v11, 0x10000, v10
    v_lshrrev_b32 v15, 1, v2
    v_lshlrev_b32 v15, 4, v15
    v_and_b32 v16, 1, v2
    v_lshl_add_u32 v15, v16, 2, v15
    v_lshrrev_b32 v16, 2, v3
    v_add_u32 v15, v15, v16
    v_mul_u32_u24 v8, 160, v15
    v_and_b32 v16, 3, v3
    v_lshl_add_u32 v8, v16, 3, v8
    v_add_u32 v9, 46080, v8
    v_mov_b32 v168, 0x3f803f80
    v_mov_b32 v169, 0x3f803f80
    v_mov_b32 v170, 0x3f803f80
    v_mov_b32 v171, 0x3f803f80
    s_mov_b32 s44, 0
    s_mov_b32 s35, 4
    s_mov_b32 s39, 10485760
    s_and_b32 s6, s5, 1
    s_lshr_b32 s7, s5, 1
    v_and_b32 v172, 3, v1
    v_cmp_eq_u32 s[30:31], 0, v172
    v_lshlrev_b32 v6, 4, v1
    v_add_u32 v4, 46080, v6
    v_add_u32 v7, 107520, v6
    s_mul_i32 s24, s5, 2688
    s_add_u32 s24, s24, 136192
    v_mul_u32_u24 v18, 168, v3
    v_add_u32 v18, s24, v18
    v_lshl_add_u32 v18, v2, 3, v18
    v_bfe_u32 v19, v1, 2, 3
    v_mul_u32_u24 v19, 168, v19
    v_lshl_add_u32 v19, v172, 3, v19
    v_add_u32 v19, s24, v19
    v_and_b32 v172, 31, v1
    v_lshrrev_b32 v173, 5, v1
    s_mul_i32 s24, s6, 5376
    s_mul_i32 s25, s7, 72
    s_add_u32 s24, s24, s25
    s_add_u32 s24, s24, 136192
    v_mul_u32_u24 v22, 168, v172
    v_add_u32 v22, s24, v22
    v_lshl_add_u32 v23, v173, 4, v22
    s_mul_i32 s26, s3, 73728
    s_mul_i32 s25, s6, 36864
    s_add_u32 s24, s26, s25
    s_mul_i32 s25, s4, 2304
    s_add_u32 s24, s24, s25
    s_lshl_b32 s25, s7, 10
    s_add_u32 s24, s24, s25
    v_and_b32 v5, 1, v2
    v_mul_u32_u24 v5, 18432, v5
    v_lshl_add_u32 v5, v173, 8, v5
    v_lshl_add_u32 v5, v3, 4, v5
    v_add_u32 v5, s24, v5
    s_mul_i32 s25, s5, 18432
    s_add_u32 s24, s26, s25
    s_add_u32 s54, s16, s24
    s_addc_u32 s55, s17, 0
    s_mov_b64 s[18:19], s[16:17]
    s_mul_i32 s56, s4, 9
    s_lshr_b32 s56, s56, 2
    s_add_u32 s56, s56, 3
    s_cmp_eq_u32 s56, 18
    s_cselect_b32 s56, 0, s56
    s_lshl_b32 s56, s56, 10
    s_mov_b32 s52, -1
    s_mov_b32 s53, 0
    v_lshlrev_b32 v17, 1, v172
    v_add_u32 v174, 60, v17
    v_add_u32 v17, 48, v17
    v_cmp_lt_u32 vcc, 15, v172
    s_nop 1
    v_cndmask_b32 v17, v17, v174, vcc
    v_lshl_add_u32 v17, v173, 7, v17
    v_min_u32 v17, 98, v17
    v_add_u32 v17, 162688, v17
    v_and_b32 v174, 4, v172
    v_cmp_gt_u32 vcc, 20, v172
    s_nop 1
    v_cndmask_b32 v16, v174, v172, vcc
    v_lshrrev_b32 v174, 3, v16
    v_cmp_gt_u32 vcc, 16, v16
    v_and_b32 v16, 7, v16
    v_lshlrev_b32 v16, 4, v16
    v_lshl_add_u32 v16, v174, 8, v16
    v_xor_b32 v174, v174, v173
    v_lshlrev_b32 v174, 7, v174
    v_lshlrev_b32 v175, 6, v173
    v_cndmask_b32 v174, v175, v174, vcc
    v_add_u32 v16, v16, v174
    s_lshl_b32 s24, s3, 6
    s_lshl_b32 s25, s6, 5
    s_add_u32 s34, s24, s25
    s_lshl_b32 s24, s3, 13
    s_lshl_b32 s25, s5, 8
    s_add_u32 s24, s24, s25
    s_add_u32 s24, s24, 2359296
    s_lshl_b32 s25, s4, 10
    s_add_u32 s25, s25, s24
    v_lshl_add_u32 v20, v3, 4, s25
    v_lshlrev_b32 v21, 10, v2
    v_lshl_add_u32 v21, v3, 4, v21
    s_add_u32 s24, s24, 2048
    v_add_u32 v21, s24, v21
    s_and_b32 s26, s3, 7
    s_mul_i32 s26, s26, 19456
    s_lshr_b32 s27, s3, 3
    s_lshl_b32 s27, s27, 2
    s_add_u32 s27, s27, s5
    s_mov_b64 s[50:51], 0
    s_cmp_ge_u32 s4, 3
    s_cbranch_scc1 L_av
    s_cmp_eq_u32 s4, 2
    s_cbranch_scc1 L_ak2
    s_lshr_b32 s24, s27, 1
    s_lshl_b32 s24, s24, 10
    s_add_u32 s26, s26, s24
    s_lshl_b32 s24, s4, 9
    s_add_u32 s26, s26, s24
    s_lshl_b32 s24, s6, 8
    s_add_u32 s26, s26, s24
    v_lshl_add_u32 v0, v3, 4, s26
    s_mov_b32 s51, 0xffff
    s_branch L_adone
L_ak2:
    s_lshl_b32 s24, s27, 6
    s_add_u32 s26, s26, s24
    s_add_u32 s26, s26, 8192
    v_lshl_add_u32 v0, v3, 2, s26
    s_mov_b32 s51, 0x11110000
    s_branch L_adone
L_av:
    s_mul_i32 s24, s27, 640
    s_add_u32 s26, s26, s24
    s_lshl_b32 s24, s4, 8
    s_add_u32 s26, s26, s24
    s_cmp_ge_u32 s4, 5
    s_cbranch_scc1 L_av2
    s_add_u32 s26, s26, 8320
    s_sub_u32 s24, s4, 3
    v_xor_b32 v0, s24, v2
    v_lshl_add_u32 v0, v0, 7, s26
    v_lshl_add_u32 v0, v3, 4, v0
    s_mov_b32 s50, 0xff00ff00
    s_branch L_adone
L_av2:
    s_add_u32 s26, s26, 8448
    v_add_u32 v172, 2, v3
    v_and_b32 v172, 3, v172
    v_lshl_add_u32 v0, v2, 6, s26
    v_lshl_add_u32 v0, v172, 4, v0
    s_mov_b32 s50, 0xf000f000
L_adone:
    s_cmp_ge_u32 s36, 32
    s_cbranch_scc1 L_nb2
    v_mov_b32 v177, s36
    s_waitcnt vmcnt(6)
    s_mov_b64 exec, 1
    global_store_byte v177, v160, s[22:23] sc1
    s_mov_b64 exec, -1
L_nb2:
    s_waitcnt lgkmcnt(0)
    s_barrier
    ds_read_b128 v[24:27], v10 offset:0
    ds_read_b128 v[28:31], v10 offset:4096
    ds_read_b128 v[32:35], v10 offset:8192
    ds_read_b128 v[36:39], v10 offset:12288
    ds_read_b128 v[40:43], v10 offset:16384
    ds_read_b128 v[44:47], v10 offset:20480
    ds_read_b64_tr_b16 v[96:97], v8 offset:0
    ds_read_b64_tr_b16 v[98:99], v8 offset:1280
    ds_read_b64_tr_b16 v[100:101], v8 offset:32
    ds_read_b64_tr_b16 v[102:103], v8 offset:1312
    ds_read_b64_tr_b16 v[104:105], v8 offset:64
    ds_read_b64_tr_b16 v[106:107], v8 offset:1344
    ds_read_b64_tr_b16 v[108:109], v8 offset:96
    ds_read_b64_tr_b16 v[110:111], v8 offset:1376
    ds_read_b64_tr_b16 v[112:113], v8 offset:128
    ds_read_b64_tr_b16 v[114:115], v8 offset:1408
    s_waitcnt lgkmcnt(8)
    v_mfma_f32_16x16x32_bf16 v[196:199], v[96:99], v[24:27], 0
    ds_read_b64_tr_b16 v[116:117], v8 offset:5120
    ds_read_b64_tr_b16 v[118:119], v8 offset:6400
    v_mfma_f32_16x16x32_bf16 v[156:159], v[168:171], v[24:27], 0
    s_waitcnt lgkmcnt(8)
    v_mfma_f32_16x16x32_bf16 v[200:203], v[100:103], v[24:27], 0
    ds_read_b64_tr_b16 v[120:121], v8 offset:5152
    ds_read_b64_tr_b16 v[122:123], v8 offset:6432
    s_waitcnt lgkmcnt(8)
    v_mfma_f32_16x16x32_bf16 v[204:207], v[104:107], v[24:27], 0
    ds_read_b64_tr_b16 v[124:125], v8 offset:5184
    ds_read_b64_tr_b16 v[126:127], v8 offset:6464
    v_mfma_f32_16x16x32_bf16 v[164:167], v[24:27], v[24:27], 0
    s_waitcnt lgkmcnt(8)
    v_mfma_f32_16x16x32_bf16 v[208:211], v[108:111], v[24:27], 0
    ds_read_b64_tr_b16 v[128:129], v8 offset:5216
    ds_read_b64_tr_b16 v[130:131], v8 offset:6496
    s_waitcnt lgkmcnt(8)
    v_mfma_f32_16x16x32_bf16 v[212:215], v[112:115], v[24:27], 0
    ds_read_b64_tr_b16 v[132:133], v8 offset:5248
    ds_read_b64_tr_b16 v[134:135], v8 offset:6528
    v_mfma_f32_16x16x32_bf16 v[156:159], v[168:171], v[28:31], v[156:159]
    s_waitcnt lgkmcnt(8)
    v_mfma_f32_16x16x32_bf16 v[196:199], v[116:119], v[28:31], v[196:199]
    s_barrier
    ds_read_b128 v[48:51], v10 offset:24576
    ds_read_b128 v[52:55], v10 offset:28672
    ds_read_b64_tr_b16 v[136:137], v8 offset:10240
    ds_read_b64_tr_b16 v[138:139], v8 offset:11520
    v_mfma_f32_16x16x32_bf16 v[164:167], v[28:31], v[28:31], v[164:167]
    s_waitcnt lgkmcnt(10)
    v_mfma_f32_16x16x32_bf16 v[200:203], v[120:123], v[28:31], v[200:203]
    ds_read_b64_tr_b16 v[140:141], v8 offset:10272
    ds_read_b64_tr_b16 v[142:143], v8 offset:11552
    s_waitcnt lgkmcnt(10)
    v_mfma_f32_16x16x32_bf16 v[204:207], v[124:127], v[28:31], v[204:207]
    ds_read_b64_tr_b16 v[144:145], v8 offset:10304
    ds_read_b64_tr_b16 v[146:147], v8 offset:11584
    v_mfma_f32_16x16x32_bf16 v[156:159], v[168:171], v[32:35], v[156:159]
    s_waitcnt lgkmcnt(10)
    v_mfma_f32_16x16x32_bf16 v[208:211], v[128:131], v[28:31], v[208:211]
    ds_read_b64_tr_b16 v[148:149], v8 offset:10336
    ds_read_b64_tr_b16 v[150:151], v8 offset:11616
    s_waitcnt lgkmcnt(10)
    v_mfma_f32_16x16x32_bf16 v[212:215], v[132:135], v[28:31], v[212:215]
    ds_read_b64_tr_b16 v[152:153], v8 offset:10368
    ds_read_b64_tr_b16 v[154:155], v8 offset:11648
    v_mfma_f32_16x16x32_bf16 v[164:167], v[32:35], v[32:35], v[164:167]
    s_waitcnt lgkmcnt(8)
    v_mfma_f32_16x16x32_bf16 v[196:199], v[136:139], v[32:35], v[196:199]
    ds_read_b64_tr_b16 v[96:97], v8 offset:15360
    ds_read_b64_tr_b16 v[98:99], v8 offset:16640
    v_mfma_f32_16x16x32_bf16 v[156:159], v[168:171], v[36:39], v[156:159]
    s_waitcnt lgkmcnt(8)
    v_mfma_f32_16x16x32_bf16 v[200:203], v[140:143], v[32:35], v[200:203]
    ds_read_b64_tr_b16 v[100:101], v8 offset:15392
    ds_read_b64_tr_b16 v[102:103], v8 offset:16672
    s_waitcnt lgkmcnt(8)
    v_mfma_f32_16x16x32_bf16 v[204:207], v[144:147], v[32:35], v[204:207]
    ds_read_b64_tr_b16 v[104:105], v8 offset:15424
    ds_read_b64_tr_b16 v[106:107], v8 offset:16704
    v_mfma_f32_16x16x32_bf16 v[164:167], v[36:39], v[36:39], v[164:167]
    s_waitcnt lgkmcnt(8)
    v_mfma_f32_16x16x32_bf16 v[208:211], v[148:151], v[32:35], v[208:211]
    ds_read_b64_tr_b16 v[108:109], v8 offset:15456
    ds_read_b64_tr_b16 v[110:111], v8 offset:16736
    s_waitcnt lgkmcnt(8)
    v_mfma_f32_16x16x32_bf16 v[212:215], v[152:155], v[32:35], v[212:215]
    ds_read_b64_tr_b16 v[112:113], v8 offset:15488
    ds_read_b64_tr_b16 v[114:115], v8 offset:16768
    v_mfma_f32_16x16x32_bf16 v[156:159], v[168:171], v[40:43], v[156:159]
    s_waitcnt lgkmcnt(8)
    v_mfma_f32_16x16x32_bf16 v[196:199], v[96:99], v[36:39], v[196:199]
    s_barrier
    ds_read_b128 v[56:59], v10 offset:32768
    ds_read_b128 v[60:63], v10 offset:36864
    ds_read_b64_tr_b16 v[116:117], v8 offset:20480
    ds_read_b64_tr_b16 v[118:119], v8 offset:21760
    v_mfma_f32_16x16x32_bf16 v[164:167], v[40:43], v[40:43], v[164:167]
    s_waitcnt lgkmcnt(10)
    v_mfma_f32_16x16x32_bf16 v[200:203], v[100:103], v[36:39], v[200:203]
    ds_read_b64_tr_b16 v[120:121], v8 offset:20512
    ds_read_b64_tr_b16 v[122:123], v8 offset:21792
    s_waitcnt lgkmcnt(10)
    v_mfma_f32_16x16x32_bf16 v[204:207], v[104:107], v[36:39], v[204:207]
    ds_read_b64_tr_b16 v[124:125], v8 offset:20544
    ds_read_b64_tr_b16 v[126:127], v8 offset:21824
    v_mfma_f32_16x16x32_bf16 v[156:159], v[168:171], v[44:47], v[156:159]
    s_waitcnt lgkmcnt(10)
    v_mfma_f32_16x16x32_bf16 v[208:211], v[108:111], v[36:39], v[208:211]
    ds_read_b64_tr_b16 v[128:129], v8 offset:20576
    ds_read_b64_tr_b16 v[130:131], v8 offset:21856
    s_waitcnt lgkmcnt(10)
    v_mfma_f32_16x16x32_bf16 v[212:215], v[112:115], v[36:39], v[212:215]
    ds_read_b64_tr_b16 v[132:133], v8 offset:20608
    ds_read_b64_tr_b16 v[134:135], v8 offset:21888
    v_mfma_f32_16x16x32_bf16 v[164:167], v[44:47], v[44:47], v[164:167]
    s_waitcnt lgkmcnt(8)
    v_mfma_f32_16x16x32_bf16 v[196:199], v[116:119], v[40:43], v[196:199]
    ds_read_b64_tr_b16 v[136:137], v8 offset:25600
    ds_read_b64_tr_b16 v[138:139], v8 offset:26880
    v_mfma_f32_16x16x32_bf16 v[156:159], v[168:171], v[48:51], v[156:159]
    s_waitcnt lgkmcnt(8)
    v_mfma_f32_16x16x32_bf16 v[200:203], v[120:123], v[40:43], v[200:203]
    ds_read_b64_tr_b16 v[140:141], v8 offset:25632
    ds_read_b64_tr_b16 v[142:143], v8 offset:26912
    s_waitcnt lgkmcnt(8)
    v_mfma_f32_16x16x32_bf16 v[204:207], v[124:127], v[40:43], v[204:207]
    ds_read_b64_tr_b16 v[144:145], v8 offset:25664
    ds_read_b64_tr_b16 v[146:147], v8 offset:26944
    v_mfma_f32_16x16x32_bf16 v[164:167], v[48:51], v[48:51], v[164:167]
    s_waitcnt lgkmcnt(8)
    v_mfma_f32_16x16x32_bf16 v[208:211], v[128:131], v[40:43], v[208:211]
    ds_read_b64_tr_b16 v[148:149], v8 offset:25696
    ds_read_b64_tr_b16 v[150:151], v8 offset:26976
    s_waitcnt lgkmcnt(8)
    v_mfma_f32_16x16x32_bf16 v[212:215], v[132:135], v[40:43], v[212:215]
    ds_read_b64_tr_b16 v[152:153], v8 offset:25728
    ds_read_b64_tr_b16 v[154:155], v8 offset:27008
    v_mfma_f32_16x16x32_bf16 v[156:159], v[168:171], v[52:55], v[156:159]
    s_waitcnt lgkmcnt(8)
    v_mfma_f32_16x16x32_bf16 v[196:199], v[136:139], v[44:47], v[196:199]
    s_barrier
    ds_read_b128 v[64:67], v10 offset:40960
    ds_read_b128 v[68:71], v10 offset:45056
    ds_read_b64_tr_b16 v[96:97], v8 offset:30720
    ds_read_b64_tr_b16 v[98:99], v8 offset:32000
    v_mfma_f32_16x16x32_bf16 v[164:167], v[52:55], v[52:55], v[164:167]
    s_waitcnt lgkmcnt(10)
    v_mfma_f32_16x16x32_bf16 v[200:203], v[140:143], v[44:47], v[200:203]
    ds_read_b64_tr_b16 v[100:101], v8 offset:30752
    ds_read_b64_tr_b16 v[102:103], v8 offset:32032
    s_waitcnt lgkmcnt(10)
    v_mfma_f32_16x16x32_bf16 v[204:207], v[144:147], v[44:47], v[204:207]
    ds_read_b64_tr_b16 v[104:105], v8 offset:30784
    ds_read_b64_tr_b16 v[106:107], v8 offset:32064
    v_mfma_f32_16x16x32_bf16 v[156:159], v[168:171], v[56:59], v[156:159]
    s_waitcnt lgkmcnt(10)
    v_mfma_f32_16x16x32_bf16 v[208:211], v[148:151], v[44:47], v[208:211]
    ds_read_b64_tr_b16 v[108:109], v8 offset:30816
    ds_read_b64_tr_b16 v[110:111], v8 offset:32096
    s_waitcnt lgkmcnt(10)
    v_mfma_f32_16x16x32_bf16 v[212:215], v[152:155], v[44:47], v[212:215]
    ds_read_b64_tr_b16 v[112:113], v8 offset:30848
    ds_read_b64_tr_b16 v[114:115], v8 offset:32128
    v_mfma_f32_16x16x32_bf16 v[164:167], v[56:59], v[56:59], v[164:167]
    s_waitcnt lgkmcnt(8)
    v_mfma_f32_16x16x32_bf16 v[196:199], v[96:99], v[48:51], v[196:199]
    ds_read_b64_tr_b16 v[116:117], v8 offset:35840
    ds_read_b64_tr_b16 v[118:119], v8 offset:37120
    v_mfma_f32_16x16x32_bf16 v[156:159], v[168:171], v[60:63], v[156:159]
    s_waitcnt lgkmcnt(8)
    v_mfma_f32_16x16x32_bf16 v[200:203], v[100:103], v[48:51], v[200:203]
    ds_read_b64_tr_b16 v[120:121], v8 offset:35872
    ds_read_b64_tr_b16 v[122:123], v8 offset:37152
    s_waitcnt lgkmcnt(8)
    v_mfma_f32_16x16x32_bf16 v[204:207], v[104:107], v[48:51], v[204:207]
    ds_read_b64_tr_b16 v[124:125], v8 offset:35904
    ds_read_b64_tr_b16 v[126:127], v8 offset:37184
    v_mfma_f32_16x16x32_bf16 v[164:167], v[60:63], v[60:63], v[164:167]
    s_waitcnt lgkmcnt(8)
    v_mfma_f32_16x16x32_bf16 v[208:211], v[108:111], v[48:51], v[208:211]
    ds_read_b64_tr_b16 v[128:129], v8 offset:35936
    ds_read_b64_tr_b16 v[130:131], v8 offset:37216
    s_waitcnt lgkmcnt(8)
    v_mfma_f32_16x16x32_bf16 v[212:215], v[112:115], v[48:51], v[212:215]
    ds_read_b64_tr_b16 v[132:133], v8 offset:35968
    ds_read_b64_tr_b16 v[134:135], v8 offset:37248
    v_mfma_f32_16x16x32_bf16 v[156:159], v[168:171], v[64:67], v[156:159]
    s_waitcnt lgkmcnt(8)
    v_mfma_f32_16x16x32_bf16 v[196:199], v[116:119], v[52:55], v[196:199]
    s_barrier
    ds_read_b128 v[72:75], v10 offset:49152
    ds_read_b128 v[76:79], v10 offset:53248
    ds_read_b64_tr_b16 v[136:137], v8 offset:40960
    ds_read_b64_tr_b16 v[138:139], v8 offset:42240
    v_mfma_f32_16x16x32_bf16 v[164:167], v[64:67], v[64:67], v[164:167]
    s_waitcnt lgkmcnt(10)
    v_mfma_f32_16x16x32_bf16 v[200:203], v[120:123], v[52:55], v[200:203]
    ds_read_b64_tr_b16 v[140:141], v8 offset:40992
    ds_read_b64_tr_b16 v[142:143], v8 offset:42272
    s_waitcnt lgkmcnt(10)
    v_mfma_f32_16x16x32_bf16 v[204:207], v[124:127], v[52:55], v[204:207]
    ds_read_b64_tr_b16 v[144:145], v8 offset:41024
    ds_read_b64_tr_b16 v[146:147], v8 offset:42304
    v_mfma_f32_16x16x32_bf16 v[156:159], v[168:171], v[68:71], v[156:159]
    s_waitcnt lgkmcnt(10)
    v_mfma_f32_16x16x32_bf16 v[208:211], v[128:131], v[52:55], v[208:211]
    ds_read_b64_tr_b16 v[148:149], v8 offset:41056
    ds_read_b64_tr_b16 v[150:151], v8 offset:42336
    s_waitcnt lgkmcnt(10)
    v_mfma_f32_16x16x32_bf16 v[212:215], v[132:135], v[52:55], v[212:215]
    ds_read_b64_tr_b16 v[152:153], v8 offset:41088
    ds_read_b64_tr_b16 v[154:155], v8 offset:42368
    v_mfma_f32_16x16x32_bf16 v[164:167], v[68:71], v[68:71], v[164:167]
    s_waitcnt lgkmcnt(8)
    v_mfma_f32_16x16x32_bf16 v[196:199], v[136:139], v[56:59], v[196:199]
    ds_read_b64_tr_b16 v[96:97], v9 offset:0
    ds_read_b64_tr_b16 v[98:99], v9 offset:1280
    v_mfma_f32_16x16x32_bf16 v[156:159], v[168:171], v[72:75], v[156:159]
    s_waitcnt lgkmcnt(8)
    v_mfma_f32_16x16x32_bf16 v[200:203], v[140:143], v[56:59], v[200:203]
    ds_read_b64_tr_b16 v[100:101], v9 offset:32
    ds_read_b64_tr_b16 v[102:103], v9 offset:1312
    s_waitcnt lgkmcnt(8)
    v_mfma_f32_16x16x32_bf16 v[204:207], v[144:147], v[56:59], v[204:207]
    ds_read_b64_tr_b16 v[104:105], v9 offset:64
    ds_read_b64_tr_b16 v[106:107], v9 offset:1344
    v_mfma_f32_16x16x32_bf16 v[164:167], v[72:75], v[72:75], v[164:167]
    s_waitcnt lgkmcnt(8)
    v_mfma_f32_16x16x32_bf16 v[208:211], v[148:151], v[56:59], v[208:211]
    ds_read_b64_tr_b16 v[108:109], v9 offset:96
    ds_read_b64_tr_b16 v[110:111], v9 offset:1376
    s_waitcnt lgkmcnt(8)
    v_mfma_f32_16x16x32_bf16 v[212:215], v[152:155], v[56:59], v[212:215]
    ds_read_b64_tr_b16 v[112:113], v9 offset:128
    ds_read_b64_tr_b16 v[114:115], v9 offset:1408
    v_mfma_f32_16x16x32_bf16 v[156:159], v[168:171], v[76:79], v[156:159]
    s_waitcnt lgkmcnt(8)
    v_mfma_f32_16x16x32_bf16 v[196:199], v[96:99], v[60:63], v[196:199]
    s_barrier
    ds_read_b128 v[80:83], v10 offset:57344
    ds_read_b128 v[84:87], v10 offset:61440
    ds_read_b64_tr_b16 v[116:117], v9 offset:5120
    ds_read_b64_tr_b16 v[118:119], v9 offset:6400
    v_mfma_f32_16x16x32_bf16 v[164:167], v[76:79], v[76:79], v[164:167]
    s_waitcnt lgkmcnt(10)
    v_mfma_f32_16x16x32_bf16 v[200:203], v[100:103], v[60:63], v[200:203]
    ds_read_b64_tr_b16 v[120:121], v9 offset:5152
    ds_read_b64_tr_b16 v[122:123], v9 offset:6432
    s_waitcnt lgkmcnt(10)
    v_mfma_f32_16x16x32_bf16 v[204:207], v[104:107], v[60:63], v[204:207]
    ds_read_b64_tr_b16 v[124:125], v9 offset:5184
    ds_read_b64_tr_b16 v[126:127], v9 offset:6464
    s_waitcnt lgkmcnt(10)
    v_mfma_f32_16x16x32_bf16 v[208:211], v[108:111], v[60:63], v[208:211]
    ds_read_b64_tr_b16 v[128:129], v9 offset:5216
    ds_read_b64_tr_b16 v[130:131], v9 offset:6496
    s_waitcnt lgkmcnt(10)
    v_mfma_f32_16x16x32_bf16 v[212:215], v[112:115], v[60:63], v[212:215]
    ds_read_b64_tr_b16 v[132:133], v9 offset:5248
    ds_read_b64_tr_b16 v[134:135], v9 offset:6528
    s_waitcnt lgkmcnt(8)
    v_mfma_f32_16x16x32_bf16 v[196:199], v[116:119], v[64:67], v[196:199]
    ds_read_b64_tr_b16 v[136:137], v9 offset:10240
    ds_read_b64_tr_b16 v[138:139], v9 offset:11520
    v_mfma_f32_16x16x32_bf16 v[156:159], v[168:171], v[80:83], v[156:159]
    s_waitcnt lgkmcnt(8)
    v_mfma_f32_16x16x32_bf16 v[200:203], v[120:123], v[64:67], v[200:203]
    ds_read_b64_tr_b16 v[140:141], v9 offset:10272
    ds_read_b64_tr_b16 v[142:143], v9 offset:11552
    s_waitcnt lgkmcnt(8)
    v_mfma_f32_16x16x32_bf16 v[204:207], v[124:127], v[64:67], v[204:207]
    ds_read_b64_tr_b16 v[144:145], v9 offset:10304
    ds_read_b64_tr_b16 v[146:147], v9 offset:11584
    v_mfma_f32_16x16x32_bf16 v[164:167], v[80:83], v[80:83], v[164:167]
    s_waitcnt lgkmcnt(8)
    v_mfma_f32_16x16x32_bf16 v[208:211], v[128:131], v[64:67], v[208:211]
    ds_read_b64_tr_b16 v[148:149], v9 offset:10336
    ds_read_b64_tr_b16 v[150:151], v9 offset:11616
    s_waitcnt lgkmcnt(8)
    v_mfma_f32_16x16x32_bf16 v[212:215], v[132:135], v[64:67], v[212:215]
    ds_read_b64_tr_b16 v[152:153], v9 offset:10368
    ds_read_b64_tr_b16 v[154:155], v9 offset:11648
    v_mfma_f32_16x16x32_bf16 v[156:159], v[168:171], v[84:87], v[156:159]
    s_waitcnt lgkmcnt(8)
    v_mfma_f32_16x16x32_bf16 v[196:199], v[136:139], v[68:71], v[196:199]
    s_barrier
    ds_read_b128 v[88:91], v11 offset:0
    ds_read_b128 v[92:95], v11 offset:4096
    ds_read_b64_tr_b16 v[96:97], v9 offset:15360
    ds_read_b64_tr_b16 v[98:99], v9 offset:16640
    v_mfma_f32_16x16x32_bf16 v[164:167], v[84:87], v[84:87], v[164:167]
    s_waitcnt lgkmcnt(10)
    v_mfma_f32_16x16x32_bf16 v[200:203], v[140:143], v[68:71], v[200:203]
    ds_read_b64_tr_b16 v[100:101], v9 offset:15392
    ds_read_b64_tr_b16 v[102:103], v9 offset:16672
    s_waitcnt lgkmcnt(10)
    v_mfma_f32_16x16x32_bf16 v[204:207], v[144:147], v[68:71], v[204:207]
    ds_read_b64_tr_b16 v[104:105], v9 offset:15424
    ds_read_b64_tr_b16 v[106:107], v9 offset:16704
    s_waitcnt lgkmcnt(10)
    v_mfma_f32_16x16x32_bf16 v[208:211], v[148:151], v[68:71], v[208:211]
    ds_read_b64_tr_b16 v[108:109], v9 offset:15456
    ds_read_b64_tr_b16 v[110:111], v9 offset:16736
    s_waitcnt lgkmcnt(10)
    v_mfma_f32_16x16x32_bf16 v[212:215], v[152:155], v[68:71], v[212:215]
    ds_read_b64_tr_b16 v[112:113], v9 offset:15488
    ds_read_b64_tr_b16 v[114:115], v9 offset:16768
    s_waitcnt lgkmcnt(8)
    v_mfma_f32_16x16x32_bf16 v[196:199], v[96:99], v[72:75], v[196:199]
    ds_read_b64_tr_b16 v[116:117], v9 offset:20480
    ds_read_b64_tr_b16 v[118:119], v9 offset:21760
    v_mfma_f32_16x16x32_bf16 v[156:159], v[168:171], v[88:91], v[156:159]
    s_waitcnt lgkmcnt(8)
    v_mfma_f32_16x16x32_bf16 v[200:203], v[100:103], v[72:75], v[200:203]
    ds_read_b64_tr_b16 v[120:121], v9 offset:20512
    ds_read_b64_tr_b16 v[122:123], v9 offset:21792
    s_waitcnt lgkmcnt(8)
    v_mfma_f32_16x16x32_bf16 v[204:207], v[104:107], v[72:75], v[204:207]
    ds_read_b64_tr_b16 v[124:125], v9 offset:20544
    ds_read_b64_tr_b16 v[126:127], v9 offset:21824
    v_mfma_f32_16x16x32_bf16 v[164:167], v[88:91], v[88:91], v[164:167]
    s_waitcnt lgkmcnt(8)
    v_mfma_f32_16x16x32_bf16 v[208:211], v[108:111], v[72:75], v[208:211]
    ds_read_b64_tr_b16 v[128:129], v9 offset:20576
    ds_read_b64_tr_b16 v[130:131], v9 offset:21856
    s_waitcnt lgkmcnt(8)
    v_mfma_f32_16x16x32_bf16 v[212:215], v[112:115], v[72:75], v[212:215]
    ds_read_b64_tr_b16 v[132:133], v9 offset:20608
    ds_read_b64_tr_b16 v[134:135], v9 offset:21888
    v_mfma_f32_16x16x32_bf16 v[156:159], v[168:171], v[92:95], v[156:159]
    s_waitcnt lgkmcnt(8)
    v_mfma_f32_16x16x32_bf16 v[196:199], v[116:119], v[76:79], v[196:199]
    s_barrier
    ds_read_b64_tr_b16 v[136:137], v9 offset:25600
    ds_read_b64_tr_b16 v[138:139], v9 offset:26880
    v_mfma_f32_16x16x32_bf16 v[164:167], v[92:95], v[92:95], v[164:167]
    s_waitcnt lgkmcnt(8)
    v_mfma_f32_16x16x32_bf16 v[200:203], v[120:123], v[76:79], v[200:203]
    ds_read_b64_tr_b16 v[140:141], v9 offset:25632
    ds_read_b64_tr_b16 v[142:143], v9 offset:26912
    s_waitcnt lgkmcnt(8)
    v_mfma_f32_16x16x32_bf16 v[204:207], v[124:127], v[76:79], v[204:207]
    ds_read_b64_tr_b16 v[144:145], v9 offset:25664
    ds_read_b64_tr_b16 v[146:147], v9 offset:26944
    s_waitcnt lgkmcnt(8)
    v_mfma_f32_16x16x32_bf16 v[208:211], v[128:131], v[76:79], v[208:211]
    ds_read_b64_tr_b16 v[148:149], v9 offset:25696
    ds_read_b64_tr_b16 v[150:151], v9 offset:26976
    v_lshlrev_b32 v12, 2, v2
    v_sub_u32 v12, v3, v12
    s_waitcnt lgkmcnt(8)
    v_mfma_f32_16x16x32_bf16 v[212:215], v[132:135], v[76:79], v[212:215]
    ds_read_b64_tr_b16 v[152:153], v9 offset:25728
    ds_read_b64_tr_b16 v[154:155], v9 offset:27008
    v_mov_b32 v13, 0
    v_cmp_eq_u32 vcc, 0, v12
    s_nop 1
    v_cndmask_b32 v13, v13, v164, vcc
    s_waitcnt lgkmcnt(8)
    v_mfma_f32_16x16x32_bf16 v[196:199], v[136:139], v[80:83], v[196:199]
    ds_read_b64_tr_b16 v[96:97], v9 offset:30720
    ds_read_b64_tr_b16 v[98:99], v9 offset:32000
    v_cmp_eq_u32 vcc, 1, v12
    s_nop 1
    v_cndmask_b32 v13, v13, v165, vcc
    s_waitcnt lgkmcnt(8)
    v_mfma_f32_16x16x32_bf16 v[200:203], v[140:143], v[80:83], v[200:203]
    ds_read_b64_tr_b16 v[100:101], v9 offset:30752
    ds_read_b64_tr_b16 v[102:103], v9 offset:32032
    v_cmp_eq_u32 vcc, 2, v12
    s_nop 1
    v_cndmask_b32 v13, v13, v166, vcc
    v_cmp_eq_u32 vcc, 3, v12
    s_waitcnt lgkmcnt(8)
    v_mfma_f32_16x16x32_bf16 v[204:207], v[144:147], v[80:83], v[204:207]
    ds_read_b64_tr_b16 v[104:105], v9 offset:30784
    ds_read_b64_tr_b16 v[106:107], v9 offset:32064
    v_cndmask_b32 v13, v13, v167, vcc
    v_mov_b32 v15, v13
    s_waitcnt lgkmcnt(8)
    v_mfma_f32_16x16x32_bf16 v[208:211], v[148:151], v[80:83], v[208:211]
    ds_read_b64_tr_b16 v[108:109], v9 offset:30816
    ds_read_b64_tr_b16 v[110:111], v9 offset:32096
    v_permlane16_swap_b32 v13, v15
    v_add_f32 v13, v13, v15
    v_mov_b32 v15, v13
    s_waitcnt lgkmcnt(8)
    v_mfma_f32_16x16x32_bf16 v[212:215], v[152:155], v[80:83], v[212:215]
    ds_read_b64_tr_b16 v[112:113], v9 offset:30848
    ds_read_b64_tr_b16 v[114:115], v9 offset:32128
    v_permlane32_swap_b32 v13, v15
    v_add_f32 v13, v13, v15
    v_mul_f32 v12, 0x3ae38e39, v156
    s_waitcnt lgkmcnt(8)
    v_mfma_f32_16x16x32_bf16 v[196:199], v[96:99], v[84:87], v[196:199]
    s_barrier
    ds_read_b64_tr_b16 v[116:117], v9 offset:35840
    ds_read_b64_tr_b16 v[118:119], v9 offset:37120
    v_mul_f32 v14, 0x3ae38e39, v13
    v_fma_f32 v14, -v12, v12, v14
    s_waitcnt lgkmcnt(8)
    v_mfma_f32_16x16x32_bf16 v[200:203], v[100:103], v[84:87], v[200:203]
    ds_read_b64_tr_b16 v[120:121], v9 offset:35872
    ds_read_b64_tr_b16 v[122:123], v9 offset:37152
    v_max_f32 v14, 0, v14
    v_cvt_pk_bf16_f32 v15, v12, v12
    v_and_b32 v15, 0xffff0000, v15
    s_waitcnt lgkmcnt(8)
    v_mfma_f32_16x16x32_bf16 v[204:207], v[104:107], v[84:87], v[204:207]
    ds_read_b64_tr_b16 v[124:125], v9 offset:35904
    ds_read_b64_tr_b16 v[126:127], v9 offset:37184
    v_cvt_pk_bf16_f32 v173, v14, v14
    v_and_b32 v173, 0xffff0000, v173
    s_waitcnt lgkmcnt(8)
    v_mfma_f32_16x16x32_bf16 v[208:211], v[108:111], v[84:87], v[208:211]
    ds_read_b64_tr_b16 v[128:129], v9 offset:35936
    ds_read_b64_tr_b16 v[130:131], v9 offset:37216
    v_add_f32 v173, 0x3727c5ac, v173
    v_cvt_pk_bf16_f32 v173, v173, v173
    v_and_b32 v173, 0xffff0000, v173
    s_waitcnt lgkmcnt(8)
    v_mfma_f32_16x16x32_bf16 v[212:215], v[112:115], v[84:87], v[212:215]
    ds_read_b64_tr_b16 v[132:133], v9 offset:35968
    ds_read_b64_tr_b16 v[134:135], v9 offset:37248
    v_sqrt_f32 v173, v173
    s_nop 0
    v_cvt_pk_bf16_f32 v172, v173, v173
    s_waitcnt lgkmcnt(8)
    v_mfma_f32_16x16x32_bf16 v[196:199], v[116:119], v[88:91], v[196:199]
    s_barrier
    ds_read_b64_tr_b16 v[136:137], v9 offset:40960
    ds_read_b64_tr_b16 v[138:139], v9 offset:42240
    v_and_b32 v172, 0xffff0000, v172
    v_rcp_f32 v10, v172
    s_nop 0
    v_mul_f32 v11, v15, v10
    s_waitcnt lgkmcnt(8)
    v_mfma_f32_16x16x32_bf16 v[200:203], v[120:123], v[88:91], v[200:203]
    ds_read_b64_tr_b16 v[140:141], v9 offset:40992
    ds_read_b64_tr_b16 v[142:143], v9 offset:42272
    v_mul_f32 v12, 0x3eae1a93, v10
    v_mul_f32 v13, 0x3eae1a93, v11
    v_cndmask_b32 v10, v10, v12, s[52:53]
    s_waitcnt lgkmcnt(8)
    v_mfma_f32_16x16x32_bf16 v[204:207], v[124:127], v[88:91], v[204:207]
    ds_read_b64_tr_b16 v[144:145], v9 offset:41024
    ds_read_b64_tr_b16 v[146:147], v9 offset:42304
    v_cndmask_b32 v11, v11, v13, s[52:53]
    s_add_u32 s22, s16, s39
    s_waitcnt lgkmcnt(8)
    v_mfma_f32_16x16x32_bf16 v[208:211], v[128:131], v[88:91], v[208:211]
    ds_read_b64_tr_b16 v[148:149], v9 offset:41056
    ds_read_b64_tr_b16 v[150:151], v9 offset:42336
    s_addc_u32 s23, s17, 0
    s_add_u32 s20, s22, 155648
    s_addc_u32 s21, s23, 0
    s_waitcnt lgkmcnt(8)
    v_mfma_f32_16x16x32_bf16 v[212:215], v[132:135], v[88:91], v[212:215]
    ds_read_b64_tr_b16 v[152:153], v9 offset:41088
    ds_read_b64_tr_b16 v[154:155], v9 offset:42368
    v_lshlrev_b32 v14, 4, v2
    v_add_u32 v14, 162368, v14
    s_waitcnt lgkmcnt(8)
    v_mfma_f32_16x16x32_bf16 v[196:199], v[136:139], v[92:95], v[196:199]
    s_waitcnt vmcnt(0)
    v_cndmask_b32 v246, v246, v168, s[30:31]
    v_cndmask_b32 v247, v247, v168, s[30:31]
    s_waitcnt lgkmcnt(6)
    v_mfma_f32_16x16x32_bf16 v[200:203], v[140:143], v[92:95], v[200:203]
    v_cndmask_b32 v248, v248, v168, s[30:31]
    v_cndmask_b32 v249, v249, v168, s[30:31]
    s_waitcnt lgkmcnt(4)
    v_mfma_f32_16x16x32_bf16 v[204:207], v[144:147], v[92:95], v[204:207]
    v_cndmask_b32 v250, v250, v168, s[30:31]
    v_cndmask_b32 v251, v251, v168, s[30:31]
    v_cndmask_b32 v252, v252, v168, s[30:31]
    s_waitcnt lgkmcnt(2)
    v_mfma_f32_16x16x32_bf16 v[208:211], v[148:151], v[92:95], v[208:211]
    v_cndmask_b32 v253, v253, v168, s[30:31]
    v_cndmask_b32 v254, v254, v168, s[30:31]
    v_cndmask_b32 v255, v255, v168, s[30:31]
    s_waitcnt lgkmcnt(0)
    v_mfma_f32_16x16x32_bf16 v[212:215], v[152:155], v[92:95], v[212:215]
    s_barrier
    ds_read_b128 v[232:235], v14 offset:256
    ds_read_b128 v[216:219], v14 offset:0
    ds_read_b128 v[220:223], v14 offset:64
    ds_read_b128 v[224:227], v14 offset:128
    ds_read_b128 v[228:231], v14 offset:192
L_E:
    s_nop 4
    v_pk_mul_f32 v[106:107], v[10:11], v[212:213] op_sel_hi:[0,1]
    v_pk_mul_f32 v[108:109], v[10:11], v[214:215] op_sel_hi:[0,1]
    s_waitcnt lgkmcnt(4)
    v_pk_fma_f32 v[106:107], v[10:11], v[232:233], v[106:107] op_sel:[1,0,0] neg_lo:[1,0,0] neg_hi:[1,0,0]
    v_pk_fma_f32 v[108:109], v[10:11], v[234:235], v[108:109] op_sel:[1,0,0] neg_lo:[1,0,0] neg_hi:[1,0,0]
    v_cvt_pk_bf16_f32 v104, v106, v107
    v_cvt_pk_bf16_f32 v105, v108, v109
    ds_write_b64 v18, v[104:105] offset:128
    ds_read_b64_tr_b16 v[118:119], v19 offset:128
    ds_read_b64_tr_b16 v[120:121], v19 offset:1472
    s_cmp_ge_u32 s4, 3
    s_cbranch_scc1 L_vpart
    s_cmp_eq_u32 s4, 2
    s_cbranch_scc0 L_k01
    v_mov_b32_dpp v114, v105 quad_perm:[0,0,0,0] row_mask:0xf bank_mask:0xf
    v_mov_b32_dpp v115, v105 quad_perm:[1,1,1,1] row_mask:0xf bank_mask:0xf
    v_mov_b32_dpp v116, v105 quad_perm:[2,2,2,2] row_mask:0xf bank_mask:0xf
    v_mov_b32_dpp v117, v105 quad_perm:[3,3,3,3] row_mask:0xf bank_mask:0xf
    s_branch L_kst
L_k01:
    v_mov_b32 v114, v104
    v_mov_b32 v115, v105
    s_nop 0
    v_permlane16_swap_b32 v114, v116
    v_permlane16_swap_b32 v115, v117
L_kst:
    s_mov_b64 exec, s[50:51]
    global_store_dwordx4 v0, v[114:117], s[20:21]
    global_store_dwordx4 v0, v[114:117], s[22:23] sc1
    s_mov_b64 exec, -1
L_vpart:
    v_pk_mul_f32 v[106:107], v[12:13], v[196:197] op_sel_hi:[0,1]
    v_pk_mul_f32 v[108:109], v[12:13], v[198:199] op_sel_hi:[0,1]
    s_waitcnt lgkmcnt(3)
    v_pk_fma_f32 v[106:107], v[12:13], v[216:217], v[106:107] op_sel:[1,0,0] neg_lo:[1,0,0] neg_hi:[1,0,0]
    v_pk_fma_f32 v[108:109], v[12:13], v[218:219], v[108:109] op_sel:[1,0,0] neg_lo:[1,0,0] neg_hi:[1,0,0]
    v_cvt_pk_bf16_f32 v96, v106, v107
    v_cvt_pk_bf16_f32 v97, v108, v109
    ds_write_b64 v18, v[96:97] offset:0
    v_pk_mul_f32 v[110:111], v[12:13], v[200:201] op_sel_hi:[0,1]
    v_pk_mul_f32 v[112:113], v[12:13], v[202:203] op_sel_hi:[0,1]
    v_pk_fma_f32 v[110:111], v[12:13], v[220:221], v[110:111] op_sel:[1,0,0] neg_lo:[1,0,0] neg_hi:[1,0,0]
    v_pk_fma_f32 v[112:113], v[12:13], v[222:223], v[112:113] op_sel:[1,0,0] neg_lo:[1,0,0] neg_hi:[1,0,0]
    v_cvt_pk_bf16_f32 v98, v110, v111
    v_cvt_pk_bf16_f32 v99, v112, v113
    ds_write_b64 v18, v[98:99] offset:32
    s_sub_u32 s24, s4, 3
    s_cmp_ge_u32 s24, 3
    s_cbranch_scc1 L_kvdone
    s_cmp_eq_u32 s24, 2
    s_waitcnt lgkmcnt(2)
    s_cbranch_scc0 L_vst
    s_mov_b64 exec, 0x10001000
    v_mov_b32 v118, 0x3f803f80
    v_mov_b32 v119, 0x3f803f80
    v_mov_b32 v120, 0x3f803f80
    v_mov_b32 v121, 0x3f803f80
    s_mov_b64 exec, 0x20002000
    v_mov_b32 v118, 0
    v_mov_b32 v119, 0
    v_mov_b32 v120, 0
    v_mov_b32 v121, 0
L_vst:
    s_mov_b64 exec, s[50:51]
    global_store_dwordx4 v0, v[118:121], s[20:21]
    global_store_dwordx4 v0, v[118:121], s[22:23] sc1
    s_mov_b64 exec, -1
L_kvdone:
    v_pk_mul_f32 v[106:107], v[12:13], v[204:205] op_sel_hi:[0,1]
    v_pk_mul_f32 v[108:109], v[12:13], v[206:207] op_sel_hi:[0,1]
    v_pk_fma_f32 v[106:107], v[12:13], v[224:225], v[106:107] op_sel:[1,0,0] neg_lo:[1,0,0] neg_hi:[1,0,0]
    v_pk_fma_f32 v[108:109], v[12:13], v[226:227], v[108:109] op_sel:[1,0,0] neg_lo:[1,0,0] neg_hi:[1,0,0]
    v_cvt_pk_bf16_f32 v100, v106, v107
    v_cvt_pk_bf16_f32 v101, v108, v109
    ds_write_b64 v18, v[100:101] offset:64
    v_pk_mul_f32 v[110:111], v[12:13], v[208:209] op_sel_hi:[0,1]
    v_pk_mul_f32 v[112:113], v[12:13], v[210:211] op_sel_hi:[0,1]
    v_pk_fma_f32 v[110:111], v[12:13], v[228:229], v[110:111] op_sel:[1,0,0] neg_lo:[1,0,0] neg_hi:[1,0,0]
    v_pk_fma_f32 v[112:113], v[12:13], v[230:231], v[112:113] op_sel:[1,0,0] neg_lo:[1,0,0] neg_hi:[1,0,0]
    v_cvt_pk_bf16_f32 v102, v110, v111
    v_cvt_pk_bf16_f32 v103, v112, v113
    ds_write_b64 v18, v[102:103] offset:96
    s_lshl_b32 s24, s5, 8
    s_add_u32 s24, s24, 159744
    v_lshrrev_b32 v164, 1, v1
    v_xor_b32 v164, v164, v1
    v_and_b32 v164, 4, v164
    v_mul_u32_u24 v164, 3, v164
    v_xor_b32 v164, v164, v1
    v_lshlrev_b32 v165, 2, v164
    v_lshlrev_b32 v164, 4, v164
    v_add_u32 v167, s24, v165
    ds_write_b32 v167, v165
    v_mov_b32 v135, 0xdddd
    v_mov_b32 v160, 0
    v_mov_b32 v161, 0
    v_mov_b32 v162, 0
    v_mov_b32 v163, 0
    s_waitcnt lgkmcnt(0)
    s_barrier
    ds_read2_b32 v[176:177], v23 offset0:0 offset1:1
    ds_read2_b32 v[178:179], v23 offset0:2 offset1:3
    ds_read_b32 v216, v22 offset:32
    ds_read2_b32 v[180:181], v23 offset0:9 offset1:10
    ds_read2_b32 v[182:183], v23 offset0:11 offset1:12
    ds_read_b32 v224, v22 offset:68
    v_mfma_f32_32x32x16_bf16 v[64:79], v[160:163], v[160:163], 0
    v_mfma_f32_32x32x16_bf16 v[80:95], v[160:163], v[160:163], 0
    v_mov_b32 v166, v16
    v_mov_b32 v170, 160832
    s_cmp_lg_u32 s44, 0
    s_cbranch_scc1 L_xn
L_prep:
    s_waitcnt lgkmcnt(0)
    v_cndmask_b32 v219, 0, v216, s[52:53]
    v_cndmask_b32 v220, v216, 0, s[52:53]
    v_mov_b32 v216, v219
    v_mov_b32 v217, 0
    v_mov_b32 v218, 0
    v_mov_b32 v223, v220
    v_mov_b32 v221, 0
    v_mov_b32 v222, 0
    v_cndmask_b32 v227, 0, v224, s[52:53]
    v_cndmask_b32 v228, v224, 0, s[52:53]
    v_mov_b32 v224, v227
    v_mov_b32 v225, 0
    v_mov_b32 v226, 0
    v_mov_b32 v231, v228
    v_mov_b32 v229, 0
    v_mov_b32 v230, 0
    s_barrier
    ds_read_b128 v[136:139], v164 offset:0
    ds_read2st64_b32 v[144:145], v165 offset0:32 offset1:33
    ds_read_b128 v[140:143], v164 offset:1024
    ds_read_b128 v[148:151], v166 offset:9216
    ds_read_b128 v[152:155], v166 offset:9856
    s_waitcnt lgkmcnt(3)
    v_mfma_f32_32x32x16_bf16 v[96:111], v[136:139], v[176:179], 0
    v_mfma_f32_32x32x16_bf16 v[112:127], v[136:139], v[180:183], 0
    s_nop 7
    s_nop 1
    v_mfma_f32_32x32x8_bf16 v[96:111], v[144:145], v[216:217], v[96:111]
    v_mfma_f32_32x32x8_bf16 v[112:127], v[144:145], v[224:225], v[112:127]
    s_mov_b32 s11, 0
    s_nop 9
    v_max_f32 v128, v96, v97
    v_max3_f32 v128, v98, v99, v128
    v_max3_f32 v128, v100, v101, v128
    v_max3_f32 v128, v102, v103, v128
    v_max3_f32 v128, v104, v105, v128
    v_max3_f32 v128, v106, v107, v128
    v_max3_f32 v128, v108, v109, v128
    v_max3_f32 v128, v110, v111, v128
    v_mov_b32 v129, v128
    v_max_f32 v130, v112, v113
    v_max3_f32 v130, v114, v115, v130
    v_max3_f32 v130, v116, v117, v130
    v_max3_f32 v130, v118, v119, v130
    v_max3_f32 v130, v120, v121, v130
    v_max3_f32 v130, v122, v123, v130
    v_max3_f32 v130, v124, v125, v130
    v_max3_f32 v130, v126, v127, v130
    v_mov_b32 v131, v130
    v_permlane32_swap_b32 v128, v129
    s_nop 0
    v_permlane32_swap_b32 v130, v131
    v_min_f32 v32, -v128, -v129
    v_min_f32 v33, -v128, -v129
    v_min_f32 v48, -v130, -v131
    v_min_f32 v49, -v130, -v131
    v_pk_add_f32 v[96:97], v[96:97], v[32:33]
    v_pk_add_f32 v[98:99], v[98:99], v[32:33]
    v_pk_add_f32 v[100:101], v[100:101], v[32:33]
    v_pk_add_f32 v[102:103], v[102:103], v[32:33]
    v_pk_add_f32 v[104:105], v[104:105], v[32:33]
    v_pk_add_f32 v[106:107], v[106:107], v[32:33]
    v_pk_add_f32 v[108:109], v[108:109], v[32:33]
    v_pk_add_f32 v[110:111], v[110:111], v[32:33]
    v_pk_mov_b32 v[50:51], v[48:49], v[48:49]
    v_pk_mov_b32 v[52:53], v[48:49], v[48:49]
    v_pk_mov_b32 v[54:55], v[48:49], v[48:49]
    v_pk_mov_b32 v[56:57], v[48:49], v[48:49]
    v_pk_mov_b32 v[58:59], v[48:49], v[48:49]
    v_pk_mov_b32 v[60:61], v[48:49], v[48:49]
    v_pk_mov_b32 v[62:63], v[48:49], v[48:49]
    v_pk_mov_b32 v[34:35], v[32:33], v[32:33]
    v_pk_mov_b32 v[36:37], v[32:33], v[32:33]
    v_pk_mov_b32 v[38:39], v[32:33], v[32:33]
    v_pk_mov_b32 v[40:41], v[32:33], v[32:33]
    v_pk_mov_b32 v[42:43], v[32:33], v[32:33]
    v_pk_mov_b32 v[44:45], v[32:33], v[32:33]
    v_pk_mov_b32 v[46:47], v[32:33], v[32:33]
    s_waitcnt lgkmcnt(0)
    .p2align 6
L_loop:
    v_exp_f32 v96, v96
    v_exp_f32 v97, v97
    v_smfmac_f32_32x32x32_bf16 v[80:95], v[160:163], v[120:127], v135
    ds_read_b128 v[156:159], v166 offset:10496
    v_exp_f32 v98, v98
    v_exp_f32 v99, v99
    v_exp_f32 v100, v100
    v_mfma_f32_32x32x16_bf16 v[112:127], v[136:139], v[180:183], v[48:63]
    ds_read_b128 v[136:139], v164 offset:2048
    v_exp_f32 v101, v101
    v_exp_f32 v102, v102
    v_exp_f32 v103, v103
    v_exp_f32 v104, v104
    v_mfma_f32_32x32x8_bf16 v[112:127], v[144:145], v[224:225], v[112:127]
    v_exp_f32 v105, v105
    v_exp_f32 v106, v106
    v_exp_f32 v107, v107
    v_exp_f32 v108, v108
    v_smfmac_f32_32x32x32_bf16 v[64:79], v[148:151], v[96:103], v135
    ds_read_b128 v[160:163], v166 offset:11136
    v_exp_f32 v109, v109
    v_exp_f32 v110, v110
    v_exp_f32 v111, v111
    v_exp_f32 v112, v112
    v_exp_f32 v113, v113
    v_smfmac_f32_32x32x32_bf16 v[64:79], v[152:155], v[104:111], v135
    ds_read2st64_b32 v[146:147], v165 offset0:34 offset1:35
    v_exp_f32 v114, v114
    v_exp_f32 v115, v115
    v_exp_f32 v116, v116
    v_mfma_f32_32x32x16_bf16 v[96:111], v[140:143], v[176:179], v[32:47]
    v_exp_f32 v117, v117
    v_exp_f32 v118, v118
    v_exp_f32 v119, v119
    v_exp_f32 v120, v120
    v_mfma_f32_32x32x8_bf16 v[96:111], v[144:145], v[220:221], v[96:111]
    v_exp_f32 v121, v121
    v_exp_f32 v122, v122
    v_exp_f32 v123, v123
    v_exp_f32 v124, v124
    v_smfmac_f32_32x32x32_bf16 v[80:95], v[148:151], v[112:119], v135
    s_waitcnt lgkmcnt(0)
    v_exp_f32 v125, v125
    v_exp_f32 v126, v126
    v_exp_f32 v127, v127
    v_exp_f32 v96, v96
    v_exp_f32 v97, v97
    v_smfmac_f32_32x32x32_bf16 v[80:95], v[152:155], v[120:127], v135
    ds_read_b128 v[148:151], v166 offset:11776
    v_exp_f32 v98, v98
    v_exp_f32 v99, v99
    v_exp_f32 v100, v100
    v_mfma_f32_32x32x16_bf16 v[112:127], v[140:143], v[180:183], v[48:63]
    ds_read_b128 v[140:143], v164 offset:3072
    v_exp_f32 v101, v101
    v_exp_f32 v102, v102
    v_exp_f32 v103, v103
    v_exp_f32 v104, v104
    v_mfma_f32_32x32x8_bf16 v[112:127], v[144:145], v[228:229], v[112:127]
    v_exp_f32 v105, v105
    v_exp_f32 v106, v106
    v_exp_f32 v107, v107
    v_exp_f32 v108, v108
    v_smfmac_f32_32x32x32_bf16 v[64:79], v[156:159], v[96:103], v135
    ds_read_b128 v[152:155], v166 offset:12416
    v_exp_f32 v109, v109
    v_exp_f32 v110, v110
    v_exp_f32 v111, v111
    v_exp_f32 v112, v112
    v_exp_f32 v113, v113
    v_smfmac_f32_32x32x32_bf16 v[64:79], v[160:163], v[104:111], v135
    v_exp_f32 v114, v114
    v_exp_f32 v115, v115
    v_exp_f32 v116, v116
    v_mfma_f32_32x32x16_bf16 v[96:111], v[136:139], v[176:179], v[32:47]
    v_exp_f32 v117, v117
    v_exp_f32 v118, v118
    v_exp_f32 v119, v119
    v_exp_f32 v120, v120
    v_mfma_f32_32x32x8_bf16 v[96:111], v[144:145], v[218:219], v[96:111]
    v_exp_f32 v121, v121
    v_exp_f32 v122, v122
    v_exp_f32 v123, v123
    v_exp_f32 v124, v124
    v_smfmac_f32_32x32x32_bf16 v[80:95], v[156:159], v[112:119], v135
    s_waitcnt lgkmcnt(0)
    v_exp_f32 v125, v125
    v_exp_f32 v126, v126
    v_exp_f32 v127, v127
    v_exp_f32 v96, v96
    v_exp_f32 v97, v97
    v_smfmac_f32_32x32x32_bf16 v[80:95], v[160:163], v[120:127], v135
    ds_read_b128 v[156:159], v166 offset:13056
    v_exp_f32 v98, v98
    v_exp_f32 v99, v99
    v_exp_f32 v100, v100
    v_mfma_f32_32x32x16_bf16 v[112:127], v[136:139], v[180:183], v[48:63]
    ds_read_b128 v[136:139], v164 offset:4096
    v_exp_f32 v101, v101
    v_exp_f32 v102, v102
    v_exp_f32 v103, v103
    v_exp_f32 v104, v104
    v_mfma_f32_32x32x8_bf16 v[112:127], v[144:145], v[226:227], v[112:127]
    v_exp_f32 v105, v105
    v_exp_f32 v106, v106
    v_exp_f32 v107, v107
    v_exp_f32 v108, v108
    v_smfmac_f32_32x32x32_bf16 v[64:79], v[148:151], v[96:103], v135
    ds_read_b128 v[160:163], v166 offset:13696
    v_exp_f32 v109, v109
    v_exp_f32 v110, v110
    v_exp_f32 v111, v111
    v_exp_f32 v112, v112
    v_exp_f32 v113, v113
    v_smfmac_f32_32x32x32_bf16 v[64:79], v[152:155], v[104:111], v135
    v_exp_f32 v114, v114
    v_exp_f32 v115, v115
    v_exp_f32 v116, v116
    v_mfma_f32_32x32x16_bf16 v[96:111], v[140:143], v[176:179], v[32:47]
    v_exp_f32 v117, v117
    v_exp_f32 v118, v118
    v_exp_f32 v119, v119
    v_exp_f32 v120, v120
    v_mfma_f32_32x32x8_bf16 v[96:111], v[144:145], v[222:223], v[96:111]
    v_exp_f32 v121, v121
    v_exp_f32 v122, v122
    v_exp_f32 v123, v123
    v_exp_f32 v124, v124
    v_smfmac_f32_32x32x32_bf16 v[80:95], v[148:151], v[112:119], v135
    s_waitcnt lgkmcnt(0)
    v_exp_f32 v125, v125
    v_exp_f32 v126, v126
    v_exp_f32 v127, v127
    v_exp_f32 v96, v96
    v_exp_f32 v97, v97
    v_smfmac_f32_32x32x32_bf16 v[80:95], v[152:155], v[120:127], v135
    ds_read_b128 v[148:151], v166 offset:14336
    v_exp_f32 v98, v98
    v_exp_f32 v99, v99
    v_exp_f32 v100, v100
    v_mfma_f32_32x32x16_bf16 v[112:127], v[140:143], v[180:183], v[48:63]
    ds_read_b128 v[140:143], v164 offset:5120
    v_exp_f32 v101, v101
    v_exp_f32 v102, v102
    v_exp_f32 v103, v103
    v_exp_f32 v104, v104
    v_mfma_f32_32x32x8_bf16 v[112:127], v[144:145], v[230:231], v[112:127]
    v_exp_f32 v105, v105
    v_exp_f32 v106, v106
    v_exp_f32 v107, v107
    v_exp_f32 v108, v108
    v_smfmac_f32_32x32x32_bf16 v[64:79], v[156:159], v[96:103], v135
    ds_read_b128 v[152:155], v166 offset:14976
    v_exp_f32 v109, v109
    v_exp_f32 v110, v110
    v_exp_f32 v111, v111
    v_exp_f32 v112, v112
    v_exp_f32 v113, v113
    v_smfmac_f32_32x32x32_bf16 v[64:79], v[160:163], v[104:111], v135
    v_exp_f32 v114, v114
    v_exp_f32 v115, v115
    v_exp_f32 v116, v116
    v_mfma_f32_32x32x16_bf16 v[96:111], v[136:139], v[176:179], v[32:47]
    v_exp_f32 v117, v117
    v_exp_f32 v118, v118
    v_exp_f32 v119, v119
    v_exp_f32 v120, v120
    v_mfma_f32_32x32x8_bf16 v[96:111], v[146:147], v[216:217], v[96:111]
    v_exp_f32 v121, v121
    v_exp_f32 v122, v122
    v_exp_f32 v123, v123
    v_exp_f32 v124, v124
    v_smfmac_f32_32x32x32_bf16 v[80:95], v[156:159], v[112:119], v135
    s_waitcnt lgkmcnt(0)
    v_exp_f32 v125, v125
    v_exp_f32 v126, v126
    v_exp_f32 v127, v127
    v_exp_f32 v96, v96
    v_exp_f32 v97, v97
    v_smfmac_f32_32x32x32_bf16 v[80:95], v[160:163], v[120:127], v135
    ds_read_b128 v[156:159], v166 offset:15616
    v_exp_f32 v98, v98
    v_exp_f32 v99, v99
    v_exp_f32 v100, v100
    v_mfma_f32_32x32x16_bf16 v[112:127], v[136:139], v[180:183], v[48:63]
    ds_read_b128 v[136:139], v164 offset:6144
    v_exp_f32 v101, v101
    v_exp_f32 v102, v102
    v_exp_f32 v103, v103
    v_exp_f32 v104, v104
    v_mfma_f32_32x32x8_bf16 v[112:127], v[146:147], v[224:225], v[112:127]
    v_exp_f32 v105, v105
    v_exp_f32 v106, v106
    v_exp_f32 v107, v107
    v_exp_f32 v108, v108
    v_smfmac_f32_32x32x32_bf16 v[64:79], v[148:151], v[96:103], v135
    ds_read_b128 v[160:163], v166 offset:16256
    v_exp_f32 v109, v109
    v_exp_f32 v110, v110
    v_exp_f32 v111, v111
    v_exp_f32 v112, v112
    v_exp_f32 v113, v113
    v_smfmac_f32_32x32x32_bf16 v[64:79], v[152:155], v[104:111], v135
    ds_read_b32 v171, v170 offset:0
    v_exp_f32 v114, v114
    v_exp_f32 v115, v115
    v_exp_f32 v116, v116
    v_mfma_f32_32x32x16_bf16 v[96:111], v[140:143], v[176:179], v[32:47]
    v_exp_f32 v117, v117
    v_exp_f32 v118, v118
    v_exp_f32 v119, v119
    v_exp_f32 v120, v120
    v_mfma_f32_32x32x8_bf16 v[96:111], v[146:147], v[220:221], v[96:111]
    v_exp_f32 v121, v121
    v_exp_f32 v122, v122
    v_exp_f32 v123, v123
    v_exp_f32 v124, v124
    v_smfmac_f32_32x32x32_bf16 v[80:95], v[148:151], v[112:119], v135
    s_waitcnt lgkmcnt(0)
    v_exp_f32 v125, v125
    v_exp_f32 v126, v126
    v_exp_f32 v127, v127
    v_exp_f32 v96, v96
    v_exp_f32 v97, v97
    v_smfmac_f32_32x32x32_bf16 v[80:95], v[152:155], v[120:127], v135
    ds_read_b128 v[148:151], v166 offset:16896
    v_exp_f32 v98, v98
    v_exp_f32 v99, v99
    v_exp_f32 v100, v100
    v_mfma_f32_32x32x16_bf16 v[112:127], v[140:143], v[180:183], v[48:63]
    ds_read_b128 v[140:143], v164 offset:7168
    v_exp_f32 v101, v101
    v_exp_f32 v102, v102
    v_exp_f32 v103, v103
    v_exp_f32 v104, v104
    v_mfma_f32_32x32x8_bf16 v[112:127], v[146:147], v[228:229], v[112:127]
    v_exp_f32 v105, v105
    v_exp_f32 v106, v106
    v_exp_f32 v107, v107
    v_exp_f32 v108, v108
    v_smfmac_f32_32x32x32_bf16 v[64:79], v[156:159], v[96:103], v135
    ds_read_b128 v[152:155], v166 offset:17536
    v_exp_f32 v109, v109
    v_exp_f32 v110, v110
    v_exp_f32 v111, v111
    v_exp_f32 v112, v112
    v_exp_f32 v113, v113
    v_smfmac_f32_32x32x32_bf16 v[64:79], v[160:163], v[104:111], v135
    v_readfirstlane_b32 s12, v171
    v_exp_f32 v114, v114
    v_exp_f32 v115, v115
    v_exp_f32 v116, v116
    v_mfma_f32_32x32x16_bf16 v[96:111], v[136:139], v[176:179], v[32:47]
    s_cmp_lt_u32 s12, s35
    s_cbranch_scc1 L_spin5
L_spin5_ok:
    v_exp_f32 v117, v117
    v_exp_f32 v118, v118
    v_exp_f32 v119, v119
    v_exp_f32 v120, v120
    v_mfma_f32_32x32x8_bf16 v[96:111], v[146:147], v[218:219], v[96:111]
    v_exp_f32 v121, v121
    v_exp_f32 v122, v122
    v_exp_f32 v123, v123
    v_exp_f32 v124, v124
    v_smfmac_f32_32x32x32_bf16 v[80:95], v[156:159], v[112:119], v135
    s_waitcnt lgkmcnt(0)
    v_exp_f32 v125, v125
    v_exp_f32 v126, v126
    v_exp_f32 v127, v127
    v_exp_f32 v96, v96
    v_exp_f32 v97, v97
    v_smfmac_f32_32x32x32_bf16 v[80:95], v[160:163], v[120:127], v135
    ds_read_b128 v[156:159], v166 offset:18176
    v_exp_f32 v98, v98
    v_exp_f32 v99, v99
    v_exp_f32 v100, v100
    v_mfma_f32_32x32x16_bf16 v[112:127], v[136:139], v[180:183], v[48:63]
    ds_read_b128 v[136:139], v164 offset:19456
    v_exp_f32 v101, v101
    v_exp_f32 v102, v102
    v_exp_f32 v103, v103
    v_exp_f32 v104, v104
    v_mfma_f32_32x32x8_bf16 v[112:127], v[146:147], v[226:227], v[112:127]
    v_exp_f32 v105, v105
    v_exp_f32 v106, v106
    v_exp_f32 v107, v107
    v_exp_f32 v108, v108
    v_smfmac_f32_32x32x32_bf16 v[64:79], v[148:151], v[96:103], v135
    ds_read_b128 v[160:163], v166 offset:18816
    v_exp_f32 v109, v109
    v_exp_f32 v110, v110
    v_exp_f32 v111, v111
    v_exp_f32 v112, v112
    v_exp_f32 v113, v113
    v_smfmac_f32_32x32x32_bf16 v[64:79], v[152:155], v[104:111], v135
    ds_read2st64_b32 v[144:145], v165 offset0:108 offset1:109
    v_exp_f32 v114, v114
    v_exp_f32 v115, v115
    v_exp_f32 v116, v116
    v_mfma_f32_32x32x16_bf16 v[96:111], v[140:143], v[176:179], v[32:47]
    v_exp_f32 v117, v117
    v_exp_f32 v118, v118
    v_exp_f32 v119, v119
    v_exp_f32 v120, v120
    v_mfma_f32_32x32x8_bf16 v[96:111], v[146:147], v[222:223], v[96:111]
    v_exp_f32 v121, v121
    v_exp_f32 v122, v122
    v_exp_f32 v123, v123
    v_exp_f32 v124, v124
    v_smfmac_f32_32x32x32_bf16 v[80:95], v[148:151], v[112:119], v135
    s_waitcnt lgkmcnt(0)
    v_exp_f32 v125, v125
    v_exp_f32 v126, v126
    v_exp_f32 v127, v127
    v_exp_f32 v96, v96
    v_exp_f32 v97, v97
    v_smfmac_f32_32x32x32_bf16 v[80:95], v[152:155], v[120:127], v135
    ds_read_b128 v[148:151], v166 offset:28672
    v_exp_f32 v98, v98
    v_exp_f32 v99, v99
    v_exp_f32 v100, v100
    v_mfma_f32_32x32x16_bf16 v[112:127], v[140:143], v[180:183], v[48:63]
    ds_read_b128 v[140:143], v164 offset:20480
    v_exp_f32 v101, v101
    v_exp_f32 v102, v102
    v_exp_f32 v103, v103
    v_exp_f32 v104, v104
    v_mfma_f32_32x32x8_bf16 v[112:127], v[146:147], v[230:231], v[112:127]
    v_exp_f32 v105, v105
    v_exp_f32 v106, v106
    v_exp_f32 v107, v107
    v_exp_f32 v108, v108
    v_smfmac_f32_32x32x32_bf16 v[64:79], v[156:159], v[96:103], v135
    ds_read_b128 v[152:155], v166 offset:29312
    v_exp_f32 v109, v109
    v_exp_f32 v110, v110
    v_exp_f32 v111, v111
    v_exp_f32 v112, v112
    v_exp_f32 v113, v113
    v_smfmac_f32_32x32x32_bf16 v[64:79], v[160:163], v[104:111], v135
    v_exp_f32 v114, v114
    v_exp_f32 v115, v115
    v_exp_f32 v116, v116
    v_mfma_f32_32x32x16_bf16 v[96:111], v[136:139], v[176:179], v[32:47]
    v_exp_f32 v117, v117
    v_exp_f32 v118, v118
    v_exp_f32 v119, v119
    v_exp_f32 v120, v120
    v_mfma_f32_32x32x8_bf16 v[96:111], v[144:145], v[216:217], v[96:111]
    v_exp_f32 v121, v121
    v_exp_f32 v122, v122
    v_exp_f32 v123, v123
    v_exp_f32 v124, v124
    v_smfmac_f32_32x32x32_bf16 v[80:95], v[156:159], v[112:119], v135
    s_waitcnt lgkmcnt(0)
    v_exp_f32 v125, v125
    v_exp_f32 v126, v126
    v_exp_f32 v127, v127
    v_exp_f32 v96, v96
    v_exp_f32 v97, v97
    v_smfmac_f32_32x32x32_bf16 v[80:95], v[160:163], v[120:127], v135
    ds_read_b128 v[156:159], v166 offset:29952
    v_exp_f32 v98, v98
    v_exp_f32 v99, v99
    v_exp_f32 v100, v100
    v_mfma_f32_32x32x16_bf16 v[112:127], v[136:139], v[180:183], v[48:63]
    ds_read_b128 v[136:139], v164 offset:21504
    v_exp_f32 v101, v101
    v_exp_f32 v102, v102
    v_exp_f32 v103, v103
    v_exp_f32 v104, v104
    v_mfma_f32_32x32x8_bf16 v[112:127], v[144:145], v[224:225], v[112:127]
    v_exp_f32 v105, v105
    v_exp_f32 v106, v106
    v_exp_f32 v107, v107
    v_exp_f32 v108, v108
    v_smfmac_f32_32x32x32_bf16 v[64:79], v[148:151], v[96:103], v135
    ds_read_b128 v[160:163], v166 offset:30592
    v_exp_f32 v109, v109
    v_exp_f32 v110, v110
    v_exp_f32 v111, v111
    v_exp_f32 v112, v112
    v_exp_f32 v113, v113
    v_smfmac_f32_32x32x32_bf16 v[64:79], v[152:155], v[104:111], v135
    ds_read2st64_b32 v[146:147], v165 offset0:110 offset1:111
    v_exp_f32 v114, v114
    v_exp_f32 v115, v115
    v_exp_f32 v116, v116
    v_mfma_f32_32x32x16_bf16 v[96:111], v[140:143], v[176:179], v[32:47]
    v_exp_f32 v117, v117
    v_exp_f32 v118, v118
    v_exp_f32 v119, v119
    v_exp_f32 v120, v120
    v_mfma_f32_32x32x8_bf16 v[96:111], v[144:145], v[220:221], v[96:111]
    v_exp_f32 v121, v121
    v_exp_f32 v122, v122
    v_exp_f32 v123, v123
    v_exp_f32 v124, v124
    v_smfmac_f32_32x32x32_bf16 v[80:95], v[148:151], v[112:119], v135
    s_waitcnt lgkmcnt(0)
    v_exp_f32 v125, v125
    v_exp_f32 v126, v126
    v_exp_f32 v127, v127
    v_exp_f32 v96, v96
    v_exp_f32 v97, v97
    v_smfmac_f32_32x32x32_bf16 v[80:95], v[152:155], v[120:127], v135
    ds_read_b128 v[148:151], v166 offset:31232
    v_exp_f32 v98, v98
    v_exp_f32 v99, v99
    v_exp_f32 v100, v100
    v_mfma_f32_32x32x16_bf16 v[112:127], v[140:143], v[180:183], v[48:63]
    ds_read_b128 v[140:143], v164 offset:22528
    v_exp_f32 v101, v101
    v_exp_f32 v102, v102
    v_exp_f32 v103, v103
    v_exp_f32 v104, v104
    v_mfma_f32_32x32x8_bf16 v[112:127], v[144:145], v[228:229], v[112:127]
    v_exp_f32 v105, v105
    v_exp_f32 v106, v106
    v_exp_f32 v107, v107
    v_exp_f32 v108, v108
    v_smfmac_f32_32x32x32_bf16 v[64:79], v[156:159], v[96:103], v135
    ds_read_b128 v[152:155], v166 offset:31872
    v_exp_f32 v109, v109
    v_exp_f32 v110, v110
    v_exp_f32 v111, v111
    v_exp_f32 v112, v112
    v_exp_f32 v113, v113
    v_smfmac_f32_32x32x32_bf16 v[64:79], v[160:163], v[104:111], v135
    ds_write_b32 v167, v165
    v_exp_f32 v114, v114
    v_exp_f32 v115, v115
    v_exp_f32 v116, v116
    v_mfma_f32_32x32x16_bf16 v[96:111], v[136:139], v[176:179], v[32:47]
    v_exp_f32 v117, v117
    v_exp_f32 v118, v118
    v_exp_f32 v119, v119
    v_exp_f32 v120, v120
    v_mfma_f32_32x32x8_bf16 v[96:111], v[144:145], v[218:219], v[96:111]
    v_exp_f32 v121, v121
    v_exp_f32 v122, v122
    v_exp_f32 v123, v123
    v_exp_f32 v124, v124
    v_smfmac_f32_32x32x32_bf16 v[80:95], v[156:159], v[112:119], v135
    s_waitcnt lgkmcnt(0)
    v_exp_f32 v125, v125
    v_exp_f32 v126, v126
    v_exp_f32 v127, v127
    v_exp_f32 v96, v96
    v_exp_f32 v97, v97
    v_smfmac_f32_32x32x32_bf16 v[80:95], v[160:163], v[120:127], v135
    ds_read_b128 v[156:159], v166 offset:32512
    v_exp_f32 v98, v98
    v_exp_f32 v99, v99
    v_exp_f32 v100, v100
    v_mfma_f32_32x32x16_bf16 v[112:127], v[136:139], v[180:183], v[48:63]
    ds_read_b128 v[136:139], v164 offset:23552
    v_exp_f32 v101, v101
    v_exp_f32 v102, v102
    v_exp_f32 v103, v103
    v_exp_f32 v104, v104
    v_mfma_f32_32x32x8_bf16 v[112:127], v[144:145], v[226:227], v[112:127]
    v_exp_f32 v105, v105
    v_exp_f32 v106, v106
    v_exp_f32 v107, v107
    v_exp_f32 v108, v108
    v_smfmac_f32_32x32x32_bf16 v[64:79], v[148:151], v[96:103], v135
    ds_read_b128 v[160:163], v166 offset:33152
    v_exp_f32 v109, v109
    v_exp_f32 v110, v110
    v_exp_f32 v111, v111
    v_exp_f32 v112, v112
    v_exp_f32 v113, v113
    v_smfmac_f32_32x32x32_bf16 v[64:79], v[152:155], v[104:111], v135
    v_exp_f32 v114, v114
    v_exp_f32 v115, v115
    v_exp_f32 v116, v116
    v_mfma_f32_32x32x16_bf16 v[96:111], v[140:143], v[176:179], v[32:47]
    v_exp_f32 v117, v117
    v_exp_f32 v118, v118
    v_exp_f32 v119, v119
    v_exp_f32 v120, v120
    v_mfma_f32_32x32x8_bf16 v[96:111], v[144:145], v[222:223], v[96:111]
    v_exp_f32 v121, v121
    v_exp_f32 v122, v122
    v_exp_f32 v123, v123
    v_exp_f32 v124, v124
    v_smfmac_f32_32x32x32_bf16 v[80:95], v[148:151], v[112:119], v135
    s_waitcnt lgkmcnt(0)
    v_exp_f32 v125, v125
    v_exp_f32 v126, v126
    v_exp_f32 v127, v127
    v_exp_f32 v96, v96
    v_exp_f32 v97, v97
    v_smfmac_f32_32x32x32_bf16 v[80:95], v[152:155], v[120:127], v135
    ds_read_b128 v[148:151], v166 offset:33792
    v_exp_f32 v98, v98
    v_exp_f32 v99, v99
    v_exp_f32 v100, v100
    v_mfma_f32_32x32x16_bf16 v[112:127], v[140:143], v[180:183], v[48:63]
    ds_read_b128 v[140:143], v164 offset:24576
    v_exp_f32 v101, v101
    v_exp_f32 v102, v102
    v_exp_f32 v103, v103
    v_exp_f32 v104, v104
    v_mfma_f32_32x32x8_bf16 v[112:127], v[144:145], v[230:231], v[112:127]
    v_exp_f32 v105, v105
    v_exp_f32 v106, v106
    v_exp_f32 v107, v107
    v_exp_f32 v108, v108
    v_smfmac_f32_32x32x32_bf16 v[64:79], v[156:159], v[96:103], v135
    ds_read_b128 v[152:155], v166 offset:34432
    v_exp_f32 v109, v109
    v_exp_f32 v110, v110
    v_exp_f32 v111, v111
    v_exp_f32 v112, v112
    v_exp_f32 v113, v113
    v_smfmac_f32_32x32x32_bf16 v[64:79], v[160:163], v[104:111], v135
    v_exp_f32 v114, v114
    v_exp_f32 v115, v115
    v_exp_f32 v116, v116
    v_mfma_f32_32x32x16_bf16 v[96:111], v[136:139], v[176:179], v[32:47]
    v_exp_f32 v117, v117
    v_exp_f32 v118, v118
    v_exp_f32 v119, v119
    v_exp_f32 v120, v120
    v_mfma_f32_32x32x8_bf16 v[96:111], v[146:147], v[216:217], v[96:111]
    v_exp_f32 v121, v121
    v_exp_f32 v122, v122
    v_exp_f32 v123, v123
    v_exp_f32 v124, v124
    v_smfmac_f32_32x32x32_bf16 v[80:95], v[156:159], v[112:119], v135
    s_waitcnt lgkmcnt(0)
    v_exp_f32 v125, v125
    v_exp_f32 v126, v126
    v_exp_f32 v127, v127
    v_exp_f32 v96, v96
    v_exp_f32 v97, v97
    v_smfmac_f32_32x32x32_bf16 v[80:95], v[160:163], v[120:127], v135
    ds_read_b128 v[156:159], v166 offset:35072
    v_exp_f32 v98, v98
    v_exp_f32 v99, v99
    v_exp_f32 v100, v100
    v_mfma_f32_32x32x16_bf16 v[112:127], v[136:139], v[180:183], v[48:63]
    ds_read_b128 v[136:139], v164 offset:25600
    v_exp_f32 v101, v101
    v_exp_f32 v102, v102
    v_exp_f32 v103, v103
    v_exp_f32 v104, v104
    v_mfma_f32_32x32x8_bf16 v[112:127], v[146:147], v[224:225], v[112:127]
    v_exp_f32 v105, v105
    v_exp_f32 v106, v106
    v_exp_f32 v107, v107
    v_exp_f32 v108, v108
    v_smfmac_f32_32x32x32_bf16 v[64:79], v[148:151], v[96:103], v135
    ds_read_b128 v[160:163], v166 offset:35712
    v_exp_f32 v109, v109
    v_exp_f32 v110, v110
    v_exp_f32 v111, v111
    v_exp_f32 v112, v112
    v_exp_f32 v113, v113
    v_smfmac_f32_32x32x32_bf16 v[64:79], v[152:155], v[104:111], v135
    ds_read_b32 v171, v170 offset:4
    v_exp_f32 v114, v114
    v_exp_f32 v115, v115
    v_exp_f32 v116, v116
    v_mfma_f32_32x32x16_bf16 v[96:111], v[140:143], v[176:179], v[32:47]
    v_exp_f32 v117, v117
    v_exp_f32 v118, v118
    v_exp_f32 v119, v119
    v_exp_f32 v120, v120
    v_mfma_f32_32x32x8_bf16 v[96:111], v[146:147], v[220:221], v[96:111]
    v_exp_f32 v121, v121
    v_exp_f32 v122, v122
    v_exp_f32 v123, v123
    v_exp_f32 v124, v124
    v_smfmac_f32_32x32x32_bf16 v[80:95], v[148:151], v[112:119], v135
    s_waitcnt lgkmcnt(0)
    v_exp_f32 v125, v125
    v_exp_f32 v126, v126
    v_exp_f32 v127, v127
    v_exp_f32 v96, v96
    v_exp_f32 v97, v97
    v_smfmac_f32_32x32x32_bf16 v[80:95], v[152:155], v[120:127], v135
    ds_read_b128 v[148:151], v166 offset:36352
    v_exp_f32 v98, v98
    v_exp_f32 v99, v99
    v_exp_f32 v100, v100
    v_mfma_f32_32x32x16_bf16 v[112:127], v[140:143], v[180:183], v[48:63]
    ds_read_b128 v[140:143], v164 offset:26624
    v_exp_f32 v101, v101
    v_exp_f32 v102, v102
    v_exp_f32 v103, v103
    v_exp_f32 v104, v104
    v_mfma_f32_32x32x8_bf16 v[112:127], v[146:147], v[228:229], v[112:127]
    v_exp_f32 v105, v105
    v_exp_f32 v106, v106
    v_exp_f32 v107, v107
    v_exp_f32 v108, v108
    v_smfmac_f32_32x32x32_bf16 v[64:79], v[156:159], v[96:103], v135
    ds_read_b128 v[152:155], v166 offset:36992
    v_exp_f32 v109, v109
    v_exp_f32 v110, v110
    v_exp_f32 v111, v111
    v_exp_f32 v112, v112
    v_exp_f32 v113, v113
    v_smfmac_f32_32x32x32_bf16 v[64:79], v[160:163], v[104:111], v135
    v_readfirstlane_b32 s12, v171
    v_exp_f32 v114, v114
    v_exp_f32 v115, v115
    v_exp_f32 v116, v116
    v_mfma_f32_32x32x16_bf16 v[96:111], v[136:139], v[176:179], v[32:47]
    s_cmp_lt_u32 s12, s35
    s_cbranch_scc1 L_spin13
L_spin13_ok:
    v_exp_f32 v117, v117
    v_exp_f32 v118, v118
    v_exp_f32 v119, v119
    v_exp_f32 v120, v120
    v_mfma_f32_32x32x8_bf16 v[96:111], v[146:147], v[218:219], v[96:111]
    v_exp_f32 v121, v121
    v_exp_f32 v122, v122
    v_exp_f32 v123, v123
    v_exp_f32 v124, v124
    v_smfmac_f32_32x32x32_bf16 v[80:95], v[156:159], v[112:119], v135
    s_waitcnt lgkmcnt(0)
    v_exp_f32 v125, v125
    v_exp_f32 v126, v126
    v_exp_f32 v127, v127
    v_exp_f32 v96, v96
    v_exp_f32 v97, v97
    v_smfmac_f32_32x32x32_bf16 v[80:95], v[160:163], v[120:127], v135
    ds_read_b128 v[156:159], v166 offset:37632
    v_exp_f32 v98, v98
    v_exp_f32 v99, v99
    v_exp_f32 v100, v100
    v_mfma_f32_32x32x16_bf16 v[112:127], v[136:139], v[180:183], v[48:63]
    ds_read_b128 v[136:139], v164 offset:38912
    v_exp_f32 v101, v101
    v_exp_f32 v102, v102
    v_exp_f32 v103, v103
    v_exp_f32 v104, v104
    v_mfma_f32_32x32x8_bf16 v[112:127], v[146:147], v[226:227], v[112:127]
    v_exp_f32 v105, v105
    v_exp_f32 v106, v106
    v_exp_f32 v107, v107
    v_exp_f32 v108, v108
    v_smfmac_f32_32x32x32_bf16 v[64:79], v[148:151], v[96:103], v135
    ds_read_b128 v[160:163], v166 offset:38272
    v_exp_f32 v109, v109
    v_exp_f32 v110, v110
    v_exp_f32 v111, v111
    v_exp_f32 v112, v112
    v_exp_f32 v113, v113
    v_smfmac_f32_32x32x32_bf16 v[64:79], v[152:155], v[104:111], v135
    ds_read2st64_b32 v[144:145], v165 offset0:184 offset1:185
    v_exp_f32 v114, v114
    v_exp_f32 v115, v115
    v_exp_f32 v116, v116
    v_mfma_f32_32x32x16_bf16 v[96:111], v[140:143], v[176:179], v[32:47]
    s_cmp_lg_u32 s11, 3
    s_cbranch_scc1 L_nb14
    s_barrier
L_nb14:
    v_add_u32 v170, 8, v170
    v_exp_f32 v117, v117
    v_exp_f32 v118, v118
    v_exp_f32 v119, v119
    v_exp_f32 v120, v120
    v_mfma_f32_32x32x8_bf16 v[96:111], v[146:147], v[222:223], v[96:111]
    v_exp_f32 v121, v121
    v_exp_f32 v122, v122
    v_exp_f32 v123, v123
    v_exp_f32 v124, v124
    v_smfmac_f32_32x32x32_bf16 v[80:95], v[148:151], v[112:119], v135
    s_waitcnt lgkmcnt(0)
    v_exp_f32 v125, v125
    v_exp_f32 v126, v126
    v_exp_f32 v127, v127
    v_exp_f32 v96, v96
    v_exp_f32 v97, v97
    v_smfmac_f32_32x32x32_bf16 v[80:95], v[152:155], v[120:127], v135
    ds_read_b128 v[148:151], v166 offset:48128
    v_exp_f32 v98, v98
    v_exp_f32 v99, v99
    v_exp_f32 v100, v100
    v_mfma_f32_32x32x16_bf16 v[112:127], v[140:143], v[180:183], v[48:63]
    ds_read_b128 v[140:143], v164 offset:39936
    v_exp_f32 v101, v101
    v_exp_f32 v102, v102
    v_exp_f32 v103, v103
    v_exp_f32 v104, v104
    v_mfma_f32_32x32x8_bf16 v[112:127], v[146:147], v[230:231], v[112:127]
    v_exp_f32 v105, v105
    v_exp_f32 v106, v106
    v_exp_f32 v107, v107
    v_exp_f32 v108, v108
    v_smfmac_f32_32x32x32_bf16 v[64:79], v[156:159], v[96:103], v135
    ds_read_b128 v[152:155], v166 offset:48768
    v_exp_f32 v109, v109
    v_exp_f32 v110, v110
    v_exp_f32 v111, v111
    v_exp_f32 v112, v112
    v_exp_f32 v113, v113
    v_smfmac_f32_32x32x32_bf16 v[64:79], v[160:163], v[104:111], v135
    s_add_u32 s11, s11, 1
    v_exp_f32 v114, v114
    v_exp_f32 v115, v115
    v_exp_f32 v116, v116
    v_mfma_f32_32x32x16_bf16 v[96:111], v[136:139], v[176:179], v[32:47]
    s_cmp_lt_u32 s11, 4
    v_add_u32 v164, 38912, v164
    v_add_u32 v165, 38912, v165
    v_add_u32 v166, 38912, v166
    v_exp_f32 v117, v117
    v_exp_f32 v118, v118
    v_exp_f32 v119, v119
    v_exp_f32 v120, v120
    v_mfma_f32_32x32x8_bf16 v[96:111], v[144:145], v[216:217], v[96:111]
    v_exp_f32 v121, v121
    v_exp_f32 v122, v122
    v_exp_f32 v123, v123
    v_exp_f32 v124, v124
    v_smfmac_f32_32x32x32_bf16 v[80:95], v[156:159], v[112:119], v135
    s_waitcnt lgkmcnt(0)
    v_exp_f32 v125, v125
    v_exp_f32 v126, v126
    v_exp_f32 v127, v127
    s_cbranch_scc1 L_loop
    v_mov_b32 v164, 160768
    v_smfmac_f32_32x32x32_bf16 v[80:95], v[160:163], v[120:127], v135
    ds_read_b96 v[172:174], v164
    s_cmp_eq_u32 s44, 0
    s_cbranch_scc1 L_nox
    v_sub_u32 v165, v23, v22
    v_add_u32 v165, 162688, v165
    ds_read_b128 v[136:139], v165
    v_mov_b32 v164, 162732
    ds_read_b32 v144, v164
    ds_read_u16 v148, v17
    v_mov_b32 v145, 0
    v_mov_b32 v149, 0
    v_mov_b32 v129, 0
    v_mov_b32 v131, 0
    s_waitcnt lgkmcnt(1)
    v_mfma_f32_32x32x16_bf16 v[96:111], v[136:139], v[176:179], v[32:47]
    v_mfma_f32_32x32x16_bf16 v[112:127], v[136:139], v[180:183], v[48:63]
    s_nop 7
    s_nop 1
    v_mfma_f32_32x32x8_bf16 v[96:111], v[144:145], v[216:217], v[96:111]
    v_mfma_f32_32x32x8_bf16 v[112:127], v[144:145], v[224:225], v[112:127]
    s_nop 10
    v_exp_f32 v96, v96
    v_exp_f32 v112, v112
    s_waitcnt lgkmcnt(0)
    v_cvt_pk_bf16_f32 v128, v96, v96
    v_cvt_pk_bf16_f32 v130, v112, v112
    s_nop 0
    v_mfma_f32_32x32x8_bf16 v[64:79], v[148:149], v[128:129], v[64:79]
    v_mfma_f32_32x32x8_bf16 v[80:95], v[148:149], v[130:131], v[80:95]
L_nox:
    s_waitcnt lgkmcnt(0)
    v_readfirstlane_b32 s31, v174
    v_readfirstlane_b32 s33, v172
    v_readfirstlane_b32 s10, v173
    s_not_b32 s31, s31
    s_and_b32 s31, s31, 0xffff
    v_and_b32 v8, 31, v1
    s_sub_u32 s24, s31, s34
    s_nop 2
    v_mov_b32 v128, v74
    v_mov_b32 v129, v74
    s_nop 1
    v_permlane32_swap_b32 v128, v129
    v_mov_b32 v130, v90
    v_mov_b32 v131, v90
    s_nop 1
    v_permlane32_swap_b32 v130, v131
    v_cmp_ne_u32 s[46:47], s24, v8
    v_min_f32 v129, v128, v130
    v_max_f32 v131, v128, v130
    v_cmp_le_f32 vcc, 0x17800000, v129
    s_mov_b32 s14, 0x5d800000
    v_cmp_ge_f32 s[12:13], s14, v131
    s_and_b64 vcc, vcc, s[12:13]
    s_cmp_eq_u64 vcc, -1
    s_cbranch_scc0 L_slow
L_fin:
    v_rcp_f32 v128, v128
    v_rcp_f32 v130, v130
    s_mul_i32 s24, s7, 1016
    s_sub_u32 s24, 2048, s24
    v_add_u32 v8, s24, v5
    v_pk_mul_f32 v[64:65], v[64:65], v[128:129] op_sel_hi:[1,0]
    v_pk_mul_f32 v[66:67], v[66:67], v[128:129] op_sel_hi:[1,0]
    v_pk_mul_f32 v[68:69], v[68:69], v[128:129] op_sel_hi:[1,0]
    v_pk_mul_f32 v[70:71], v[70:71], v[128:129] op_sel_hi:[1,0]
    v_pk_mul_f32 v[72:73], v[72:73], v[128:129] op_sel_hi:[1,0]
    v_cvt_pk_bf16_f32 v32, v64, v65
    v_cvt_pk_bf16_f32 v33, v66, v67
    v_cvt_pk_bf16_f32 v34, v68, v69
    v_cvt_pk_bf16_f32 v35, v70, v71
    v_cvt_pk_bf16_f32 v40, v72, v73
    v_pk_mul_f32 v[80:81], v[80:81], v[130:131] op_sel_hi:[1,0]
    v_pk_mul_f32 v[82:83], v[82:83], v[130:131] op_sel_hi:[1,0]
    v_pk_mul_f32 v[84:85], v[84:85], v[130:131] op_sel_hi:[1,0]
    v_pk_mul_f32 v[86:87], v[86:87], v[130:131] op_sel_hi:[1,0]
    v_pk_mul_f32 v[88:89], v[88:89], v[130:131] op_sel_hi:[1,0]
    v_cvt_pk_bf16_f32 v36, v80, v81
    v_cvt_pk_bf16_f32 v37, v82, v83
    v_cvt_pk_bf16_f32 v38, v84, v85
    v_cvt_pk_bf16_f32 v39, v86, v87
    v_cvt_pk_bf16_f32 v41, v88, v89
    s_mov_b64 exec, s[46:47]
    s_cmp_eq_u32 s10, 1
    s_cbranch_scc0 L_oslow
    global_store_dwordx4 v5, v[32:35], s[18:19]
    global_store_dwordx4 v5, v[36:39], s[18:19] offset:512
    s_mov_b32 exec_hi, 0
    global_store_dwordx2 v8, v[40:41], s[18:19]
L_odone:
    s_mov_b64 exec, -1
    s_lshr_b32 s24, s31, 4
    s_cmp_eq_u32 s24, s38
    s_cbranch_scc1 L_resld
L_resldd:
    v_add_u32 v9, s56, v6
    global_load_dwordx4 v[24:27], v9, s[54:55] sc1
    ds_read_b128 v[96:99], v6 offset:0
    ds_read_b128 v[100:103], v6 offset:1024
    ds_read_b128 v[104:107], v6 offset:2048
    s_add_u32 s12, s56, 1024
    s_sub_u32 s13, s12, 18432
    s_min_u32 s12, s12, s13
    v_add_u32 v10, s12, v6
    global_load_dwordx4 v[28:31], v10, s[54:55] sc1
    ds_read_b128 v[108:111], v6 offset:3072
    ds_read_b128 v[112:115], v6 offset:4096
    ds_read_b128 v[116:119], v6 offset:5120
    s_add_u32 s12, s56, 2048
    s_sub_u32 s13, s12, 18432
    s_min_u32 s12, s12, s13
    v_add_u32 v9, s12, v6
    global_load_dwordx4 v[32:35], v9, s[54:55] sc1
    ds_read_b128 v[120:123], v6 offset:6144
    ds_read_b128 v[124:127], v6 offset:7168
    ds_read_b128 v[128:131], v6 offset:8192
    s_add_u32 s12, s56, 3072
    s_sub_u32 s13, s12, 18432
    s_min_u32 s12, s12, s13
    v_add_u32 v10, s12, v6
    global_load_dwordx4 v[36:39], v10, s[54:55] sc1
    ds_read_b128 v[132:135], v6 offset:9216
    ds_read_b128 v[136:139], v6 offset:10240
    ds_read_b128 v[140:143], v6 offset:11264
    s_add_u32 s12, s56, 4096
    s_sub_u32 s13, s12, 18432
    s_min_u32 s12, s12, s13
    v_add_u32 v9, s12, v6
    global_load_dwordx4 v[40:43], v9, s[54:55] sc1
    ds_read_b128 v[144:147], v6 offset:12288
    ds_read_b128 v[148:151], v6 offset:13312
    ds_read_b128 v[152:155], v6 offset:14336
    s_add_u32 s12, s56, 5120
    s_sub_u32 s13, s12, 18432
    s_min_u32 s12, s12, s13
    v_add_u32 v10, s12, v6
    global_load_dwordx4 v[44:47], v10, s[54:55] sc1
    ds_read_b128 v[156:159], v6 offset:15360
    ds_read_b128 v[160:163], v6 offset:16384
    ds_read_b128 v[164:167], v6 offset:17408
    s_add_u32 s12, s56, 6144
    s_sub_u32 s13, s12, 18432
    s_min_u32 s12, s12, s13
    v_add_u32 v9, s12, v6
    global_load_dwordx4 v[48:51], v9, s[54:55] sc1
    ds_read_b128 v[168:171], v6 offset:18432
    ds_read_b128 v[172:175], v6 offset:19456
    ds_read_b128 v[176:179], v6 offset:20480
    s_add_u32 s12, s56, 7168
    s_sub_u32 s13, s12, 18432
    s_min_u32 s12, s12, s13
    v_add_u32 v10, s12, v6
    global_load_dwordx4 v[52:55], v10, s[54:55] sc1
    ds_read_b128 v[180:183], v6 offset:21504
    ds_read_b128 v[184:187], v6 offset:22528
    ds_read_b128 v[188:191], v6 offset:23552
    ds_read_b128 v[192:195], v6 offset:24576
    s_mov_b32 s40, 30000
    s_cmp_eq_u32 s44, 0
    s_waitcnt lgkmcnt(0)
    s_barrier
    s_cbranch_scc1 L_resok
    v_lshlrev_b32 v216, 16, v236
    v_and_b32 v217, 0xffff0000, v236
    v_lshlrev_b32 v218, 16, v196
    v_and_b32 v219, 0xffff0000, v196
    v_pk_add_f32 v[216:217], v[216:217], v[218:219]
    v_cvt_pk_bf16_f32 v236, v216, v217
    v_lshlrev_b32 v216, 16, v237
    v_and_b32 v217, 0xffff0000, v237
    v_lshlrev_b32 v218, 16, v197
    v_and_b32 v219, 0xffff0000, v197
    v_pk_add_f32 v[216:217], v[216:217], v[218:219]
    v_cvt_pk_bf16_f32 v237, v216, v217
    v_lshlrev_b32 v216, 16, v238
    v_and_b32 v217, 0xffff0000, v238
    v_lshlrev_b32 v218, 16, v198
    v_and_b32 v219, 0xffff0000, v198
    v_pk_add_f32 v[216:217], v[216:217], v[218:219]
    v_cvt_pk_bf16_f32 v238, v216, v217
    v_lshlrev_b32 v216, 16, v239
    v_and_b32 v217, 0xffff0000, v239
    v_lshlrev_b32 v218, 16, v199
    v_and_b32 v219, 0xffff0000, v199
    v_pk_add_f32 v[216:217], v[216:217], v[218:219]
    v_cvt_pk_bf16_f32 v239, v216, v217
    v_lshlrev_b32 v216, 16, v240
    v_and_b32 v217, 0xffff0000, v240
    v_lshlrev_b32 v218, 16, v200
    v_and_b32 v219, 0xffff0000, v200
    v_pk_add_f32 v[216:217], v[216:217], v[218:219]
    v_cvt_pk_bf16_f32 v240, v216, v217
    v_lshlrev_b32 v216, 16, v241
    v_and_b32 v217, 0xffff0000, v241
    v_lshlrev_b32 v218, 16, v201
    v_and_b32 v219, 0xffff0000, v201
    v_pk_add_f32 v[216:217], v[216:217], v[218:219]
    v_cvt_pk_bf16_f32 v241, v216, v217
    v_lshlrev_b32 v216, 16, v242
    v_and_b32 v217, 0xffff0000, v242
    v_lshlrev_b32 v218, 16, v202
    v_and_b32 v219, 0xffff0000, v202
    v_pk_add_f32 v[216:217], v[216:217], v[218:219]
    v_cvt_pk_bf16_f32 v242, v216, v217
    v_lshlrev_b32 v216, 16, v243
    v_and_b32 v217, 0xffff0000, v243
    v_lshlrev_b32 v218, 16, v203
    v_and_b32 v219, 0xffff0000, v203
    v_pk_add_f32 v[216:217], v[216:217], v[218:219]
    v_cvt_pk_bf16_f32 v243, v216, v217
    v_lshlrev_b32 v216, 16, v244
    v_and_b32 v217, 0xffff0000, v244
    v_lshlrev_b32 v218, 16, v204
    v_and_b32 v219, 0xffff0000, v204
    v_pk_add_f32 v[216:217], v[216:217], v[218:219]
    v_cvt_pk_bf16_f32 v244, v216, v217
    v_lshlrev_b32 v216, 16, v245
    v_and_b32 v217, 0xffff0000, v245
    v_lshlrev_b32 v218, 16, v205
    v_and_b32 v219, 0xffff0000, v205
    v_pk_add_f32 v[216:217], v[216:217], v[218:219]
    v_cvt_pk_bf16_f32 v245, v216, v217
    s_lshr_b32 s24, s31, 4
    s_cmp_eq_u32 s24, s38
    s_cbranch_scc1 L_resfix
L_resok:
    v_lshlrev_b32 v216, 16, v236
    v_and_b32 v217, 0xffff0000, v236
    v_lshlrev_b32 v218, 16, v237
    v_and_b32 v219, 0xffff0000, v237
    v_lshlrev_b32 v220, 16, v238
    v_and_b32 v221, 0xffff0000, v238
    v_lshlrev_b32 v222, 16, v239
    v_and_b32 v223, 0xffff0000, v239
    v_lshlrev_b32 v224, 16, v240
    v_and_b32 v225, 0xffff0000, v240
    v_lshlrev_b32 v226, 16, v241
    v_and_b32 v227, 0xffff0000, v241
    v_lshlrev_b32 v228, 16, v242
    v_and_b32 v229, 0xffff0000, v242
    v_lshlrev_b32 v230, 16, v243
    v_and_b32 v231, 0xffff0000, v243
    v_lshlrev_b32 v232, 16, v244
    v_and_b32 v233, 0xffff0000, v244
    v_lshlrev_b32 v234, 16, v245
    v_and_b32 v235, 0xffff0000, v245
    s_mov_b32 s24, 0x22222222
    s_mov_b32 s25, s24
    s_mov_b32 s26, 0x44444444
    s_mov_b32 s27, s26
    s_mov_b32 s28, 0x88888888
    s_mov_b32 s29, s28
    s_mov_b32 s48, s44
    s_waitcnt vmcnt(7)
    v_max3_u32 v11, v24, v25, v26
    v_max_u32 v11, v27, v11
    v_cmp_eq_u32 vcc, -1, v11
    s_cbranch_vccnz L_rl0
L_rb0:
    v_mfma_f32_16x16x32_bf16 v[216:219], v[96:99], v[24:27], v[216:219]
    ds_read_b128 v[96:99], v6 offset:25600
    s_add_u32 s12, s56, 8192
    s_sub_u32 s13, s12, 18432
    s_min_u32 s12, s12, s13
    v_add_u32 v9, s12, v6
    global_load_dwordx4 v[56:59], v9, s[54:55] sc1
    v_mfma_f32_16x16x32_bf16 v[220:223], v[100:103], v[24:27], v[220:223]
    ds_read_b128 v[100:103], v6 offset:26624
    v_mfma_f32_16x16x32_bf16 v[224:227], v[104:107], v[24:27], v[224:227]
    ds_read_b128 v[104:107], v6 offset:27648
    s_waitcnt vmcnt(7)
    v_max3_u32 v11, v28, v29, v30
    v_mfma_f32_16x16x32_bf16 v[228:231], v[108:111], v[24:27], v[228:231]
    ds_read_b128 v[108:111], v6 offset:28672
    v_max_u32 v11, v31, v11
    v_cmp_eq_u32 vcc, -1, v11
    v_mfma_f32_16x16x32_bf16 v[232:235], v[112:115], v[24:27], v[232:235]
    ds_read_b128 v[112:115], v6 offset:29696
    s_cbranch_vccnz L_rl1
L_rb1:
    v_mfma_f32_16x16x32_bf16 v[216:219], v[116:119], v[28:31], v[216:219]
    ds_read_b128 v[116:119], v6 offset:30720
    s_add_u32 s12, s56, 9216
    s_sub_u32 s13, s12, 18432
    s_min_u32 s12, s12, s13
    v_add_u32 v10, s12, v6
    global_load_dwordx4 v[60:63], v10, s[54:55] sc1
    v_mfma_f32_16x16x32_bf16 v[220:223], v[120:123], v[28:31], v[220:223]
    ds_read_b128 v[120:123], v6 offset:31744
    v_mfma_f32_16x16x32_bf16 v[224:227], v[124:127], v[28:31], v[224:227]
    ds_read_b128 v[124:127], v6 offset:32768
    s_waitcnt vmcnt(7)
    v_max3_u32 v11, v32, v33, v34
    v_mfma_f32_16x16x32_bf16 v[228:231], v[128:131], v[28:31], v[228:231]
    ds_read_b128 v[128:131], v6 offset:33792
    v_max_u32 v11, v35, v11
    v_cmp_eq_u32 vcc, -1, v11
    v_mfma_f32_16x16x32_bf16 v[232:235], v[132:135], v[28:31], v[232:235]
    ds_read_b128 v[132:135], v6 offset:34816
    s_cbranch_vccnz L_rl2
L_rb2:
    v_mfma_f32_16x16x32_bf16 v[216:219], v[136:139], v[32:35], v[216:219]
    ds_read_b128 v[136:139], v6 offset:35840
    s_add_u32 s12, s56, 10240
    s_sub_u32 s13, s12, 18432
    s_min_u32 s12, s12, s13
    v_add_u32 v9, s12, v6
    global_load_dwordx4 v[64:67], v9, s[54:55] sc1
    v_mfma_f32_16x16x32_bf16 v[220:223], v[140:143], v[32:35], v[220:223]
    ds_read_b128 v[140:143], v6 offset:36864
    v_mfma_f32_16x16x32_bf16 v[224:227], v[144:147], v[32:35], v[224:227]
    ds_read_b128 v[144:147], v6 offset:37888
    s_waitcnt vmcnt(7)
    v_max3_u32 v11, v36, v37, v38
    v_mfma_f32_16x16x32_bf16 v[228:231], v[148:151], v[32:35], v[228:231]
    ds_read_b128 v[148:151], v6 offset:38912
    v_max_u32 v11, v39, v11
    v_cmp_eq_u32 vcc, -1, v11
    v_mfma_f32_16x16x32_bf16 v[232:235], v[152:155], v[32:35], v[232:235]
    ds_read_b128 v[152:155], v6 offset:39936
    s_cbranch_vccnz L_rl3
L_rb3:
    v_mfma_f32_16x16x32_bf16 v[216:219], v[156:159], v[36:39], v[216:219]
    ds_read_b128 v[156:159], v6 offset:40960
    s_add_u32 s12, s56, 11264
    s_sub_u32 s13, s12, 18432
    s_min_u32 s12, s12, s13
    v_add_u32 v10, s12, v6
    global_load_dwordx4 v[68:71], v10, s[54:55] sc1
    v_mfma_f32_16x16x32_bf16 v[220:223], v[160:163], v[36:39], v[220:223]
    ds_read_b128 v[160:163], v6 offset:41984
    v_mfma_f32_16x16x32_bf16 v[224:227], v[164:167], v[36:39], v[224:227]
    ds_read_b128 v[164:167], v6 offset:43008
    s_waitcnt vmcnt(7)
    v_max3_u32 v11, v40, v41, v42
    v_mfma_f32_16x16x32_bf16 v[228:231], v[168:171], v[36:39], v[228:231]
    ds_read_b128 v[168:171], v6 offset:44032
    v_max_u32 v11, v43, v11
    v_cmp_eq_u32 vcc, -1, v11
    v_mfma_f32_16x16x32_bf16 v[232:235], v[172:175], v[36:39], v[232:235]
    ds_read_b128 v[172:175], v6 offset:45056
    s_cbranch_vccnz L_rl4
L_rb4:
    v_mfma_f32_16x16x32_bf16 v[216:219], v[176:179], v[40:43], v[216:219]
    ds_read_b128 v[176:179], v4 offset:0
    s_add_u32 s12, s56, 12288
    s_sub_u32 s13, s12, 18432
    s_min_u32 s12, s12, s13
    v_add_u32 v9, s12, v6
    global_load_dwordx4 v[72:75], v9, s[54:55] sc1
    v_mfma_f32_16x16x32_bf16 v[220:223], v[180:183], v[40:43], v[220:223]
    ds_read_b128 v[180:183], v4 offset:1024
    v_mfma_f32_16x16x32_bf16 v[224:227], v[184:187], v[40:43], v[224:227]
    ds_read_b128 v[184:187], v4 offset:2048
    s_waitcnt vmcnt(7)
    v_max3_u32 v11, v44, v45, v46
    v_mfma_f32_16x16x32_bf16 v[228:231], v[188:191], v[40:43], v[228:231]
    ds_read_b128 v[188:191], v4 offset:3072
    v_max_u32 v11, v47, v11
    v_cmp_eq_u32 vcc, -1, v11
    v_mfma_f32_16x16x32_bf16 v[232:235], v[192:195], v[40:43], v[232:235]
    ds_read_b128 v[192:195], v4 offset:4096
    s_cbranch_vccnz L_rl5
L_rb5:
    s_waitcnt lgkmcnt(15)
    v_mfma_f32_16x16x32_bf16 v[216:219], v[96:99], v[44:47], v[216:219]
    ds_read_b128 v[96:99], v4 offset:5120
    s_add_u32 s12, s56, 13312
    s_sub_u32 s13, s12, 18432
    s_min_u32 s12, s12, s13
    v_add_u32 v10, s12, v6
    global_load_dwordx4 v[76:79], v10, s[54:55] sc1
    v_mfma_f32_16x16x32_bf16 v[220:223], v[100:103], v[44:47], v[220:223]
    ds_read_b128 v[100:103], v4 offset:6144
    v_mfma_f32_16x16x32_bf16 v[224:227], v[104:107], v[44:47], v[224:227]
    ds_read_b128 v[104:107], v4 offset:7168
    s_waitcnt vmcnt(7)
    v_max3_u32 v11, v48, v49, v50
    v_mfma_f32_16x16x32_bf16 v[228:231], v[108:111], v[44:47], v[228:231]
    ds_read_b128 v[108:111], v4 offset:8192
    v_max_u32 v11, v51, v11
    v_cmp_eq_u32 vcc, -1, v11
    v_mfma_f32_16x16x32_bf16 v[232:235], v[112:115], v[44:47], v[232:235]
    ds_read_b128 v[112:115], v4 offset:9216
    s_cbranch_vccnz L_rl6
L_rb6:
    s_waitcnt lgkmcnt(15)
    v_mfma_f32_16x16x32_bf16 v[216:219], v[116:119], v[48:51], v[216:219]
    ds_read_b128 v[116:119], v4 offset:10240
    s_add_u32 s12, s56, 14336
    s_sub_u32 s13, s12, 18432
    s_min_u32 s12, s12, s13
    v_add_u32 v9, s12, v6
    global_load_dwordx4 v[80:83], v9, s[54:55] sc1
    v_mfma_f32_16x16x32_bf16 v[220:223], v[120:123], v[48:51], v[220:223]
    ds_read_b128 v[120:123], v4 offset:11264
    v_mfma_f32_16x16x32_bf16 v[224:227], v[124:127], v[48:51], v[224:227]
    ds_read_b128 v[124:127], v4 offset:12288
    s_waitcnt vmcnt(7)
    v_max3_u32 v11, v52, v53, v54
    v_mfma_f32_16x16x32_bf16 v[228:231], v[128:131], v[48:51], v[228:231]
    ds_read_b128 v[128:131], v4 offset:13312
    v_max_u32 v11, v55, v11
    v_cmp_eq_u32 vcc, -1, v11
    v_mfma_f32_16x16x32_bf16 v[232:235], v[132:135], v[48:51], v[232:235]
    ds_read_b128 v[132:135], v4 offset:14336
    s_cbranch_vccnz L_rl7
L_rb7:
    s_waitcnt lgkmcnt(15)
    v_mfma_f32_16x16x32_bf16 v[216:219], v[136:139], v[52:55], v[216:219]
    ds_read_b128 v[136:139], v4 offset:15360
    s_add_u32 s12, s56, 15360
    s_sub_u32 s13, s12, 18432
    s_min_u32 s12, s12, s13
    v_add_u32 v10, s12, v6
    global_load_dwordx4 v[84:87], v10, s[54:55] sc1
    v_mfma_f32_16x16x32_bf16 v[220:223], v[140:143], v[52:55], v[220:223]
    ds_read_b128 v[140:143], v4 offset:16384
    v_mfma_f32_16x16x32_bf16 v[224:227], v[144:147], v[52:55], v[224:227]
    ds_read_b128 v[144:147], v4 offset:17408
    s_waitcnt vmcnt(7)
    v_max3_u32 v11, v56, v57, v58
    v_mfma_f32_16x16x32_bf16 v[228:231], v[148:151], v[52:55], v[228:231]
    ds_read_b128 v[148:151], v4 offset:18432
    v_max_u32 v11, v59, v11
    v_cmp_eq_u32 vcc, -1, v11
    v_mfma_f32_16x16x32_bf16 v[232:235], v[152:155], v[52:55], v[232:235]
    ds_read_b128 v[152:155], v4 offset:19456
    s_cbranch_vccnz L_rl8
L_rb8:
    s_waitcnt lgkmcnt(15)
    v_mfma_f32_16x16x32_bf16 v[216:219], v[156:159], v[56:59], v[216:219]
    ds_read_b128 v[156:159], v4 offset:20480
    s_add_u32 s12, s56, 16384
    s_sub_u32 s13, s12, 18432
    s_min_u32 s12, s12, s13
    v_add_u32 v9, s12, v6
    global_load_dwordx4 v[88:91], v9, s[54:55] sc1
    v_mfma_f32_16x16x32_bf16 v[220:223], v[160:163], v[56:59], v[220:223]
    ds_read_b128 v[160:163], v4 offset:21504
    v_mfma_f32_16x16x32_bf16 v[224:227], v[164:167], v[56:59], v[224:227]
    ds_read_b128 v[164:167], v4 offset:22528
    s_waitcnt vmcnt(7)
    v_max3_u32 v11, v60, v61, v62
    v_mfma_f32_16x16x32_bf16 v[228:231], v[168:171], v[56:59], v[228:231]
    ds_read_b128 v[168:171], v4 offset:23552
    v_max_u32 v11, v63, v11
    v_cmp_eq_u32 vcc, -1, v11
    v_mfma_f32_16x16x32_bf16 v[232:235], v[172:175], v[56:59], v[232:235]
    ds_read_b128 v[172:175], v4 offset:24576
    s_cbranch_vccnz L_rl9
L_rb9:
    s_waitcnt lgkmcnt(15)
    v_mfma_f32_16x16x32_bf16 v[216:219], v[176:179], v[60:63], v[216:219]
    ds_read_b128 v[176:179], v4 offset:25600
    s_add_u32 s12, s56, 17408
    s_sub_u32 s13, s12, 18432
    s_min_u32 s12, s12, s13
    v_add_u32 v10, s12, v6
    global_load_dwordx4 v[92:95], v10, s[54:55] sc1
    v_mfma_f32_16x16x32_bf16 v[220:223], v[180:183], v[60:63], v[220:223]
    ds_read_b128 v[180:183], v4 offset:26624
    v_mfma_f32_16x16x32_bf16 v[224:227], v[184:187], v[60:63], v[224:227]
    ds_read_b128 v[184:187], v4 offset:27648
    s_waitcnt vmcnt(7)
    v_max3_u32 v11, v64, v65, v66
    v_mfma_f32_16x16x32_bf16 v[228:231], v[188:191], v[60:63], v[228:231]
    ds_read_b128 v[188:191], v4 offset:28672
    v_max_u32 v11, v67, v11
    v_cmp_eq_u32 vcc, -1, v11
    v_mfma_f32_16x16x32_bf16 v[232:235], v[192:195], v[60:63], v[232:235]
    ds_read_b128 v[192:195], v4 offset:29696
    s_cbranch_vccnz L_rl10
L_rb10:
    s_waitcnt lgkmcnt(15)
    v_mfma_f32_16x16x32_bf16 v[216:219], v[96:99], v[64:67], v[216:219]
    ds_read_b128 v[96:99], v4 offset:30720
    v_mfma_f32_16x16x32_bf16 v[220:223], v[100:103], v[64:67], v[220:223]
    ds_read_b128 v[100:103], v4 offset:31744
    v_mfma_f32_16x16x32_bf16 v[224:227], v[104:107], v[64:67], v[224:227]
    ds_read_b128 v[104:107], v4 offset:32768
    s_waitcnt vmcnt(6)
    v_max3_u32 v11, v68, v69, v70
    v_mfma_f32_16x16x32_bf16 v[228:231], v[108:111], v[64:67], v[228:231]
    ds_read_b128 v[108:111], v4 offset:33792
    v_max_u32 v11, v71, v11
    v_cmp_eq_u32 vcc, -1, v11
    v_mfma_f32_16x16x32_bf16 v[232:235], v[112:115], v[64:67], v[232:235]
    ds_read_b128 v[112:115], v4 offset:34816
    s_cbranch_vccnz L_rl11
L_rb11:
    s_waitcnt lgkmcnt(15)
    v_mfma_f32_16x16x32_bf16 v[216:219], v[116:119], v[68:71], v[216:219]
    ds_read_b128 v[116:119], v4 offset:35840
    v_mfma_f32_16x16x32_bf16 v[220:223], v[120:123], v[68:71], v[220:223]
    ds_read_b128 v[120:123], v4 offset:36864
    v_mfma_f32_16x16x32_bf16 v[224:227], v[124:127], v[68:71], v[224:227]
    ds_read_b128 v[124:127], v4 offset:37888
    s_waitcnt vmcnt(5)
    v_max3_u32 v11, v72, v73, v74
    v_mfma_f32_16x16x32_bf16 v[228:231], v[128:131], v[68:71], v[228:231]
    ds_read_b128 v[128:131], v4 offset:38912
    v_max_u32 v11, v75, v11
    v_cmp_eq_u32 vcc, -1, v11
    v_mfma_f32_16x16x32_bf16 v[232:235], v[132:135], v[68:71], v[232:235]
    ds_read_b128 v[132:135], v4 offset:39936
    s_cbranch_vccnz L_rl12
L_rb12:
    s_waitcnt lgkmcnt(15)
    v_mfma_f32_16x16x32_bf16 v[216:219], v[136:139], v[72:75], v[216:219]
    ds_read_b128 v[136:139], v4 offset:40960
    v_mfma_f32_16x16x32_bf16 v[220:223], v[140:143], v[72:75], v[220:223]
    ds_read_b128 v[140:143], v4 offset:41984
    v_mfma_f32_16x16x32_bf16 v[224:227], v[144:147], v[72:75], v[224:227]
    ds_read_b128 v[144:147], v4 offset:43008
    s_waitcnt vmcnt(4)
    v_max3_u32 v11, v76, v77, v78
    v_mfma_f32_16x16x32_bf16 v[228:231], v[148:151], v[72:75], v[228:231]
    ds_read_b128 v[148:151], v4 offset:44032
    v_max_u32 v11, v79, v11
    v_cmp_eq_u32 vcc, -1, v11
    v_mfma_f32_16x16x32_bf16 v[232:235], v[152:155], v[72:75], v[232:235]
    ds_read_b128 v[152:155], v4 offset:45056
    s_cbranch_vccnz L_rl13
L_rb13:
    s_barrier
    s_waitcnt lgkmcnt(15)
    v_mfma_f32_16x16x32_bf16 v[216:219], v[156:159], v[76:79], v[216:219]
    ds_read_b128 v[156:159], v4 offset:46080
    v_mfma_f32_16x16x32_bf16 v[220:223], v[160:163], v[76:79], v[220:223]
    ds_read_b128 v[160:163], v4 offset:47104
    v_mfma_f32_16x16x32_bf16 v[224:227], v[164:167], v[76:79], v[224:227]
    ds_read_b128 v[164:167], v4 offset:48128
    s_waitcnt vmcnt(3)
    v_max3_u32 v11, v80, v81, v82
    v_mfma_f32_16x16x32_bf16 v[228:231], v[168:171], v[76:79], v[228:231]
    ds_read_b128 v[168:171], v4 offset:49152
    v_max_u32 v11, v83, v11
    v_cmp_eq_u32 vcc, -1, v11
    v_mfma_f32_16x16x32_bf16 v[232:235], v[172:175], v[76:79], v[232:235]
    ds_read_b128 v[172:175], v4 offset:50176
    s_cbranch_vccnz L_rl14
L_rb14:
    s_waitcnt lgkmcnt(15)
    v_mfma_f32_16x16x32_bf16 v[216:219], v[176:179], v[80:83], v[216:219]
    ds_read_b128 v[176:179], v4 offset:51200
    v_mfma_f32_16x16x32_bf16 v[220:223], v[180:183], v[80:83], v[220:223]
    ds_read_b128 v[180:183], v4 offset:52224
    v_mfma_f32_16x16x32_bf16 v[224:227], v[184:187], v[80:83], v[224:227]
    ds_read_b128 v[184:187], v4 offset:53248
    s_waitcnt vmcnt(2)
    v_max3_u32 v11, v84, v85, v86
    v_mfma_f32_16x16x32_bf16 v[228:231], v[188:191], v[80:83], v[228:231]
    ds_read_b128 v[188:191], v4 offset:54272
    v_max_u32 v11, v87, v11
    v_cmp_eq_u32 vcc, -1, v11
    v_mfma_f32_16x16x32_bf16 v[232:235], v[192:195], v[80:83], v[232:235]
    ds_read_b128 v[192:195], v4 offset:55296
    s_cbranch_vccnz L_rl15
L_rb15:
    s_waitcnt lgkmcnt(15)
    v_mfma_f32_16x16x32_bf16 v[216:219], v[96:99], v[84:87], v[216:219]
    ds_read_b128 v[96:99], v4 offset:56320
    v_mfma_f32_16x16x32_bf16 v[220:223], v[100:103], v[84:87], v[220:223]
    ds_read_b128 v[100:103], v4 offset:57344
    v_mfma_f32_16x16x32_bf16 v[224:227], v[104:107], v[84:87], v[224:227]
    ds_read_b128 v[104:107], v4 offset:58368
    s_waitcnt vmcnt(1)
    v_max3_u32 v11, v88, v89, v90
    v_mfma_f32_16x16x32_bf16 v[228:231], v[108:111], v[84:87], v[228:231]
    ds_read_b128 v[108:111], v4 offset:59392
    v_max_u32 v11, v91, v11
    v_cmp_eq_u32 vcc, -1, v11
    v_mfma_f32_16x16x32_bf16 v[232:235], v[112:115], v[84:87], v[232:235]
    ds_read_b128 v[112:115], v4 offset:60416
    s_cbranch_vccnz L_rl16
L_rb16:
    s_waitcnt lgkmcnt(15)
    v_mfma_f32_16x16x32_bf16 v[216:219], v[116:119], v[88:91], v[216:219]
    ds_read_b128 v[116:119], v7 offset:0
    v_mfma_f32_16x16x32_bf16 v[220:223], v[120:123], v[88:91], v[220:223]
    ds_read_b128 v[120:123], v7 offset:1024
    v_mfma_f32_16x16x32_bf16 v[224:227], v[124:127], v[88:91], v[224:227]
    ds_read_b128 v[124:127], v7 offset:2048
    s_waitcnt vmcnt(0)
    v_max3_u32 v11, v92, v93, v94
    v_mfma_f32_16x16x32_bf16 v[228:231], v[128:131], v[88:91], v[228:231]
    ds_read_b128 v[128:131], v7 offset:3072
    v_max_u32 v11, v95, v11
    v_cmp_eq_u32 vcc, -1, v11
    v_mfma_f32_16x16x32_bf16 v[232:235], v[132:135], v[88:91], v[232:235]
    ds_read_b128 v[132:135], v7 offset:4096
    s_cbranch_vccnz L_rl17
L_rb17:
    s_waitcnt lgkmcnt(15)
    v_mfma_f32_16x16x32_bf16 v[216:219], v[136:139], v[92:95], v[216:219]
    ds_read_b128 v[136:139], v7 offset:5120
    v_mfma_f32_16x16x32_bf16 v[220:223], v[140:143], v[92:95], v[220:223]
    ds_read_b128 v[140:143], v7 offset:6144
    v_mfma_f32_16x16x32_bf16 v[224:227], v[144:147], v[92:95], v[224:227]
    ds_read_b128 v[144:147], v7 offset:7168
    v_mfma_f32_16x16x32_bf16 v[228:231], v[148:151], v[92:95], v[228:231]
    ds_read_b128 v[148:151], v7 offset:8192
    v_mfma_f32_16x16x32_bf16 v[232:235], v[152:155], v[92:95], v[232:235]
    ds_read_b128 v[152:155], v7 offset:9216
    v_cvt_pk_bf16_f32 v236, v216, v217
    v_cvt_pk_bf16_f32 v237, v218, v219
    v_cvt_pk_bf16_f32 v238, v220, v221
    v_cvt_pk_bf16_f32 v239, v222, v223
    v_cvt_pk_bf16_f32 v240, v224, v225
    v_cvt_pk_bf16_f32 v241, v226, v227
    v_cvt_pk_bf16_f32 v242, v228, v229
    v_cvt_pk_bf16_f32 v243, v230, v231
    v_cvt_pk_bf16_f32 v244, v232, v233
    v_cvt_pk_bf16_f32 v245, v234, v235
    v_cndmask_b32 v244, 0, v244, s[52:53]
    v_cndmask_b32 v245, 0, v245, s[52:53]
    v_mfma_f32_16x16x32_bf16 v[12:15], v[236:239], v[236:239], 0
    v_mfma_f32_16x16x32_bf16 v[8:11], v[246:249], v[236:239], 0
    v_mfma_f32_16x16x32_bf16 v[12:15], v[240:243], v[240:243], v[12:15]
    v_mfma_f32_16x16x32_bf16 v[8:11], v[250:253], v[240:243], v[8:11]
    s_nop 5
    v_mfma_f32_16x16x16_bf16 v[12:15], v[244:245], v[244:245], v[12:15]
    v_mfma_f32_16x16x16_bf16 v[8:11], v[254:255], v[244:245], v[8:11]
    v_lshlrev_b32 v231, 4, v2
    v_add_u32 v231, 162368, v231
    ds_read_b128 v[232:235], v231 offset:256
    ds_read_b128 v[216:219], v231 offset:0
    ds_read_b128 v[220:223], v231 offset:64
    ds_read_b128 v[224:227], v231 offset:128
    ds_read_b128 v[228:231], v231 offset:192
    v_cndmask_b32 v12, v12, v13, s[24:25]
    v_cndmask_b32 v12, v12, v14, s[26:27]
    v_cndmask_b32 v10, v12, v15, s[28:29]
    s_mov_b32 exec_lo, 0x00f0000f
    s_mov_b32 exec_hi, 0xf0000f00
    s_cmp_eq_u32 s10, 1
    s_cbranch_scc0 L_pslow
    global_store_dwordx4 v20, v[8:11], s[18:19]
L_pdone:
    s_mov_b64 exec, -1
    s_mov_b32 s40, 30000
    s_cmp_lg_u32 s44, 0
    s_cbranch_scc1 L_x2
    s_waitcnt lgkmcnt(15)
    v_mfma_f32_16x16x32_bf16 v[196:199], v[156:159], v[24:27], v[196:199]
    ds_read_b128 v[156:159], v7 offset:10240
    v_subrev_u32 v18, 91136, v18
    v_mfma_f32_16x16x32_bf16 v[200:203], v[160:163], v[24:27], v[200:203]
    ds_read_b128 v[160:163], v7 offset:11264
    v_subrev_u32 v19, 91136, v19
    v_mfma_f32_16x16x32_bf16 v[204:207], v[164:167], v[24:27], v[204:207]
    ds_read_b128 v[164:167], v7 offset:12288
    v_subrev_u32 v22, 91136, v22
    v_mfma_f32_16x16x32_bf16 v[208:211], v[168:171], v[24:27], v[208:211]
    ds_read_b128 v[168:171], v7 offset:13312
    v_subrev_u32 v23, 91136, v23
    v_mfma_f32_16x16x32_bf16 v[212:215], v[172:175], v[24:27], v[212:215]
    ds_read_b128 v[172:175], v7 offset:14336
    s_mov_b32 s44, 4194304
    s_waitcnt lgkmcnt(15)
    v_mfma_f32_16x16x32_bf16 v[196:199], v[176:179], v[28:31], v[196:199]
    ds_read_b128 v[176:179], v7 offset:15360
    s_mov_b32 s35, 8
    v_mfma_f32_16x16x32_bf16 v[200:203], v[180:183], v[28:31], v[200:203]
    ds_read_b128 v[180:183], v7 offset:16384
    s_mov_b32 s39, 3551232
    v_mfma_f32_16x16x32_bf16 v[204:207], v[184:187], v[28:31], v[204:207]
    ds_read_b128 v[184:187], v7 offset:17408
    s_add_u32 s22, s16, s39
    v_mfma_f32_16x16x32_bf16 v[208:211], v[188:191], v[28:31], v[208:211]
    ds_read_b128 v[188:191], v7 offset:18432
    s_addc_u32 s23, s17, 0
    v_mfma_f32_16x16x32_bf16 v[212:215], v[192:195], v[28:31], v[212:215]
    ds_read_b128 v[192:195], v7 offset:19456
    s_add_u32 s20, s22, 155648
    s_waitcnt lgkmcnt(15)
    v_mfma_f32_16x16x32_bf16 v[196:199], v[96:99], v[32:35], v[196:199]
    ds_read_b128 v[96:99], v7 offset:20480
    s_addc_u32 s21, s23, 0
    v_mfma_f32_16x16x32_bf16 v[200:203], v[100:103], v[32:35], v[200:203]
    ds_read_b128 v[100:103], v7 offset:21504
    v_mfma_f32_16x16x32_bf16 v[204:207], v[104:107], v[32:35], v[204:207]
    ds_read_b128 v[104:107], v7 offset:22528
    v_mfma_f32_16x16x32_bf16 v[208:211], v[108:111], v[32:35], v[208:211]
    ds_read_b128 v[108:111], v7 offset:23552
    v_mfma_f32_16x16x32_bf16 v[212:215], v[112:115], v[32:35], v[212:215]
    ds_read_b128 v[112:115], v7 offset:24576
    s_waitcnt lgkmcnt(15)
    v_mfma_f32_16x16x32_bf16 v[196:199], v[116:119], v[36:39], v[196:199]
    ds_read_b128 v[116:119], v7 offset:25600
    v_mfma_f32_16x16x32_bf16 v[200:203], v[120:123], v[36:39], v[200:203]
    ds_read_b128 v[120:123], v7 offset:26624
    v_mfma_f32_16x16x32_bf16 v[204:207], v[124:127], v[36:39], v[204:207]
    ds_read_b128 v[124:127], v7 offset:27648
    v_mfma_f32_16x16x32_bf16 v[208:211], v[128:131], v[36:39], v[208:211]
    ds_read_b128 v[128:131], v7 offset:28672
    v_mfma_f32_16x16x32_bf16 v[212:215], v[132:135], v[36:39], v[212:215]
    ds_read_b128 v[132:135], v7 offset:29696
    s_waitcnt lgkmcnt(15)
    v_mfma_f32_16x16x32_bf16 v[196:199], v[136:139], v[40:43], v[196:199]
    ds_read_b128 v[136:139], v7 offset:30720
    v_mfma_f32_16x16x32_bf16 v[200:203], v[140:143], v[40:43], v[200:203]
    ds_read_b128 v[140:143], v7 offset:31744
    v_mfma_f32_16x16x32_bf16 v[204:207], v[144:147], v[40:43], v[204:207]
    ds_read_b128 v[144:147], v7 offset:32768
    v_mfma_f32_16x16x32_bf16 v[208:211], v[148:151], v[40:43], v[208:211]
    ds_read_b128 v[148:151], v7 offset:33792
    v_mfma_f32_16x16x32_bf16 v[212:215], v[152:155], v[40:43], v[212:215]
    ds_read_b128 v[152:155], v7 offset:34816
    s_waitcnt lgkmcnt(15)
    v_mfma_f32_16x16x32_bf16 v[196:199], v[156:159], v[44:47], v[196:199]
    ds_read_b128 v[156:159], v7 offset:35840
    v_mfma_f32_16x16x32_bf16 v[200:203], v[160:163], v[44:47], v[200:203]
    ds_read_b128 v[160:163], v7 offset:36864
    v_mfma_f32_16x16x32_bf16 v[204:207], v[164:167], v[44:47], v[204:207]
    ds_read_b128 v[164:167], v7 offset:37888
    v_mfma_f32_16x16x32_bf16 v[208:211], v[168:171], v[44:47], v[208:211]
    ds_read_b128 v[168:171], v7 offset:38912
    v_mfma_f32_16x16x32_bf16 v[212:215], v[172:175], v[44:47], v[212:215]
    ds_read_b128 v[172:175], v7 offset:39936
    s_waitcnt lgkmcnt(15)
    v_mfma_f32_16x16x32_bf16 v[196:199], v[176:179], v[48:51], v[196:199]
    ds_read_b128 v[176:179], v7 offset:40960
    v_mfma_f32_16x16x32_bf16 v[200:203], v[180:183], v[48:51], v[200:203]
    ds_read_b128 v[180:183], v7 offset:41984
    v_mfma_f32_16x16x32_bf16 v[204:207], v[184:187], v[48:51], v[204:207]
    ds_read_b128 v[184:187], v7 offset:43008
    v_mfma_f32_16x16x32_bf16 v[208:211], v[188:191], v[48:51], v[208:211]
    ds_read_b128 v[188:191], v7 offset:44032
    v_mfma_f32_16x16x32_bf16 v[212:215], v[192:195], v[48:51], v[212:215]
    ds_read_b128 v[192:195], v7 offset:45056
    s_waitcnt lgkmcnt(15)
    v_mfma_f32_16x16x32_bf16 v[196:199], v[96:99], v[52:55], v[196:199]
    ds_read_b128 v[96:99], v7 offset:46080
    v_mfma_f32_16x16x32_bf16 v[200:203], v[100:103], v[52:55], v[200:203]
    ds_read_b128 v[100:103], v7 offset:47104
    v_mfma_f32_16x16x32_bf16 v[204:207], v[104:107], v[52:55], v[204:207]
    ds_read_b128 v[104:107], v7 offset:48128
    v_mfma_f32_16x16x32_bf16 v[208:211], v[108:111], v[52:55], v[208:211]
    ds_read_b128 v[108:111], v7 offset:49152
    v_mfma_f32_16x16x32_bf16 v[212:215], v[112:115], v[52:55], v[212:215]
    ds_read_b128 v[112:115], v7 offset:50176
    s_waitcnt lgkmcnt(15)
    v_mfma_f32_16x16x32_bf16 v[196:199], v[116:119], v[56:59], v[196:199]
    ds_read_b128 v[116:119], v6 offset:0
    v_mfma_f32_16x16x32_bf16 v[200:203], v[120:123], v[56:59], v[200:203]
    ds_read_b128 v[120:123], v6 offset:1024
    v_mfma_f32_16x16x32_bf16 v[204:207], v[124:127], v[56:59], v[204:207]
    ds_read_b128 v[124:127], v6 offset:2048
    v_mfma_f32_16x16x32_bf16 v[208:211], v[128:131], v[56:59], v[208:211]
    ds_read_b128 v[128:131], v6 offset:3072
    v_mfma_f32_16x16x32_bf16 v[212:215], v[132:135], v[56:59], v[212:215]
    ds_read_b128 v[132:135], v6 offset:4096
    global_load_dwordx4 v[8:11], v21, s[18:19] offset:-2048 sc1
    global_load_dwordx4 v[12:15], v21, s[18:19] offset:2048 sc1
    s_waitcnt lgkmcnt(15)
    v_mfma_f32_16x16x32_bf16 v[196:199], v[136:139], v[60:63], v[196:199]
    ds_read_b128 v[136:139], v6 offset:5120
    v_mfma_f32_16x16x32_bf16 v[200:203], v[140:143], v[60:63], v[200:203]
    ds_read_b128 v[140:143], v6 offset:6144
    v_mfma_f32_16x16x32_bf16 v[204:207], v[144:147], v[60:63], v[204:207]
    ds_read_b128 v[144:147], v6 offset:7168
    v_mfma_f32_16x16x32_bf16 v[208:211], v[148:151], v[60:63], v[208:211]
    ds_read_b128 v[148:151], v6 offset:8192
    v_mfma_f32_16x16x32_bf16 v[212:215], v[152:155], v[60:63], v[212:215]
    ds_read_b128 v[152:155], v6 offset:9216
    s_waitcnt lgkmcnt(15)
    v_mfma_f32_16x16x32_bf16 v[196:199], v[156:159], v[64:67], v[196:199]
    ds_read_b128 v[156:159], v6 offset:10240
    v_mfma_f32_16x16x32_bf16 v[200:203], v[160:163], v[64:67], v[200:203]
    ds_read_b128 v[160:163], v6 offset:11264
    v_mfma_f32_16x16x32_bf16 v[204:207], v[164:167], v[64:67], v[204:207]
    ds_read_b128 v[164:167], v6 offset:12288
    v_mfma_f32_16x16x32_bf16 v[208:211], v[168:171], v[64:67], v[208:211]
    ds_read_b128 v[168:171], v6 offset:13312
    v_mfma_f32_16x16x32_bf16 v[212:215], v[172:175], v[64:67], v[212:215]
    ds_read_b128 v[172:175], v6 offset:14336
    s_waitcnt lgkmcnt(15)
    v_mfma_f32_16x16x32_bf16 v[196:199], v[176:179], v[68:71], v[196:199]
    ds_read_b128 v[176:179], v6 offset:15360
    v_mfma_f32_16x16x32_bf16 v[200:203], v[180:183], v[68:71], v[200:203]
    ds_read_b128 v[180:183], v6 offset:16384
    v_mfma_f32_16x16x32_bf16 v[204:207], v[184:187], v[68:71], v[204:207]
    ds_read_b128 v[184:187], v6 offset:17408
    v_mfma_f32_16x16x32_bf16 v[208:211], v[188:191], v[68:71], v[208:211]
    ds_read_b128 v[188:191], v6 offset:18432
    v_mfma_f32_16x16x32_bf16 v[212:215], v[192:195], v[68:71], v[212:215]
    ds_read_b128 v[192:195], v6 offset:19456
    s_waitcnt lgkmcnt(15)
    v_mfma_f32_16x16x32_bf16 v[196:199], v[96:99], v[72:75], v[196:199]
    ds_read_b128 v[96:99], v6 offset:20480
    v_mfma_f32_16x16x32_bf16 v[200:203], v[100:103], v[72:75], v[200:203]
    ds_read_b128 v[100:103], v6 offset:21504
    v_mfma_f32_16x16x32_bf16 v[204:207], v[104:107], v[72:75], v[204:207]
    ds_read_b128 v[104:107], v6 offset:22528
    v_mfma_f32_16x16x32_bf16 v[208:211], v[108:111], v[72:75], v[208:211]
    ds_read_b128 v[108:111], v6 offset:23552
    v_mfma_f32_16x16x32_bf16 v[212:215], v[112:115], v[72:75], v[212:215]
    ds_read_b128 v[112:115], v6 offset:24576
    s_waitcnt lgkmcnt(15)
    v_mfma_f32_16x16x32_bf16 v[196:199], v[116:119], v[76:79], v[196:199]
    v_mfma_f32_16x16x32_bf16 v[200:203], v[120:123], v[76:79], v[200:203]
    v_mfma_f32_16x16x32_bf16 v[204:207], v[124:127], v[76:79], v[204:207]
    v_mfma_f32_16x16x32_bf16 v[208:211], v[128:131], v[76:79], v[208:211]
    v_mfma_f32_16x16x32_bf16 v[212:215], v[132:135], v[76:79], v[212:215]
    s_waitcnt lgkmcnt(15)
    v_mfma_f32_16x16x32_bf16 v[196:199], v[136:139], v[80:83], v[196:199]
    s_waitcnt vmcnt(0)
    v_max3_u32 v29, v8, v9, v10
    v_max3_u32 v29, v12, v13, v29
    v_mfma_f32_16x16x32_bf16 v[200:203], v[140:143], v[80:83], v[200:203]
    v_max_u32 v29, v14, v29
    v_cmp_eq_u32 vcc, -1, v29
    s_cmp_eq_u64 vcc, 0
    v_mfma_f32_16x16x32_bf16 v[204:207], v[144:147], v[80:83], v[204:207]
    v_add_f32 v8, v8, v12
    v_add_f32 v9, v9, v13
    v_add_f32 v10, v10, v14
    v_mov_b32 v24, v8
    v_mfma_f32_16x16x32_bf16 v[208:211], v[148:151], v[80:83], v[208:211]
    v_mov_b32 v25, v10
    v_mov_b32 v26, v9
    v_permlane16_swap_b32 v8, v24
    v_mfma_f32_16x16x32_bf16 v[212:215], v[152:155], v[80:83], v[212:215]
    v_permlane16_swap_b32 v10, v25
    v_permlane16_swap_b32 v9, v26
    v_add_f32 v8, v8, v24
    v_add_f32 v10, v10, v25
    s_waitcnt lgkmcnt(10)
    v_mfma_f32_16x16x32_bf16 v[196:199], v[156:159], v[84:87], v[196:199]
    v_add_f32 v9, v9, v26
    v_mov_b32 v24, v8
    v_mov_b32 v25, v10
    v_mfma_f32_16x16x32_bf16 v[200:203], v[160:163], v[84:87], v[200:203]
    v_mov_b32 v26, v9
    v_permlane32_swap_b32 v8, v24
    v_permlane32_swap_b32 v10, v25
    v_mfma_f32_16x16x32_bf16 v[204:207], v[164:167], v[84:87], v[204:207]
    v_permlane32_swap_b32 v9, v26
    v_add_f32 v8, v8, v24
    v_add_f32 v10, v10, v25
    v_add_f32 v9, v9, v26
    v_mfma_f32_16x16x32_bf16 v[208:211], v[168:171], v[84:87], v[208:211]
    v_mul_f32 v24, 0x3ae38e39, v8
    v_mul_f32 v25, 0x3ae38e39, v10
    v_fma_f32 v25, -v24, v24, v25
    v_mfma_f32_16x16x32_bf16 v[212:215], v[172:175], v[84:87], v[212:215]
    v_max_f32 v25, 0, v25
    v_cvt_pk_bf16_f32 v14, v24, v24
    v_and_b32 v14, 0xffff0000, v14
    v_cvt_pk_bf16_f32 v26, v25, v25
    s_waitcnt lgkmcnt(5)
    v_mfma_f32_16x16x32_bf16 v[196:199], v[176:179], v[88:91], v[196:199]
    v_and_b32 v26, 0xffff0000, v26
    v_add_f32 v26, 0x3727c5ac, v26
    v_cvt_pk_bf16_f32 v26, v26, v26
    v_mfma_f32_16x16x32_bf16 v[200:203], v[180:183], v[88:91], v[200:203]
    v_and_b32 v26, 0xffff0000, v26
    v_sqrt_f32 v26, v26
    s_nop 0
    v_cvt_pk_bf16_f32 v15, v26, v26
    v_and_b32 v15, 0xffff0000, v15
    v_mfma_f32_16x16x32_bf16 v[204:207], v[184:187], v[88:91], v[204:207]
    v_rcp_f32 v15, v15
    s_nop 0
    v_add_f32 v10, 1.0, v15
    v_mul_f32 v11, v14, v15
    v_mfma_f32_16x16x32_bf16 v[208:211], v[188:191], v[88:91], v[208:211]
    v_mul_f32 v25, v25, v10
    v_fma_f32 v24, v10, v24, -v11
    v_mul_f32 v25, v25, v10
    v_mfma_f32_16x16x32_bf16 v[212:215], v[192:195], v[88:91], v[212:215]
    v_cvt_pk_bf16_f32 v27, v24, v24
    v_and_b32 v27, 0xffff0000, v27
    v_cvt_pk_bf16_f32 v26, v25, v25
    v_and_b32 v26, 0xffff0000, v26
    s_waitcnt lgkmcnt(0)
    v_mfma_f32_16x16x32_bf16 v[212:215], v[112:115], v[92:95], v[212:215]
    v_add_f32 v26, 0x3727c5ac, v26
    v_cvt_pk_bf16_f32 v26, v26, v26
    v_and_b32 v26, 0xffff0000, v26
    v_mfma_f32_16x16x32_bf16 v[196:199], v[96:99], v[92:95], v[196:199]
    v_sqrt_f32 v26, v26
    s_nop 0
    v_cvt_pk_bf16_f32 v28, v26, v26
    v_and_b32 v28, 0xffff0000, v28
    v_rcp_f32 v28, v28
    v_mfma_f32_16x16x32_bf16 v[200:203], v[100:103], v[92:95], v[200:203]
    v_add_f32 v11, v11, v27
    v_mul_f32 v10, v10, v28
    v_mul_f32 v11, v11, v28
    v_mfma_f32_16x16x32_bf16 v[204:207], v[104:107], v[92:95], v[204:207]
    v_mul_f32 v12, 0x3eae1a93, v10
    v_mul_f32 v13, 0x3eae1a93, v11
    v_cndmask_b32 v10, v10, v12, s[52:53]
    v_cndmask_b32 v11, v11, v13, s[52:53]
    v_mfma_f32_16x16x32_bf16 v[208:211], v[108:111], v[92:95], v[208:211]
    s_cbranch_scc1 L_E
L_pollp:
    global_load_dwordx4 v[8:11], v21, s[18:19] offset:-2048 sc1
    global_load_dwordx4 v[12:15], v21, s[18:19] offset:2048 sc1
    s_waitcnt vmcnt(0)
    v_max3_u32 v29, v8, v9, v10
    v_max3_u32 v29, v12, v13, v29
    v_max_u32 v29, v14, v29
    v_cmp_eq_u32 vcc, -1, v29
    s_cmp_eq_u64 vcc, 0
    s_cbranch_scc1 L_pollp_ok
    s_sub_u32 s40, s40, 1
    s_cbranch_scc0 L_pollp
L_pollp_ok:
    v_add_f32 v8, v8, v12
    v_add_f32 v9, v9, v13
    v_add_f32 v10, v10, v14
    v_mov_b32 v24, v8
    v_mov_b32 v25, v10
    v_mov_b32 v26, v9
    v_permlane16_swap_b32 v8, v24
    v_permlane16_swap_b32 v10, v25
    v_permlane16_swap_b32 v9, v26
    v_add_f32 v8, v8, v24
    v_add_f32 v10, v10, v25
    v_add_f32 v9, v9, v26
    v_mov_b32 v24, v8
    v_mov_b32 v25, v10
    v_mov_b32 v26, v9
    v_permlane32_swap_b32 v8, v24
    v_permlane32_swap_b32 v10, v25
    v_permlane32_swap_b32 v9, v26
    v_add_f32 v8, v8, v24
    v_add_f32 v10, v10, v25
    v_add_f32 v9, v9, v26
    v_mul_f32 v24, 0x3ae38e39, v8
    v_mul_f32 v25, 0x3ae38e39, v10
    v_fma_f32 v25, -v24, v24, v25
    v_max_f32 v25, 0, v25
    v_cvt_pk_bf16_f32 v14, v24, v24
    v_and_b32 v14, 0xffff0000, v14
    v_cvt_pk_bf16_f32 v26, v25, v25
    v_and_b32 v26, 0xffff0000, v26
    v_add_f32 v26, 0x3727c5ac, v26
    v_cvt_pk_bf16_f32 v26, v26, v26
    v_and_b32 v26, 0xffff0000, v26
    v_sqrt_f32 v26, v26
    s_nop 0
    v_cvt_pk_bf16_f32 v15, v26, v26
    v_and_b32 v15, 0xffff0000, v15
    v_rcp_f32 v15, v15
    s_cmp_lg_u32 s48, 0
    s_cbranch_scc1 L_xn
    v_add_f32 v10, 1.0, v15
    v_mul_f32 v11, v14, v15
    v_mul_f32 v25, v25, v10
    v_fma_f32 v24, v10, v24, -v11
    v_mul_f32 v25, v25, v10
    v_cvt_pk_bf16_f32 v27, v24, v24
    v_and_b32 v27, 0xffff0000, v27
    v_cvt_pk_bf16_f32 v26, v25, v25
    v_and_b32 v26, 0xffff0000, v26
    v_add_f32 v26, 0x3727c5ac, v26
    v_cvt_pk_bf16_f32 v26, v26, v26
    v_and_b32 v26, 0xffff0000, v26
    v_sqrt_f32 v26, v26
    s_nop 0
    v_cvt_pk_bf16_f32 v28, v26, v26
    v_and_b32 v28, 0xffff0000, v28
    v_rcp_f32 v28, v28
    v_add_f32 v11, v11, v27
    v_mul_f32 v10, v10, v28
    v_mul_f32 v11, v11, v28
    v_mul_f32 v12, 0x3eae1a93, v10
    v_mul_f32 v13, 0x3eae1a93, v11
    v_cndmask_b32 v10, v10, v12, s[52:53]
    v_cndmask_b32 v11, v11, v13, s[52:53]
    s_branch L_E
L_xn:
    v_fma_f32 v8, -v14, s33, v9
    v_mul_f32 v8, v8, v15
    v_cvt_pk_bf16_f32 v8, v8, v8
    v_ashrrev_i32 v10, 31, v8
    v_or_b32 v10, 0x80000000, v10
    v_xor_b32 v8, v8, v10
    s_sub_u32 s24, 0xffff, s32
    v_sub_u32 v10, s24, v3
    s_mov_b32 s24, 0xffff0000
    v_and_or_b32 v8, v8, s24, v10
    v_mov_b32 v10, v8
    s_nop 1
    v_max_u32_dpp v10, v10, v10 row_ror:8 row_mask:0xf bank_mask:0xf
    s_nop 1
    v_max_u32_dpp v10, v10, v10 row_ror:4 row_mask:0xf bank_mask:0xf
    s_nop 1
    v_max_u32_dpp v10, v10, v10 row_ror:2 row_mask:0xf bank_mask:0xf
    s_nop 1
    v_max_u32_dpp v10, v10, v10 row_ror:1 row_mask:0xf bank_mask:0xf
    v_cmp_eq_u32 s[42:43], v8, v10
    v_readfirstlane_b32 s12, v10
    s_and_b32 s24, s4, 7
    s_cmp_eq_u32 s24, 7
    s_cselect_b32 s24, s48, 0
    s_cmp_eq_u32 s24, 0
    s_cbranch_scc1 L_nokey
    v_mov_b32 v9, 158720
    v_mov_b32 v24, 1
    s_mov_b64 exec, 1
    ds_max_u32 v9, v10 offset:32
    ds_add_rtn_u32 v24, v9, v24 offset:36
    ds_read2_b32 v[26:27], v9 offset0:8 offset1:0
    s_lshl_b32 s24, s3, 7
    s_add_u32 s24, s24, 3543040
    v_mov_b32 v25, s24
    v_subrev_u32 v9, 4096, v25
    s_waitcnt lgkmcnt(0)
    v_cmp_lt_u32 vcc, v26, v27
    v_readfirstlane_b32 s24, v24
    s_nop 0
    v_cndmask_b32 v25, v25, v9, vcc
    s_cmp_lg_u32 s24, 3
    s_cbranch_scc1 L_nokey1
    global_store_dword v25, v26, s[18:19] sc1
L_nokey1:
    s_mov_b64 exec, -1
L_nokey:
    s_mul_i32 s24, s38, 4224
    s_mul_i32 s25, s4, 144
    s_add_u32 s24, s24, 2621440
    s_mul_i32 s13, s4, 384
    s_add_u32 s13, s13, s24
    s_add_u32 s24, s24, s25
    v_lshl_add_u32 v8, v2, 4, s13
    v_lshl_add_u32 v9, v2, 3, s13
    v_lshl_add_u32 v28, v2, 4, s24
    v_lshl_add_u32 v29, v2, 3, s24
    v_lshlrev_b32 v24, 16, v236
    v_and_b32 v25, 0xffff0000, v236
    v_pk_add_f32 v[24:25], v[24:25], v[14:15] op_sel_hi:[1,0] neg_lo:[0,1] neg_hi:[0,1]
    v_cvt_pk_bf16_f32 v24, v24, v25
    v_and_b32 v25, 0xffff0000, v24
    v_lshlrev_b32 v24, 16, v24
    v_pk_mul_f32 v[24:25], v[24:25], v[14:15] op_sel:[0,1]
    v_cvt_pk_bf16_f32 v196, v24, v25
    v_lshlrev_b32 v26, 16, v237
    v_and_b32 v27, 0xffff0000, v237
    v_pk_add_f32 v[26:27], v[26:27], v[14:15] op_sel_hi:[1,0] neg_lo:[0,1] neg_hi:[0,1]
    v_cvt_pk_bf16_f32 v26, v26, v27
    v_and_b32 v27, 0xffff0000, v26
    v_lshlrev_b32 v26, 16, v26
    v_pk_mul_f32 v[26:27], v[26:27], v[14:15] op_sel:[0,1]
    v_cvt_pk_bf16_f32 v197, v26, v27
    v_lshlrev_b32 v24, 16, v238
    v_and_b32 v25, 0xffff0000, v238
    v_pk_add_f32 v[24:25], v[24:25], v[14:15] op_sel_hi:[1,0] neg_lo:[0,1] neg_hi:[0,1]
    v_cvt_pk_bf16_f32 v24, v24, v25
    v_and_b32 v25, 0xffff0000, v24
    v_lshlrev_b32 v24, 16, v24
    v_pk_mul_f32 v[24:25], v[24:25], v[14:15] op_sel:[0,1]
    v_cvt_pk_bf16_f32 v198, v24, v25
    v_lshlrev_b32 v26, 16, v239
    v_and_b32 v27, 0xffff0000, v239
    v_pk_add_f32 v[26:27], v[26:27], v[14:15] op_sel_hi:[1,0] neg_lo:[0,1] neg_hi:[0,1]
    v_cvt_pk_bf16_f32 v26, v26, v27
    v_and_b32 v27, 0xffff0000, v26
    v_lshlrev_b32 v26, 16, v26
    v_pk_mul_f32 v[26:27], v[26:27], v[14:15] op_sel:[0,1]
    v_cvt_pk_bf16_f32 v199, v26, v27
    v_lshlrev_b32 v24, 16, v240
    v_and_b32 v25, 0xffff0000, v240
    v_pk_add_f32 v[24:25], v[24:25], v[14:15] op_sel_hi:[1,0] neg_lo:[0,1] neg_hi:[0,1]
    v_cvt_pk_bf16_f32 v24, v24, v25
    v_and_b32 v25, 0xffff0000, v24
    v_lshlrev_b32 v24, 16, v24
    v_pk_mul_f32 v[24:25], v[24:25], v[14:15] op_sel:[0,1]
    v_cvt_pk_bf16_f32 v200, v24, v25
    v_lshlrev_b32 v26, 16, v241
    v_and_b32 v27, 0xffff0000, v241
    v_pk_add_f32 v[26:27], v[26:27], v[14:15] op_sel_hi:[1,0] neg_lo:[0,1] neg_hi:[0,1]
    v_cvt_pk_bf16_f32 v26, v26, v27
    v_and_b32 v27, 0xffff0000, v26
    v_lshlrev_b32 v26, 16, v26
    v_pk_mul_f32 v[26:27], v[26:27], v[14:15] op_sel:[0,1]
    v_cvt_pk_bf16_f32 v201, v26, v27
    v_lshlrev_b32 v24, 16, v242
    v_and_b32 v25, 0xffff0000, v242
    v_pk_add_f32 v[24:25], v[24:25], v[14:15] op_sel_hi:[1,0] neg_lo:[0,1] neg_hi:[0,1]
    v_cvt_pk_bf16_f32 v24, v24, v25
    v_and_b32 v25, 0xffff0000, v24
    v_lshlrev_b32 v24, 16, v24
    v_pk_mul_f32 v[24:25], v[24:25], v[14:15] op_sel:[0,1]
    v_cvt_pk_bf16_f32 v202, v24, v25
    v_lshlrev_b32 v26, 16, v243
    v_and_b32 v27, 0xffff0000, v243
    v_pk_add_f32 v[26:27], v[26:27], v[14:15] op_sel_hi:[1,0] neg_lo:[0,1] neg_hi:[0,1]
    v_cvt_pk_bf16_f32 v26, v26, v27
    v_and_b32 v27, 0xffff0000, v26
    v_lshlrev_b32 v26, 16, v26
    v_pk_mul_f32 v[26:27], v[26:27], v[14:15] op_sel:[0,1]
    v_cvt_pk_bf16_f32 v203, v26, v27
    v_lshlrev_b32 v24, 16, v244
    v_and_b32 v25, 0xffff0000, v244
    v_pk_add_f32 v[24:25], v[24:25], v[14:15] op_sel_hi:[1,0] neg_lo:[0,1] neg_hi:[0,1]
    v_cvt_pk_bf16_f32 v24, v24, v25
    v_and_b32 v25, 0xffff0000, v24
    v_lshlrev_b32 v24, 16, v24
    v_pk_mul_f32 v[24:25], v[24:25], v[14:15] op_sel:[0,1]
    v_cvt_pk_bf16_f32 v204, v24, v25
    v_lshlrev_b32 v26, 16, v245
    v_and_b32 v27, 0xffff0000, v245
    v_pk_add_f32 v[26:27], v[26:27], v[14:15] op_sel_hi:[1,0] neg_lo:[0,1] neg_hi:[0,1]
    v_cvt_pk_bf16_f32 v26, v26, v27
    v_and_b32 v27, 0xffff0000, v26
    v_lshlrev_b32 v26, 16, v26
    v_pk_mul_f32 v[26:27], v[26:27], v[14:15] op_sel:[0,1]
    v_cvt_pk_bf16_f32 v205, v26, v27
    s_mov_b64 exec, s[42:43]
    global_store_dwordx4 v8, v[196:199], s[18:19] sc1
    global_store_dwordx4 v8, v[200:203], s[18:19] offset:128 sc1
    s_mov_b32 exec_hi, 0
    global_store_dwordx2 v9, v[204:205], s[18:19] offset:256 sc1
    global_store_dwordx2 v29, v[244:245], s[18:19] offset:3200 sc1
    s_mov_b64 exec, s[42:43]
    global_store_dwordx4 v28, v[236:239], s[18:19] offset:3072 sc1
    global_store_dwordx4 v28, v[240:243], s[18:19] offset:3136 sc1
L_x9:
    s_mov_b64 exec, -1
    s_add_u32 s18, s16, 4194304
    s_addc_u32 s19, s17, 0
    s_add_u32 s54, s54, 4194304
    s_addc_u32 s55, s55, 0
    s_cmp_eq_u32 s48, 0
    s_cbranch_scc1 L_prep
    s_waitcnt lgkmcnt(0)
    v_lshlrev_b32 v216, 16, v236
    v_and_b32 v217, 0xffff0000, v236
    v_lshlrev_b32 v218, 16, v196
    v_and_b32 v219, 0xffff0000, v196
    v_pk_add_f32 v[216:217], v[216:217], v[218:219]
    v_cvt_pk_bf16_f32 v236, v216, v217
    v_lshlrev_b32 v216, 16, v237
    v_and_b32 v217, 0xffff0000, v237
    v_lshlrev_b32 v218, 16, v197
    v_and_b32 v219, 0xffff0000, v197
    v_pk_add_f32 v[216:217], v[216:217], v[218:219]
    v_cvt_pk_bf16_f32 v237, v216, v217
    v_lshlrev_b32 v216, 16, v238
    v_and_b32 v217, 0xffff0000, v238
    v_lshlrev_b32 v218, 16, v198
    v_and_b32 v219, 0xffff0000, v198
    v_pk_add_f32 v[216:217], v[216:217], v[218:219]
    v_cvt_pk_bf16_f32 v238, v216, v217
    v_lshlrev_b32 v216, 16, v239
    v_and_b32 v217, 0xffff0000, v239
    v_lshlrev_b32 v218, 16, v199
    v_and_b32 v219, 0xffff0000, v199
    v_pk_add_f32 v[216:217], v[216:217], v[218:219]
    v_cvt_pk_bf16_f32 v239, v216, v217
    v_lshlrev_b32 v216, 16, v240
    v_and_b32 v217, 0xffff0000, v240
    v_lshlrev_b32 v218, 16, v200
    v_and_b32 v219, 0xffff0000, v200
    v_pk_add_f32 v[216:217], v[216:217], v[218:219]
    v_cvt_pk_bf16_f32 v240, v216, v217
    v_lshlrev_b32 v216, 16, v241
    v_and_b32 v217, 0xffff0000, v241
    v_lshlrev_b32 v218, 16, v201
    v_and_b32 v219, 0xffff0000, v201
    v_pk_add_f32 v[216:217], v[216:217], v[218:219]
    v_cvt_pk_bf16_f32 v241, v216, v217
    v_lshlrev_b32 v216, 16, v242
    v_and_b32 v217, 0xffff0000, v242
    v_lshlrev_b32 v218, 16, v202
    v_and_b32 v219, 0xffff0000, v202
    v_pk_add_f32 v[216:217], v[216:217], v[218:219]
    v_cvt_pk_bf16_f32 v242, v216, v217
    v_lshlrev_b32 v216, 16, v243
    v_and_b32 v217, 0xffff0000, v243
    v_lshlrev_b32 v218, 16, v203
    v_and_b32 v219, 0xffff0000, v203
    v_pk_add_f32 v[216:217], v[216:217], v[218:219]
    v_cvt_pk_bf16_f32 v243, v216, v217
    v_lshlrev_b32 v216, 16, v244
    v_and_b32 v217, 0xffff0000, v244
    v_lshlrev_b32 v218, 16, v204
    v_and_b32 v219, 0xffff0000, v204
    v_pk_add_f32 v[216:217], v[216:217], v[218:219]
    v_cvt_pk_bf16_f32 v244, v216, v217
    v_lshlrev_b32 v216, 16, v245
    v_and_b32 v217, 0xffff0000, v245
    v_lshlrev_b32 v218, 16, v205
    v_and_b32 v219, 0xffff0000, v205
    v_pk_add_f32 v[216:217], v[216:217], v[218:219]
    v_cvt_pk_bf16_f32 v245, v216, v217
    v_add_u32 v5, s32, v3
    v_mul_u32_u24 v5, 1152, v5
    v_add_u32 v5, s25, v5
    v_lshl_add_u32 v22, v2, 4, v5
    v_lshl_add_u32 v23, v2, 3, v5
    s_not_b64 exec, s[42:43]
    global_store_dwordx4 v22, v[236:239], s[8:9]
    global_store_dwordx4 v22, v[240:243], s[8:9] offset:64
    s_mov_b32 exec_hi, 0
    global_store_dwordx2 v23, v[244:245], s[8:9] offset:128
    s_mov_b64 exec, -1
    s_add_u32 s12, s12, 1
    v_mov_b32 v16, 158720
    s_mov_b32 s40, 524288
L_mkey:
    ds_read_b64 v[18:19], v16
    s_waitcnt lgkmcnt(0)
    v_readfirstlane_b32 s30, v18
    v_readfirstlane_b32 s31, v19
    s_max_u32 s30, s30, s31
    s_cmp_gt_u32 s30, s12
    s_cbranch_scc1 L_mkey_st
    s_cmp_lg_u32 s31, 0
    s_cbranch_scc1 L_end
    s_sub_u32 s40, s40, 1
    s_cbranch_scc0 L_mkey
L_mkey_st:
    v_mov_b32 v18, 1
    s_mov_b64 exec, 1
    ds_add_u32 v16, v18 offset:40
    s_mov_b64 exec, s[42:43]
    global_store_dwordx4 v22, v[236:239], s[8:9]
    global_store_dwordx4 v22, v[240:243], s[8:9] offset:64
    s_mov_b32 exec_hi, 0
    global_store_dwordx2 v23, v[244:245], s[8:9] offset:128
    s_endpgm
L_x2:
    global_load_dwordx4 v[8:11], v21, s[18:19] offset:-2048 sc1
    global_load_dwordx4 v[12:15], v21, s[18:19] offset:2048 sc1
    v_lshlrev_b32 v32, 16, v236
    v_and_b32 v33, 0xffff0000, v236
    v_lshlrev_b32 v34, 16, v237
    v_and_b32 v35, 0xffff0000, v237
    v_lshlrev_b32 v36, 16, v238
    v_and_b32 v37, 0xffff0000, v238
    v_lshlrev_b32 v38, 16, v239
    v_and_b32 v39, 0xffff0000, v239
    v_lshlrev_b32 v40, 16, v240
    v_and_b32 v41, 0xffff0000, v240
    v_lshlrev_b32 v42, 16, v241
    v_and_b32 v43, 0xffff0000, v241
    v_lshlrev_b32 v44, 16, v242
    v_and_b32 v45, 0xffff0000, v242
    v_lshlrev_b32 v46, 16, v243
    v_and_b32 v47, 0xffff0000, v243
    v_lshlrev_b32 v48, 16, v244
    v_and_b32 v49, 0xffff0000, v244
    v_lshlrev_b32 v50, 16, v245
    v_and_b32 v51, 0xffff0000, v245
    s_mul_i32 s24, s38, 4224
    s_mul_i32 s25, s4, 144
    s_add_u32 s24, s24, 2621440
    s_mul_i32 s13, s4, 384
    s_add_u32 s13, s13, s24
    s_add_u32 s24, s24, s25
    v_lshl_add_u32 v52, v2, 4, s13
    v_lshl_add_u32 v53, v2, 3, s13
    v_lshl_add_u32 v54, v2, 4, s24
    v_lshl_add_u32 v55, v2, 3, s24
    s_sub_u32 s24, 0xffff, s32
    v_sub_u32 v56, s24, v3
    v_mov_b32 v57, 158720
    v_mov_b32 v58, 1
    s_lshl_b32 s24, s3, 7
    s_add_u32 s24, s24, 3543040
    v_mov_b32 v59, s24
    v_subrev_u32 v60, 4096, v59
    s_mov_b32 s13, 0xffff0000
    s_branch L_x2w
L_x2l:
    global_load_dwordx4 v[8:11], v21, s[18:19] offset:-2048 sc1
    global_load_dwordx4 v[12:15], v21, s[18:19] offset:2048 sc1
L_x2w:
    s_waitcnt vmcnt(0)
    v_max3_u32 v29, v8, v9, v10
    v_max3_u32 v29, v12, v13, v29
    v_max_u32 v29, v14, v29
    v_cmp_eq_u32 vcc, -1, v29
    s_cmp_eq_u64 vcc, 0
    s_cbranch_scc1 L_x2l_ok
    s_sub_u32 s40, s40, 1
    s_cbranch_scc0 L_x2l
L_x2l_ok:
    v_add_f32 v8, v8, v12
    v_add_f32 v9, v9, v13
    v_add_f32 v10, v10, v14
    v_mov_b32 v24, v8
    v_mov_b32 v25, v10
    v_mov_b32 v26, v9
    v_permlane16_swap_b32 v8, v24
    v_permlane16_swap_b32 v10, v25
    v_permlane16_swap_b32 v9, v26
    v_add_f32 v8, v8, v24
    v_add_f32 v10, v10, v25
    v_add_f32 v9, v9, v26
    v_mov_b32 v24, v8
    v_mov_b32 v25, v10
    v_mov_b32 v26, v9
    v_permlane32_swap_b32 v8, v24
    v_permlane32_swap_b32 v10, v25
    v_permlane32_swap_b32 v9, v26
    v_add_f32 v8, v8, v24
    v_add_f32 v10, v10, v25
    v_add_f32 v9, v9, v26
    v_mul_f32 v24, 0x3ae38e39, v8
    v_mul_f32 v25, 0x3ae38e39, v10
    v_fma_f32 v25, -v24, v24, v25
    v_max_f32 v25, 0, v25
    v_cvt_pk_bf16_f32 v14, v24, v24
    v_and_b32 v14, 0xffff0000, v14
    v_cvt_pk_bf16_f32 v26, v25, v25
    v_and_b32 v26, 0xffff0000, v26
    v_add_f32 v26, 0x3727c5ac, v26
    v_cvt_pk_bf16_f32 v26, v26, v26
    v_and_b32 v26, 0xffff0000, v26
    v_sqrt_f32 v26, v26
    s_nop 0
    v_cvt_pk_bf16_f32 v15, v26, v26
    v_and_b32 v15, 0xffff0000, v15
    v_rcp_f32 v15, v15
    v_fma_f32 v8, -v14, s33, v9
    v_mul_f32 v8, v8, v15
    v_cvt_pk_bf16_f32 v8, v8, v8
    v_ashrrev_i32 v10, 31, v8
    v_or_b32 v10, 0x80000000, v10
    v_xor_b32 v8, v8, v10
    v_and_or_b32 v8, v8, s13, v56
    v_mov_b32 v10, v8
    s_nop 1
    v_max_u32_dpp v10, v10, v10 row_ror:8 row_mask:0xf bank_mask:0xf
    s_nop 1
    v_max_u32_dpp v10, v10, v10 row_ror:4 row_mask:0xf bank_mask:0xf
    s_nop 1
    v_max_u32_dpp v10, v10, v10 row_ror:2 row_mask:0xf bank_mask:0xf
    s_nop 1
    v_max_u32_dpp v10, v10, v10 row_ror:1 row_mask:0xf bank_mask:0xf
    s_cmp_eq_u32 s4, 7
    s_cbranch_scc0 L_x2a
    s_mov_b64 exec, 1
    ds_max_u32 v57, v10 offset:32
    ds_add_rtn_u32 v58, v57, v58 offset:36
    ds_read2_b32 v[26:27], v57 offset0:8 offset1:0
    s_mov_b64 exec, -1
L_x2a:
    v_cmp_eq_u32 s[42:43], v8, v10
    v_readfirstlane_b32 s12, v10
    v_pk_add_f32 v[32:33], v[32:33], v[14:15] op_sel_hi:[1,0] neg_lo:[0,1] neg_hi:[0,1]
    v_pk_add_f32 v[34:35], v[34:35], v[14:15] op_sel_hi:[1,0] neg_lo:[0,1] neg_hi:[0,1]
    v_pk_add_f32 v[36:37], v[36:37], v[14:15] op_sel_hi:[1,0] neg_lo:[0,1] neg_hi:[0,1]
    v_pk_add_f32 v[38:39], v[38:39], v[14:15] op_sel_hi:[1,0] neg_lo:[0,1] neg_hi:[0,1]
    v_pk_add_f32 v[40:41], v[40:41], v[14:15] op_sel_hi:[1,0] neg_lo:[0,1] neg_hi:[0,1]
    v_pk_add_f32 v[42:43], v[42:43], v[14:15] op_sel_hi:[1,0] neg_lo:[0,1] neg_hi:[0,1]
    v_pk_add_f32 v[44:45], v[44:45], v[14:15] op_sel_hi:[1,0] neg_lo:[0,1] neg_hi:[0,1]
    v_cvt_pk_bf16_f32 v32, v32, v33
    v_cvt_pk_bf16_f32 v34, v34, v35
    v_cvt_pk_bf16_f32 v36, v36, v37
    v_cvt_pk_bf16_f32 v38, v38, v39
    v_cvt_pk_bf16_f32 v40, v40, v41
    v_cvt_pk_bf16_f32 v42, v42, v43
    v_cvt_pk_bf16_f32 v44, v44, v45
    v_and_b32 v33, 0xffff0000, v32
    v_lshlrev_b32 v32, 16, v32
    v_and_b32 v35, 0xffff0000, v34
    v_lshlrev_b32 v34, 16, v34
    v_and_b32 v37, 0xffff0000, v36
    v_lshlrev_b32 v36, 16, v36
    v_and_b32 v39, 0xffff0000, v38
    v_lshlrev_b32 v38, 16, v38
    v_and_b32 v41, 0xffff0000, v40
    v_lshlrev_b32 v40, 16, v40
    v_and_b32 v43, 0xffff0000, v42
    v_lshlrev_b32 v42, 16, v42
    v_and_b32 v45, 0xffff0000, v44
    v_lshlrev_b32 v44, 16, v44
    s_cbranch_scc0 L_x2b
    s_waitcnt lgkmcnt(0)
    v_cmp_lt_u32 vcc, v26, v27
    v_readfirstlane_b32 s24, v58
    s_nop 0
    v_cndmask_b32 v59, v59, v60, vcc
    s_cmp_lg_u32 s24, 3
    s_cbranch_scc1 L_x2b
    s_mov_b64 exec, 1
    global_store_dword v59, v26, s[18:19] sc1
    s_mov_b64 exec, -1
L_x2b:
    v_pk_add_f32 v[46:47], v[46:47], v[14:15] op_sel_hi:[1,0] neg_lo:[0,1] neg_hi:[0,1]
    v_pk_add_f32 v[48:49], v[48:49], v[14:15] op_sel_hi:[1,0] neg_lo:[0,1] neg_hi:[0,1]
    v_pk_add_f32 v[50:51], v[50:51], v[14:15] op_sel_hi:[1,0] neg_lo:[0,1] neg_hi:[0,1]
    v_cvt_pk_bf16_f32 v46, v46, v47
    v_cvt_pk_bf16_f32 v48, v48, v49
    v_cvt_pk_bf16_f32 v50, v50, v51
    v_and_b32 v47, 0xffff0000, v46
    v_lshlrev_b32 v46, 16, v46
    v_and_b32 v49, 0xffff0000, v48
    v_lshlrev_b32 v48, 16, v48
    v_and_b32 v51, 0xffff0000, v50
    v_lshlrev_b32 v50, 16, v50
    v_pk_mul_f32 v[32:33], v[32:33], v[14:15] op_sel:[0,1]
    v_pk_mul_f32 v[34:35], v[34:35], v[14:15] op_sel:[0,1]
    v_pk_mul_f32 v[36:37], v[36:37], v[14:15] op_sel:[0,1]
    v_pk_mul_f32 v[38:39], v[38:39], v[14:15] op_sel:[0,1]
    v_pk_mul_f32 v[40:41], v[40:41], v[14:15] op_sel:[0,1]
    v_pk_mul_f32 v[42:43], v[42:43], v[14:15] op_sel:[0,1]
    v_pk_mul_f32 v[44:45], v[44:45], v[14:15] op_sel:[0,1]
    v_pk_mul_f32 v[46:47], v[46:47], v[14:15] op_sel:[0,1]
    v_pk_mul_f32 v[48:49], v[48:49], v[14:15] op_sel:[0,1]
    v_pk_mul_f32 v[50:51], v[50:51], v[14:15] op_sel:[0,1]
    v_cvt_pk_bf16_f32 v196, v32, v33
    v_cvt_pk_bf16_f32 v197, v34, v35
    v_cvt_pk_bf16_f32 v198, v36, v37
    v_cvt_pk_bf16_f32 v199, v38, v39
    v_cvt_pk_bf16_f32 v200, v40, v41
    v_cvt_pk_bf16_f32 v201, v42, v43
    v_cvt_pk_bf16_f32 v202, v44, v45
    v_cvt_pk_bf16_f32 v203, v46, v47
    v_cvt_pk_bf16_f32 v204, v48, v49
    v_cvt_pk_bf16_f32 v205, v50, v51
    s_mov_b64 exec, s[42:43]
    global_store_dwordx4 v52, v[196:199], s[18:19] sc1
    global_store_dwordx4 v52, v[200:203], s[18:19] offset:128 sc1
    s_mov_b32 exec_hi, 0
    global_store_dwordx2 v53, v[204:205], s[18:19] offset:256 sc1
    global_store_dwordx2 v55, v[244:245], s[18:19] offset:3200 sc1
    s_mov_b64 exec, s[42:43]
    global_store_dwordx4 v54, v[236:239], s[18:19] offset:3072 sc1
    global_store_dwordx4 v54, v[240:243], s[18:19] offset:3136 sc1
    s_branch L_x9
L_oslow:
    global_store_dwordx4 v5, v[32:35], s[18:19] sc1
    global_store_dwordx4 v5, v[36:39], s[18:19] offset:512 sc1
    s_mov_b32 exec_hi, 0
    global_store_dwordx2 v8, v[40:41], s[18:19] sc1
    s_branch L_odone
L_spin5:
    s_mov_b32 s41, 524288
L_spin5_l:
    ds_read_b32 v171, v170 offset:0
    s_waitcnt lgkmcnt(0)
    v_readfirstlane_b32 s12, v171
    s_cmp_ge_u32 s12, s35
    s_cbranch_scc1 L_spin5_ok
    s_sub_u32 s41, s41, 1
    s_cbranch_scc0 L_spin5_l
    s_branch L_spin5_ok
L_spin13:
    s_mov_b32 s41, 524288
L_spin13_l:
    ds_read_b32 v171, v170 offset:4
    s_waitcnt lgkmcnt(0)
    v_readfirstlane_b32 s12, v171
    s_cmp_ge_u32 s12, s35
    s_cbranch_scc1 L_spin13_ok
    s_sub_u32 s41, s41, 1
    s_cbranch_scc0 L_spin13_l
    s_branch L_spin13_ok
L_pslow:
    global_store_dwordx4 v20, v[8:11], s[18:19] sc1
    s_branch L_pdone
L_resld:
    s_mul_i32 s24, s4, 144
    v_lshl_add_u32 v11, v2, 4, s24
    v_min_u32 v12, 1, v2
    v_lshl_add_u32 v12, v12, 3, s24
    v_lshrrev_b32 v13, 5, v11
    v_mul_u32_u24 v13, 96, v13
    v_add_u32 v11, 3530752, v11
    v_add_u32 v11, v11, v13
    v_lshrrev_b32 v13, 5, v12
    v_mul_u32_u24 v13, 96, v13
    v_add_u32 v12, 3530752, v12
    v_add_u32 v12, v12, v13
    s_mov_b64 exec, s[42:43]
    global_load_dwordx4 v[220:223], v11, s[16:17] sc1
    global_load_dwordx4 v[224:227], v11, s[16:17] offset:256 sc1
    global_load_dwordx2 v[228:229], v12, s[16:17] offset:512 sc1
    s_mov_b64 exec, -1
    s_branch L_resldd
L_resfix:
    s_mov_b64 exec, s[42:43]
    s_waitcnt vmcnt(8)
    v_mov_b32 v236, v220
    v_mov_b32 v237, v221
    v_mov_b32 v238, v222
    v_mov_b32 v239, v223
    v_mov_b32 v240, v224
    v_mov_b32 v241, v225
    v_mov_b32 v242, v226
    v_mov_b32 v243, v227
    v_mov_b32 v244, v228
    v_mov_b32 v245, v229
    s_mov_b64 exec, -1
    s_branch L_resok
L_rl0:
    s_sub_u32 s40, s40, 1
    s_cmp_lt_i32 s40, 0
    s_cbranch_scc1 L_rb0
    s_sleep 1
    v_add_u32 v9, s56, v6
    global_load_dwordx4 v[24:27], v9, s[54:55] sc1
    s_add_u32 s12, s56, 1024
    s_sub_u32 s13, s12, 18432
    s_min_u32 s12, s12, s13
    v_add_u32 v10, s12, v6
    global_load_dwordx4 v[28:31], v10, s[54:55] sc1
    s_add_u32 s12, s56, 2048
    s_sub_u32 s13, s12, 18432
    s_min_u32 s12, s12, s13
    v_add_u32 v9, s12, v6
    global_load_dwordx4 v[32:35], v9, s[54:55] sc1
    s_waitcnt vmcnt(0)
    v_max3_u32 v11, v24, v25, v26
    v_max_u32 v11, v27, v11
    v_cmp_eq_u32 vcc, -1, v11
    s_cbranch_vccnz L_rl0
    s_branch L_rb0
L_rl1:
    s_sub_u32 s40, s40, 1
    s_cmp_lt_i32 s40, 0
    s_cbranch_scc1 L_rb1
    s_sleep 1
    s_add_u32 s12, s56, 1024
    s_sub_u32 s13, s12, 18432
    s_min_u32 s12, s12, s13
    v_add_u32 v10, s12, v6
    global_load_dwordx4 v[28:31], v10, s[54:55] sc1
    s_add_u32 s12, s56, 2048
    s_sub_u32 s13, s12, 18432
    s_min_u32 s12, s12, s13
    v_add_u32 v9, s12, v6
    global_load_dwordx4 v[32:35], v9, s[54:55] sc1
    s_add_u32 s12, s56, 3072
    s_sub_u32 s13, s12, 18432
    s_min_u32 s12, s12, s13
    v_add_u32 v10, s12, v6
    global_load_dwordx4 v[36:39], v10, s[54:55] sc1
    s_waitcnt vmcnt(0)
    v_max3_u32 v11, v28, v29, v30
    v_max_u32 v11, v31, v11
    v_cmp_eq_u32 vcc, -1, v11
    s_cbranch_vccnz L_rl1
    s_branch L_rb1
L_rl2:
    s_sub_u32 s40, s40, 1
    s_cmp_lt_i32 s40, 0
    s_cbranch_scc1 L_rb2
    s_sleep 1
    s_add_u32 s12, s56, 2048
    s_sub_u32 s13, s12, 18432
    s_min_u32 s12, s12, s13
    v_add_u32 v9, s12, v6
    global_load_dwordx4 v[32:35], v9, s[54:55] sc1
    s_add_u32 s12, s56, 3072
    s_sub_u32 s13, s12, 18432
    s_min_u32 s12, s12, s13
    v_add_u32 v10, s12, v6
    global_load_dwordx4 v[36:39], v10, s[54:55] sc1
    s_add_u32 s12, s56, 4096
    s_sub_u32 s13, s12, 18432
    s_min_u32 s12, s12, s13
    v_add_u32 v9, s12, v6
    global_load_dwordx4 v[40:43], v9, s[54:55] sc1
    s_waitcnt vmcnt(0)
    v_max3_u32 v11, v32, v33, v34
    v_max_u32 v11, v35, v11
    v_cmp_eq_u32 vcc, -1, v11
    s_cbranch_vccnz L_rl2
    s_branch L_rb2
L_rl3:
    s_sub_u32 s40, s40, 1
    s_cmp_lt_i32 s40, 0
    s_cbranch_scc1 L_rb3
    s_sleep 1
    s_add_u32 s12, s56, 3072
    s_sub_u32 s13, s12, 18432
    s_min_u32 s12, s12, s13
    v_add_u32 v10, s12, v6
    global_load_dwordx4 v[36:39], v10, s[54:55] sc1
    s_add_u32 s12, s56, 4096
    s_sub_u32 s13, s12, 18432
    s_min_u32 s12, s12, s13
    v_add_u32 v9, s12, v6
    global_load_dwordx4 v[40:43], v9, s[54:55] sc1
    s_add_u32 s12, s56, 5120
    s_sub_u32 s13, s12, 18432
    s_min_u32 s12, s12, s13
    v_add_u32 v10, s12, v6
    global_load_dwordx4 v[44:47], v10, s[54:55] sc1
    s_waitcnt vmcnt(0)
    v_max3_u32 v11, v36, v37, v38
    v_max_u32 v11, v39, v11
    v_cmp_eq_u32 vcc, -1, v11
    s_cbranch_vccnz L_rl3
    s_branch L_rb3
L_rl4:
    s_sub_u32 s40, s40, 1
    s_cmp_lt_i32 s40, 0
    s_cbranch_scc1 L_rb4
    s_sleep 1
    s_add_u32 s12, s56, 4096
    s_sub_u32 s13, s12, 18432
    s_min_u32 s12, s12, s13
    v_add_u32 v9, s12, v6
    global_load_dwordx4 v[40:43], v9, s[54:55] sc1
    s_add_u32 s12, s56, 5120
    s_sub_u32 s13, s12, 18432
    s_min_u32 s12, s12, s13
    v_add_u32 v10, s12, v6
    global_load_dwordx4 v[44:47], v10, s[54:55] sc1
    s_add_u32 s12, s56, 6144
    s_sub_u32 s13, s12, 18432
    s_min_u32 s12, s12, s13
    v_add_u32 v9, s12, v6
    global_load_dwordx4 v[48:51], v9, s[54:55] sc1
    s_waitcnt vmcnt(0)
    v_max3_u32 v11, v40, v41, v42
    v_max_u32 v11, v43, v11
    v_cmp_eq_u32 vcc, -1, v11
    s_cbranch_vccnz L_rl4
    s_branch L_rb4
L_rl5:
    s_sub_u32 s40, s40, 1
    s_cmp_lt_i32 s40, 0
    s_cbranch_scc1 L_rb5
    s_sleep 1
    s_add_u32 s12, s56, 5120
    s_sub_u32 s13, s12, 18432
    s_min_u32 s12, s12, s13
    v_add_u32 v10, s12, v6
    global_load_dwordx4 v[44:47], v10, s[54:55] sc1
    s_add_u32 s12, s56, 6144
    s_sub_u32 s13, s12, 18432
    s_min_u32 s12, s12, s13
    v_add_u32 v9, s12, v6
    global_load_dwordx4 v[48:51], v9, s[54:55] sc1
    s_add_u32 s12, s56, 7168
    s_sub_u32 s13, s12, 18432
    s_min_u32 s12, s12, s13
    v_add_u32 v10, s12, v6
    global_load_dwordx4 v[52:55], v10, s[54:55] sc1
    s_waitcnt vmcnt(0)
    v_max3_u32 v11, v44, v45, v46
    v_max_u32 v11, v47, v11
    v_cmp_eq_u32 vcc, -1, v11
    s_cbranch_vccnz L_rl5
    s_branch L_rb5
L_rl6:
    s_sub_u32 s40, s40, 1
    s_cmp_lt_i32 s40, 0
    s_cbranch_scc1 L_rb6
    s_sleep 1
    s_add_u32 s12, s56, 6144
    s_sub_u32 s13, s12, 18432
    s_min_u32 s12, s12, s13
    v_add_u32 v9, s12, v6
    global_load_dwordx4 v[48:51], v9, s[54:55] sc1
    s_add_u32 s12, s56, 7168
    s_sub_u32 s13, s12, 18432
    s_min_u32 s12, s12, s13
    v_add_u32 v10, s12, v6
    global_load_dwordx4 v[52:55], v10, s[54:55] sc1
    s_add_u32 s12, s56, 8192
    s_sub_u32 s13, s12, 18432
    s_min_u32 s12, s12, s13
    v_add_u32 v9, s12, v6
    global_load_dwordx4 v[56:59], v9, s[54:55] sc1
    s_waitcnt vmcnt(0)
    v_max3_u32 v11, v48, v49, v50
    v_max_u32 v11, v51, v11
    v_cmp_eq_u32 vcc, -1, v11
    s_cbranch_vccnz L_rl6
    s_branch L_rb6
L_rl7:
    s_sub_u32 s40, s40, 1
    s_cmp_lt_i32 s40, 0
    s_cbranch_scc1 L_rb7
    s_sleep 1
    s_add_u32 s12, s56, 7168
    s_sub_u32 s13, s12, 18432
    s_min_u32 s12, s12, s13
    v_add_u32 v10, s12, v6
    global_load_dwordx4 v[52:55], v10, s[54:55] sc1
    s_add_u32 s12, s56, 8192
    s_sub_u32 s13, s12, 18432
    s_min_u32 s12, s12, s13
    v_add_u32 v9, s12, v6
    global_load_dwordx4 v[56:59], v9, s[54:55] sc1
    s_add_u32 s12, s56, 9216
    s_sub_u32 s13, s12, 18432
    s_min_u32 s12, s12, s13
    v_add_u32 v10, s12, v6
    global_load_dwordx4 v[60:63], v10, s[54:55] sc1
    s_waitcnt vmcnt(0)
    v_max3_u32 v11, v52, v53, v54
    v_max_u32 v11, v55, v11
    v_cmp_eq_u32 vcc, -1, v11
    s_cbranch_vccnz L_rl7
    s_branch L_rb7
L_rl8:
    s_sub_u32 s40, s40, 1
    s_cmp_lt_i32 s40, 0
    s_cbranch_scc1 L_rb8
    s_sleep 1
    s_add_u32 s12, s56, 8192
    s_sub_u32 s13, s12, 18432
    s_min_u32 s12, s12, s13
    v_add_u32 v9, s12, v6
    global_load_dwordx4 v[56:59], v9, s[54:55] sc1
    s_add_u32 s12, s56, 9216
    s_sub_u32 s13, s12, 18432
    s_min_u32 s12, s12, s13
    v_add_u32 v10, s12, v6
    global_load_dwordx4 v[60:63], v10, s[54:55] sc1
    s_add_u32 s12, s56, 10240
    s_sub_u32 s13, s12, 18432
    s_min_u32 s12, s12, s13
    v_add_u32 v9, s12, v6
    global_load_dwordx4 v[64:67], v9, s[54:55] sc1
    s_waitcnt vmcnt(0)
    v_max3_u32 v11, v56, v57, v58
    v_max_u32 v11, v59, v11
    v_cmp_eq_u32 vcc, -1, v11
    s_cbranch_vccnz L_rl8
    s_branch L_rb8
L_rl9:
    s_sub_u32 s40, s40, 1
    s_cmp_lt_i32 s40, 0
    s_cbranch_scc1 L_rb9
    s_sleep 1
    s_add_u32 s12, s56, 9216
    s_sub_u32 s13, s12, 18432
    s_min_u32 s12, s12, s13
    v_add_u32 v10, s12, v6
    global_load_dwordx4 v[60:63], v10, s[54:55] sc1
    s_add_u32 s12, s56, 10240
    s_sub_u32 s13, s12, 18432
    s_min_u32 s12, s12, s13
    v_add_u32 v9, s12, v6
    global_load_dwordx4 v[64:67], v9, s[54:55] sc1
    s_add_u32 s12, s56, 11264
    s_sub_u32 s13, s12, 18432
    s_min_u32 s12, s12, s13
    v_add_u32 v10, s12, v6
    global_load_dwordx4 v[68:71], v10, s[54:55] sc1
    s_waitcnt vmcnt(0)
    v_max3_u32 v11, v60, v61, v62
    v_max_u32 v11, v63, v11
    v_cmp_eq_u32 vcc, -1, v11
    s_cbranch_vccnz L_rl9
    s_branch L_rb9
L_rl10:
    s_sub_u32 s40, s40, 1
    s_cmp_lt_i32 s40, 0
    s_cbranch_scc1 L_rb10
    s_sleep 1
    s_add_u32 s12, s56, 10240
    s_sub_u32 s13, s12, 18432
    s_min_u32 s12, s12, s13
    v_add_u32 v9, s12, v6
    global_load_dwordx4 v[64:67], v9, s[54:55] sc1
    s_add_u32 s12, s56, 11264
    s_sub_u32 s13, s12, 18432
    s_min_u32 s12, s12, s13
    v_add_u32 v10, s12, v6
    global_load_dwordx4 v[68:71], v10, s[54:55] sc1
    s_add_u32 s12, s56, 12288
    s_sub_u32 s13, s12, 18432
    s_min_u32 s12, s12, s13
    v_add_u32 v9, s12, v6
    global_load_dwordx4 v[72:75], v9, s[54:55] sc1
    s_waitcnt vmcnt(0)
    v_max3_u32 v11, v64, v65, v66
    v_max_u32 v11, v67, v11
    v_cmp_eq_u32 vcc, -1, v11
    s_cbranch_vccnz L_rl10
    s_branch L_rb10
L_rl11:
    s_sub_u32 s40, s40, 1
    s_cmp_lt_i32 s40, 0
    s_cbranch_scc1 L_rb11
    s_sleep 1
    s_add_u32 s12, s56, 11264
    s_sub_u32 s13, s12, 18432
    s_min_u32 s12, s12, s13
    v_add_u32 v10, s12, v6
    global_load_dwordx4 v[68:71], v10, s[54:55] sc1
    s_add_u32 s12, s56, 12288
    s_sub_u32 s13, s12, 18432
    s_min_u32 s12, s12, s13
    v_add_u32 v9, s12, v6
    global_load_dwordx4 v[72:75], v9, s[54:55] sc1
    s_add_u32 s12, s56, 13312
    s_sub_u32 s13, s12, 18432
    s_min_u32 s12, s12, s13
    v_add_u32 v10, s12, v6
    global_load_dwordx4 v[76:79], v10, s[54:55] sc1
    s_waitcnt vmcnt(0)
    v_max3_u32 v11, v68, v69, v70
    v_max_u32 v11, v71, v11
    v_cmp_eq_u32 vcc, -1, v11
    s_cbranch_vccnz L_rl11
    s_branch L_rb11
L_rl12:
    s_sub_u32 s40, s40, 1
    s_cmp_lt_i32 s40, 0
    s_cbranch_scc1 L_rb12
    s_sleep 1
    s_add_u32 s12, s56, 12288
    s_sub_u32 s13, s12, 18432
    s_min_u32 s12, s12, s13
    v_add_u32 v9, s12, v6
    global_load_dwordx4 v[72:75], v9, s[54:55] sc1
    s_add_u32 s12, s56, 13312
    s_sub_u32 s13, s12, 18432
    s_min_u32 s12, s12, s13
    v_add_u32 v10, s12, v6
    global_load_dwordx4 v[76:79], v10, s[54:55] sc1
    s_add_u32 s12, s56, 14336
    s_sub_u32 s13, s12, 18432
    s_min_u32 s12, s12, s13
    v_add_u32 v9, s12, v6
    global_load_dwordx4 v[80:83], v9, s[54:55] sc1
    s_waitcnt vmcnt(0)
    v_max3_u32 v11, v72, v73, v74
    v_max_u32 v11, v75, v11
    v_cmp_eq_u32 vcc, -1, v11
    s_cbranch_vccnz L_rl12
    s_branch L_rb12
L_rl13:
    s_sub_u32 s40, s40, 1
    s_cmp_lt_i32 s40, 0
    s_cbranch_scc1 L_rb13
    s_sleep 1
    s_add_u32 s12, s56, 13312
    s_sub_u32 s13, s12, 18432
    s_min_u32 s12, s12, s13
    v_add_u32 v10, s12, v6
    global_load_dwordx4 v[76:79], v10, s[54:55] sc1
    s_add_u32 s12, s56, 14336
    s_sub_u32 s13, s12, 18432
    s_min_u32 s12, s12, s13
    v_add_u32 v9, s12, v6
    global_load_dwordx4 v[80:83], v9, s[54:55] sc1
    s_add_u32 s12, s56, 15360
    s_sub_u32 s13, s12, 18432
    s_min_u32 s12, s12, s13
    v_add_u32 v10, s12, v6
    global_load_dwordx4 v[84:87], v10, s[54:55] sc1
    s_waitcnt vmcnt(0)
    v_max3_u32 v11, v76, v77, v78
    v_max_u32 v11, v79, v11
    v_cmp_eq_u32 vcc, -1, v11
    s_cbranch_vccnz L_rl13
    s_branch L_rb13
L_rl14:
    s_sub_u32 s40, s40, 1
    s_cmp_lt_i32 s40, 0
    s_cbranch_scc1 L_rb14
    s_sleep 1
    s_add_u32 s12, s56, 14336
    s_sub_u32 s13, s12, 18432
    s_min_u32 s12, s12, s13
    v_add_u32 v9, s12, v6
    global_load_dwordx4 v[80:83], v9, s[54:55] sc1
    s_add_u32 s12, s56, 15360
    s_sub_u32 s13, s12, 18432
    s_min_u32 s12, s12, s13
    v_add_u32 v10, s12, v6
    global_load_dwordx4 v[84:87], v10, s[54:55] sc1
    s_add_u32 s12, s56, 16384
    s_sub_u32 s13, s12, 18432
    s_min_u32 s12, s12, s13
    v_add_u32 v9, s12, v6
    global_load_dwordx4 v[88:91], v9, s[54:55] sc1
    s_waitcnt vmcnt(0)
    v_max3_u32 v11, v80, v81, v82
    v_max_u32 v11, v83, v11
    v_cmp_eq_u32 vcc, -1, v11
    s_cbranch_vccnz L_rl14
    s_branch L_rb14
L_rl15:
    s_sub_u32 s40, s40, 1
    s_cmp_lt_i32 s40, 0
    s_cbranch_scc1 L_rb15
    s_sleep 1
    s_add_u32 s12, s56, 15360
    s_sub_u32 s13, s12, 18432
    s_min_u32 s12, s12, s13
    v_add_u32 v10, s12, v6
    global_load_dwordx4 v[84:87], v10, s[54:55] sc1
    s_add_u32 s12, s56, 16384
    s_sub_u32 s13, s12, 18432
    s_min_u32 s12, s12, s13
    v_add_u32 v9, s12, v6
    global_load_dwordx4 v[88:91], v9, s[54:55] sc1
    s_add_u32 s12, s56, 17408
    s_sub_u32 s13, s12, 18432
    s_min_u32 s12, s12, s13
    v_add_u32 v10, s12, v6
    global_load_dwordx4 v[92:95], v10, s[54:55] sc1
    s_waitcnt vmcnt(0)
    v_max3_u32 v11, v84, v85, v86
    v_max_u32 v11, v87, v11
    v_cmp_eq_u32 vcc, -1, v11
    s_cbranch_vccnz L_rl15
    s_branch L_rb15
L_rl16:
    s_sub_u32 s40, s40, 1
    s_cmp_lt_i32 s40, 0
    s_cbranch_scc1 L_rb16
    s_sleep 1
    s_add_u32 s12, s56, 16384
    s_sub_u32 s13, s12, 18432
    s_min_u32 s12, s12, s13
    v_add_u32 v9, s12, v6
    global_load_dwordx4 v[88:91], v9, s[54:55] sc1
    s_add_u32 s12, s56, 17408
    s_sub_u32 s13, s12, 18432
    s_min_u32 s12, s12, s13
    v_add_u32 v10, s12, v6
    global_load_dwordx4 v[92:95], v10, s[54:55] sc1
    s_waitcnt vmcnt(0)
    v_max3_u32 v11, v88, v89, v90
    v_max_u32 v11, v91, v11
    v_cmp_eq_u32 vcc, -1, v11
    s_cbranch_vccnz L_rl16
    s_branch L_rb16
L_rl17:
    s_sub_u32 s40, s40, 1
    s_cmp_lt_i32 s40, 0
    s_cbranch_scc1 L_rb17
    s_sleep 1
    s_add_u32 s12, s56, 17408
    s_sub_u32 s13, s12, 18432
    s_min_u32 s12, s12, s13
    v_add_u32 v10, s12, v6
    global_load_dwordx4 v[92:95], v10, s[54:55] sc1
    s_waitcnt vmcnt(0)
    v_max3_u32 v11, v92, v93, v94
    v_max_u32 v11, v95, v11
    v_cmp_eq_u32 vcc, -1, v11
    s_cbranch_vccnz L_rl17
    s_branch L_rb17
L_slow:
    v_lshlrev_b32 v9, 2, v1
    v_mov_b32 v128, 0xff800000
    v_mov_b32 v130, 0xff800000
    s_add_u32 s20, s16, s39
    s_addc_u32 s21, s17, 0
    s_mov_b32 s11, 0
L_sl0:
    s_add_u32 s22, s20, 8192
    s_addc_u32 s23, s21, 0
    global_load_dword v144, v9, s[22:23] offset:0 sc1
    global_load_dword v145, v9, s[22:23] offset:256 sc1
    global_load_dword v146, v9, s[22:23] offset:512 sc1
    global_load_dword v147, v9, s[22:23] offset:768 sc1
    s_add_u32 s22, s20, 0
    s_addc_u32 s23, s21, 0
    global_load_dwordx4 v[136:139], v6, s[22:23] sc1
    s_waitcnt vmcnt(0)
    v_mfma_f32_32x32x16_bf16 v[96:111], v[136:139], v[176:179], 0
    v_mfma_f32_32x32x16_bf16 v[112:127], v[136:139], v[180:183], 0
    s_nop 7
    s_nop 1
    v_mfma_f32_32x32x8_bf16 v[96:111], v[144:145], v[216:217], v[96:111]
    v_mfma_f32_32x32x8_bf16 v[112:127], v[144:145], v[224:225], v[112:127]
    s_nop 10
    v_max3_f32 v128, v96, v97, v128
    v_max3_f32 v128, v98, v99, v128
    v_max3_f32 v128, v100, v101, v128
    v_max3_f32 v128, v102, v103, v128
    v_max3_f32 v128, v104, v105, v128
    v_max3_f32 v128, v106, v107, v128
    v_max3_f32 v128, v108, v109, v128
    v_max3_f32 v128, v110, v111, v128
    v_max3_f32 v130, v112, v113, v130
    v_max3_f32 v130, v114, v115, v130
    v_max3_f32 v130, v116, v117, v130
    v_max3_f32 v130, v118, v119, v130
    v_max3_f32 v130, v120, v121, v130
    v_max3_f32 v130, v122, v123, v130
    v_max3_f32 v130, v124, v125, v130
    v_max3_f32 v130, v126, v127, v130
    s_add_u32 s22, s20, 1024
    s_addc_u32 s23, s21, 0
    global_load_dwordx4 v[140:143], v6, s[22:23] sc1
    s_waitcnt vmcnt(0)
    v_mfma_f32_32x32x16_bf16 v[96:111], v[140:143], v[176:179], 0
    v_mfma_f32_32x32x16_bf16 v[112:127], v[140:143], v[180:183], 0
    s_nop 7
    s_nop 1
    v_mfma_f32_32x32x8_bf16 v[96:111], v[144:145], v[220:221], v[96:111]
    v_mfma_f32_32x32x8_bf16 v[112:127], v[144:145], v[228:229], v[112:127]
    s_nop 10
    v_max3_f32 v128, v96, v97, v128
    v_max3_f32 v128, v98, v99, v128
    v_max3_f32 v128, v100, v101, v128
    v_max3_f32 v128, v102, v103, v128
    v_max3_f32 v128, v104, v105, v128
    v_max3_f32 v128, v106, v107, v128
    v_max3_f32 v128, v108, v109, v128
    v_max3_f32 v128, v110, v111, v128
    v_max3_f32 v130, v112, v113, v130
    v_max3_f32 v130, v114, v115, v130
    v_max3_f32 v130, v116, v117, v130
    v_max3_f32 v130, v118, v119, v130
    v_max3_f32 v130, v120, v121, v130
    v_max3_f32 v130, v122, v123, v130
    v_max3_f32 v130, v124, v125, v130
    v_max3_f32 v130, v126, v127, v130
    s_add_u32 s22, s20, 2048
    s_addc_u32 s23, s21, 0
    global_load_dwordx4 v[136:139], v6, s[22:23] sc1
    s_waitcnt vmcnt(0)
    v_mfma_f32_32x32x16_bf16 v[96:111], v[136:139], v[176:179], 0
    v_mfma_f32_32x32x16_bf16 v[112:127], v[136:139], v[180:183], 0
    s_nop 7
    s_nop 1
    v_mfma_f32_32x32x8_bf16 v[96:111], v[144:145], v[218:219], v[96:111]
    v_mfma_f32_32x32x8_bf16 v[112:127], v[144:145], v[226:227], v[112:127]
    s_nop 10
    v_max3_f32 v128, v96, v97, v128
    v_max3_f32 v128, v98, v99, v128
    v_max3_f32 v128, v100, v101, v128
    v_max3_f32 v128, v102, v103, v128
    v_max3_f32 v128, v104, v105, v128
    v_max3_f32 v128, v106, v107, v128
    v_max3_f32 v128, v108, v109, v128
    v_max3_f32 v128, v110, v111, v128
    v_max3_f32 v130, v112, v113, v130
    v_max3_f32 v130, v114, v115, v130
    v_max3_f32 v130, v116, v117, v130
    v_max3_f32 v130, v118, v119, v130
    v_max3_f32 v130, v120, v121, v130
    v_max3_f32 v130, v122, v123, v130
    v_max3_f32 v130, v124, v125, v130
    v_max3_f32 v130, v126, v127, v130
    s_add_u32 s22, s20, 3072
    s_addc_u32 s23, s21, 0
    global_load_dwordx4 v[140:143], v6, s[22:23] sc1
    s_waitcnt vmcnt(0)
    v_mfma_f32_32x32x16_bf16 v[96:111], v[140:143], v[176:179], 0
    v_mfma_f32_32x32x16_bf16 v[112:127], v[140:143], v[180:183], 0
    s_nop 7
    s_nop 1
    v_mfma_f32_32x32x8_bf16 v[96:111], v[144:145], v[222:223], v[96:111]
    v_mfma_f32_32x32x8_bf16 v[112:127], v[144:145], v[230:231], v[112:127]
    s_nop 10
    v_max3_f32 v128, v96, v97, v128
    v_max3_f32 v128, v98, v99, v128
    v_max3_f32 v128, v100, v101, v128
    v_max3_f32 v128, v102, v103, v128
    v_max3_f32 v128, v104, v105, v128
    v_max3_f32 v128, v106, v107, v128
    v_max3_f32 v128, v108, v109, v128
    v_max3_f32 v128, v110, v111, v128
    v_max3_f32 v130, v112, v113, v130
    v_max3_f32 v130, v114, v115, v130
    v_max3_f32 v130, v116, v117, v130
    v_max3_f32 v130, v118, v119, v130
    v_max3_f32 v130, v120, v121, v130
    v_max3_f32 v130, v122, v123, v130
    v_max3_f32 v130, v124, v125, v130
    v_max3_f32 v130, v126, v127, v130
    s_add_u32 s22, s20, 4096
    s_addc_u32 s23, s21, 0
    global_load_dwordx4 v[136:139], v6, s[22:23] sc1
    s_waitcnt vmcnt(0)
    v_mfma_f32_32x32x16_bf16 v[96:111], v[136:139], v[176:179], 0
    v_mfma_f32_32x32x16_bf16 v[112:127], v[136:139], v[180:183], 0
    s_nop 7
    s_nop 1
    v_mfma_f32_32x32x8_bf16 v[96:111], v[146:147], v[216:217], v[96:111]
    v_mfma_f32_32x32x8_bf16 v[112:127], v[146:147], v[224:225], v[112:127]
    s_nop 10
    v_max3_f32 v128, v96, v97, v128
    v_max3_f32 v128, v98, v99, v128
    v_max3_f32 v128, v100, v101, v128
    v_max3_f32 v128, v102, v103, v128
    v_max3_f32 v128, v104, v105, v128
    v_max3_f32 v128, v106, v107, v128
    v_max3_f32 v128, v108, v109, v128
    v_max3_f32 v128, v110, v111, v128
    v_max3_f32 v130, v112, v113, v130
    v_max3_f32 v130, v114, v115, v130
    v_max3_f32 v130, v116, v117, v130
    v_max3_f32 v130, v118, v119, v130
    v_max3_f32 v130, v120, v121, v130
    v_max3_f32 v130, v122, v123, v130
    v_max3_f32 v130, v124, v125, v130
    v_max3_f32 v130, v126, v127, v130
    s_add_u32 s22, s20, 5120
    s_addc_u32 s23, s21, 0
    global_load_dwordx4 v[140:143], v6, s[22:23] sc1
    s_waitcnt vmcnt(0)
    v_mfma_f32_32x32x16_bf16 v[96:111], v[140:143], v[176:179], 0
    v_mfma_f32_32x32x16_bf16 v[112:127], v[140:143], v[180:183], 0
    s_nop 7
    s_nop 1
    v_mfma_f32_32x32x8_bf16 v[96:111], v[146:147], v[220:221], v[96:111]
    v_mfma_f32_32x32x8_bf16 v[112:127], v[146:147], v[228:229], v[112:127]
    s_nop 10
    v_max3_f32 v128, v96, v97, v128
    v_max3_f32 v128, v98, v99, v128
    v_max3_f32 v128, v100, v101, v128
    v_max3_f32 v128, v102, v103, v128
    v_max3_f32 v128, v104, v105, v128
    v_max3_f32 v128, v106, v107, v128
    v_max3_f32 v128, v108, v109, v128
    v_max3_f32 v128, v110, v111, v128
    v_max3_f32 v130, v112, v113, v130
    v_max3_f32 v130, v114, v115, v130
    v_max3_f32 v130, v116, v117, v130
    v_max3_f32 v130, v118, v119, v130
    v_max3_f32 v130, v120, v121, v130
    v_max3_f32 v130, v122, v123, v130
    v_max3_f32 v130, v124, v125, v130
    v_max3_f32 v130, v126, v127, v130
    s_add_u32 s22, s20, 6144
    s_addc_u32 s23, s21, 0
    global_load_dwordx4 v[136:139], v6, s[22:23] sc1
    s_waitcnt vmcnt(0)
    v_mfma_f32_32x32x16_bf16 v[96:111], v[136:139], v[176:179], 0
    v_mfma_f32_32x32x16_bf16 v[112:127], v[136:139], v[180:183], 0
    s_nop 7
    s_nop 1
    v_mfma_f32_32x32x8_bf16 v[96:111], v[146:147], v[218:219], v[96:111]
    v_mfma_f32_32x32x8_bf16 v[112:127], v[146:147], v[226:227], v[112:127]
    s_nop 10
    v_max3_f32 v128, v96, v97, v128
    v_max3_f32 v128, v98, v99, v128
    v_max3_f32 v128, v100, v101, v128
    v_max3_f32 v128, v102, v103, v128
    v_max3_f32 v128, v104, v105, v128
    v_max3_f32 v128, v106, v107, v128
    v_max3_f32 v128, v108, v109, v128
    v_max3_f32 v128, v110, v111, v128
    v_max3_f32 v130, v112, v113, v130
    v_max3_f32 v130, v114, v115, v130
    v_max3_f32 v130, v116, v117, v130
    v_max3_f32 v130, v118, v119, v130
    v_max3_f32 v130, v120, v121, v130
    v_max3_f32 v130, v122, v123, v130
    v_max3_f32 v130, v124, v125, v130
    v_max3_f32 v130, v126, v127, v130
    s_add_u32 s22, s20, 7168
    s_addc_u32 s23, s21, 0
    global_load_dwordx4 v[140:143], v6, s[22:23] sc1
    s_waitcnt vmcnt(0)
    v_mfma_f32_32x32x16_bf16 v[96:111], v[140:143], v[176:179], 0
    v_mfma_f32_32x32x16_bf16 v[112:127], v[140:143], v[180:183], 0
    s_nop 7
    s_nop 1
    v_mfma_f32_32x32x8_bf16 v[96:111], v[146:147], v[222:223], v[96:111]
    v_mfma_f32_32x32x8_bf16 v[112:127], v[146:147], v[230:231], v[112:127]
    s_nop 10
    v_max3_f32 v128, v96, v97, v128
    v_max3_f32 v128, v98, v99, v128
    v_max3_f32 v128, v100, v101, v128
    v_max3_f32 v128, v102, v103, v128
    v_max3_f32 v128, v104, v105, v128
    v_max3_f32 v128, v106, v107, v128
    v_max3_f32 v128, v108, v109, v128
    v_max3_f32 v128, v110, v111, v128
    v_max3_f32 v130, v112, v113, v130
    v_max3_f32 v130, v114, v115, v130
    v_max3_f32 v130, v116, v117, v130
    v_max3_f32 v130, v118, v119, v130
    v_max3_f32 v130, v120, v121, v130
    v_max3_f32 v130, v122, v123, v130
    v_max3_f32 v130, v124, v125, v130
    v_max3_f32 v130, v126, v127, v130
    s_add_u32 s20, s20, 19456
    s_addc_u32 s21, s21, 0
    s_add_u32 s11, s11, 1
    s_cmp_lt_u32 s11, 8
    s_nop 7
    s_nop 7
    s_cbranch_scc1 L_sl0
    v_mov_b32 v129, v128
    s_nop 1
    v_permlane32_swap_b32 v128, v129
    v_max_f32 v128, v128, v129
    v_sub_f32 v32, 0, v128
    v_mov_b32 v64, 0
    v_sub_f32 v33, 0, v128
    v_mov_b32 v65, 0
    v_sub_f32 v34, 0, v128
    v_mov_b32 v66, 0
    v_sub_f32 v35, 0, v128
    v_mov_b32 v67, 0
    v_sub_f32 v36, 0, v128
    v_mov_b32 v68, 0
    v_sub_f32 v37, 0, v128
    v_mov_b32 v69, 0
    v_sub_f32 v38, 0, v128
    v_mov_b32 v70, 0
    v_sub_f32 v39, 0, v128
    v_mov_b32 v71, 0
    v_sub_f32 v40, 0, v128
    v_mov_b32 v72, 0
    v_sub_f32 v41, 0, v128
    v_mov_b32 v73, 0
    v_sub_f32 v42, 0, v128
    v_mov_b32 v74, 0
    v_sub_f32 v43, 0, v128
    v_mov_b32 v75, 0
    v_sub_f32 v44, 0, v128
    v_mov_b32 v76, 0
    v_sub_f32 v45, 0, v128
    v_mov_b32 v77, 0
    v_sub_f32 v46, 0, v128
    v_mov_b32 v78, 0
    v_sub_f32 v47, 0, v128
    v_mov_b32 v79, 0
    v_mov_b32 v129, v130
    s_nop 1
    v_permlane32_swap_b32 v130, v129
    v_max_f32 v130, v130, v129
    v_sub_f32 v48, 0, v130
    v_mov_b32 v80, 0
    v_sub_f32 v49, 0, v130
    v_mov_b32 v81, 0
    v_sub_f32 v50, 0, v130
    v_mov_b32 v82, 0
    v_sub_f32 v51, 0, v130
    v_mov_b32 v83, 0
    v_sub_f32 v52, 0, v130
    v_mov_b32 v84, 0
    v_sub_f32 v53, 0, v130
    v_mov_b32 v85, 0
    v_sub_f32 v54, 0, v130
    v_mov_b32 v86, 0
    v_sub_f32 v55, 0, v130
    v_mov_b32 v87, 0
    v_sub_f32 v56, 0, v130
    v_mov_b32 v88, 0
    v_sub_f32 v57, 0, v130
    v_mov_b32 v89, 0
    v_sub_f32 v58, 0, v130
    v_mov_b32 v90, 0
    v_sub_f32 v59, 0, v130
    v_mov_b32 v91, 0
    v_sub_f32 v60, 0, v130
    v_mov_b32 v92, 0
    v_sub_f32 v61, 0, v130
    v_mov_b32 v93, 0
    v_sub_f32 v62, 0, v130
    v_mov_b32 v94, 0
    v_sub_f32 v63, 0, v130
    v_mov_b32 v95, 0
    s_add_u32 s20, s16, s39
    s_addc_u32 s21, s17, 0
    s_mov_b32 s11, 0
L_sl1:
    s_add_u32 s22, s20, 8192
    s_addc_u32 s23, s21, 0
    global_load_dword v144, v9, s[22:23] offset:0 sc1
    global_load_dword v145, v9, s[22:23] offset:256 sc1
    global_load_dword v146, v9, s[22:23] offset:512 sc1
    global_load_dword v147, v9, s[22:23] offset:768 sc1
    s_add_u32 s22, s20, 0
    s_addc_u32 s23, s21, 0
    global_load_dwordx4 v[136:139], v6, s[22:23] sc1
    s_add_u32 s22, s20, 9216
    s_addc_u32 s23, s21, 0
    global_load_dwordx4 v[148:151], v16, s[22:23] sc1
    global_load_dwordx4 v[152:155], v16, s[22:23] offset:640 sc1
    s_waitcnt vmcnt(0)
    v_mfma_f32_32x32x16_bf16 v[96:111], v[136:139], v[176:179], v[32:47]
    v_mfma_f32_32x32x16_bf16 v[112:127], v[136:139], v[180:183], v[48:63]
    s_nop 7
    s_nop 1
    v_mfma_f32_32x32x8_bf16 v[96:111], v[144:145], v[216:217], v[96:111]
    v_mfma_f32_32x32x8_bf16 v[112:127], v[144:145], v[224:225], v[112:127]
    s_nop 10
    v_exp_f32 v96, v96
    v_exp_f32 v97, v97
    v_exp_f32 v98, v98
    v_exp_f32 v99, v99
    v_exp_f32 v100, v100
    v_exp_f32 v101, v101
    v_exp_f32 v102, v102
    v_exp_f32 v103, v103
    v_exp_f32 v104, v104
    v_exp_f32 v105, v105
    v_exp_f32 v106, v106
    v_exp_f32 v107, v107
    v_exp_f32 v108, v108
    v_exp_f32 v109, v109
    v_exp_f32 v110, v110
    v_exp_f32 v111, v111
    v_cvt_pk_bf16_f32 v128, v96, v97
    v_cvt_pk_bf16_f32 v129, v98, v99
    v_cvt_pk_bf16_f32 v130, v100, v101
    v_cvt_pk_bf16_f32 v131, v102, v103
    v_cvt_pk_bf16_f32 v132, v104, v105
    v_cvt_pk_bf16_f32 v133, v106, v107
    v_cvt_pk_bf16_f32 v134, v108, v109
    v_cvt_pk_bf16_f32 v135, v110, v111
    v_mfma_f32_32x32x16_bf16 v[64:79], v[148:151], v[128:131], v[64:79]
    s_nop 0
    v_mfma_f32_32x32x16_bf16 v[64:79], v[152:155], v[132:135], v[64:79]
    v_exp_f32 v112, v112
    v_exp_f32 v113, v113
    v_exp_f32 v114, v114
    v_exp_f32 v115, v115
    v_exp_f32 v116, v116
    v_exp_f32 v117, v117
    v_exp_f32 v118, v118
    v_exp_f32 v119, v119
    v_exp_f32 v120, v120
    v_exp_f32 v121, v121
    v_exp_f32 v122, v122
    v_exp_f32 v123, v123
    v_exp_f32 v124, v124
    v_exp_f32 v125, v125
    v_exp_f32 v126, v126
    v_exp_f32 v127, v127
    v_cvt_pk_bf16_f32 v128, v112, v113
    v_cvt_pk_bf16_f32 v129, v114, v115
    v_cvt_pk_bf16_f32 v130, v116, v117
    v_cvt_pk_bf16_f32 v131, v118, v119
    v_cvt_pk_bf16_f32 v132, v120, v121
    v_cvt_pk_bf16_f32 v133, v122, v123
    v_cvt_pk_bf16_f32 v134, v124, v125
    v_cvt_pk_bf16_f32 v135, v126, v127
    v_mfma_f32_32x32x16_bf16 v[80:95], v[148:151], v[128:131], v[80:95]
    s_nop 0
    v_mfma_f32_32x32x16_bf16 v[80:95], v[152:155], v[132:135], v[80:95]
    s_add_u32 s22, s20, 1024
    s_addc_u32 s23, s21, 0
    global_load_dwordx4 v[140:143], v6, s[22:23] sc1
    s_add_u32 s22, s20, 10496
    s_addc_u32 s23, s21, 0
    global_load_dwordx4 v[156:159], v16, s[22:23] sc1
    global_load_dwordx4 v[160:163], v16, s[22:23] offset:640 sc1
    s_waitcnt vmcnt(0)
    v_mfma_f32_32x32x16_bf16 v[96:111], v[140:143], v[176:179], v[32:47]
    v_mfma_f32_32x32x16_bf16 v[112:127], v[140:143], v[180:183], v[48:63]
    s_nop 7
    s_nop 1
    v_mfma_f32_32x32x8_bf16 v[96:111], v[144:145], v[220:221], v[96:111]
    v_mfma_f32_32x32x8_bf16 v[112:127], v[144:145], v[228:229], v[112:127]
    s_nop 10
    v_exp_f32 v96, v96
    v_exp_f32 v97, v97
    v_exp_f32 v98, v98
    v_exp_f32 v99, v99
    v_exp_f32 v100, v100
    v_exp_f32 v101, v101
    v_exp_f32 v102, v102
    v_exp_f32 v103, v103
    v_exp_f32 v104, v104
    v_exp_f32 v105, v105
    v_exp_f32 v106, v106
    v_exp_f32 v107, v107
    v_exp_f32 v108, v108
    v_exp_f32 v109, v109
    v_exp_f32 v110, v110
    v_exp_f32 v111, v111
    v_cvt_pk_bf16_f32 v128, v96, v97
    v_cvt_pk_bf16_f32 v129, v98, v99
    v_cvt_pk_bf16_f32 v130, v100, v101
    v_cvt_pk_bf16_f32 v131, v102, v103
    v_cvt_pk_bf16_f32 v132, v104, v105
    v_cvt_pk_bf16_f32 v133, v106, v107
    v_cvt_pk_bf16_f32 v134, v108, v109
    v_cvt_pk_bf16_f32 v135, v110, v111
    v_mfma_f32_32x32x16_bf16 v[64:79], v[156:159], v[128:131], v[64:79]
    s_nop 0
    v_mfma_f32_32x32x16_bf16 v[64:79], v[160:163], v[132:135], v[64:79]
    v_exp_f32 v112, v112
    v_exp_f32 v113, v113
    v_exp_f32 v114, v114
    v_exp_f32 v115, v115
    v_exp_f32 v116, v116
    v_exp_f32 v117, v117
    v_exp_f32 v118, v118
    v_exp_f32 v119, v119
    v_exp_f32 v120, v120
    v_exp_f32 v121, v121
    v_exp_f32 v122, v122
    v_exp_f32 v123, v123
    v_exp_f32 v124, v124
    v_exp_f32 v125, v125
    v_exp_f32 v126, v126
    v_exp_f32 v127, v127
    v_cvt_pk_bf16_f32 v128, v112, v113
    v_cvt_pk_bf16_f32 v129, v114, v115
    v_cvt_pk_bf16_f32 v130, v116, v117
    v_cvt_pk_bf16_f32 v131, v118, v119
    v_cvt_pk_bf16_f32 v132, v120, v121
    v_cvt_pk_bf16_f32 v133, v122, v123
    v_cvt_pk_bf16_f32 v134, v124, v125
    v_cvt_pk_bf16_f32 v135, v126, v127
    v_mfma_f32_32x32x16_bf16 v[80:95], v[156:159], v[128:131], v[80:95]
    s_nop 0
    v_mfma_f32_32x32x16_bf16 v[80:95], v[160:163], v[132:135], v[80:95]
    s_add_u32 s22, s20, 2048
    s_addc_u32 s23, s21, 0
    global_load_dwordx4 v[136:139], v6, s[22:23] sc1
    s_add_u32 s22, s20, 11776
    s_addc_u32 s23, s21, 0
    global_load_dwordx4 v[148:151], v16, s[22:23] sc1
    global_load_dwordx4 v[152:155], v16, s[22:23] offset:640 sc1
    s_waitcnt vmcnt(0)
    v_mfma_f32_32x32x16_bf16 v[96:111], v[136:139], v[176:179], v[32:47]
    v_mfma_f32_32x32x16_bf16 v[112:127], v[136:139], v[180:183], v[48:63]
    s_nop 7
    s_nop 1
    v_mfma_f32_32x32x8_bf16 v[96:111], v[144:145], v[218:219], v[96:111]
    v_mfma_f32_32x32x8_bf16 v[112:127], v[144:145], v[226:227], v[112:127]
    s_nop 10
    v_exp_f32 v96, v96
    v_exp_f32 v97, v97
    v_exp_f32 v98, v98
    v_exp_f32 v99, v99
    v_exp_f32 v100, v100
    v_exp_f32 v101, v101
    v_exp_f32 v102, v102
    v_exp_f32 v103, v103
    v_exp_f32 v104, v104
    v_exp_f32 v105, v105
    v_exp_f32 v106, v106
    v_exp_f32 v107, v107
    v_exp_f32 v108, v108
    v_exp_f32 v109, v109
    v_exp_f32 v110, v110
    v_exp_f32 v111, v111
    v_cvt_pk_bf16_f32 v128, v96, v97
    v_cvt_pk_bf16_f32 v129, v98, v99
    v_cvt_pk_bf16_f32 v130, v100, v101
    v_cvt_pk_bf16_f32 v131, v102, v103
    v_cvt_pk_bf16_f32 v132, v104, v105
    v_cvt_pk_bf16_f32 v133, v106, v107
    v_cvt_pk_bf16_f32 v134, v108, v109
    v_cvt_pk_bf16_f32 v135, v110, v111
    v_mfma_f32_32x32x16_bf16 v[64:79], v[148:151], v[128:131], v[64:79]
    s_nop 0
    v_mfma_f32_32x32x16_bf16 v[64:79], v[152:155], v[132:135], v[64:79]
    v_exp_f32 v112, v112
    v_exp_f32 v113, v113
    v_exp_f32 v114, v114
    v_exp_f32 v115, v115
    v_exp_f32 v116, v116
    v_exp_f32 v117, v117
    v_exp_f32 v118, v118
    v_exp_f32 v119, v119
    v_exp_f32 v120, v120
    v_exp_f32 v121, v121
    v_exp_f32 v122, v122
    v_exp_f32 v123, v123
    v_exp_f32 v124, v124
    v_exp_f32 v125, v125
    v_exp_f32 v126, v126
    v_exp_f32 v127, v127
    v_cvt_pk_bf16_f32 v128, v112, v113
    v_cvt_pk_bf16_f32 v129, v114, v115
    v_cvt_pk_bf16_f32 v130, v116, v117
    v_cvt_pk_bf16_f32 v131, v118, v119
    v_cvt_pk_bf16_f32 v132, v120, v121
    v_cvt_pk_bf16_f32 v133, v122, v123
    v_cvt_pk_bf16_f32 v134, v124, v125
    v_cvt_pk_bf16_f32 v135, v126, v127
    v_mfma_f32_32x32x16_bf16 v[80:95], v[148:151], v[128:131], v[80:95]
    s_nop 0
    v_mfma_f32_32x32x16_bf16 v[80:95], v[152:155], v[132:135], v[80:95]
    s_add_u32 s22, s20, 3072
    s_addc_u32 s23, s21, 0
    global_load_dwordx4 v[140:143], v6, s[22:23] sc1
    s_add_u32 s22, s20, 13056
    s_addc_u32 s23, s21, 0
    global_load_dwordx4 v[156:159], v16, s[22:23] sc1
    global_load_dwordx4 v[160:163], v16, s[22:23] offset:640 sc1
    s_waitcnt vmcnt(0)
    v_mfma_f32_32x32x16_bf16 v[96:111], v[140:143], v[176:179], v[32:47]
    v_mfma_f32_32x32x16_bf16 v[112:127], v[140:143], v[180:183], v[48:63]
    s_nop 7
    s_nop 1
    v_mfma_f32_32x32x8_bf16 v[96:111], v[144:145], v[222:223], v[96:111]
    v_mfma_f32_32x32x8_bf16 v[112:127], v[144:145], v[230:231], v[112:127]
    s_nop 10
    v_exp_f32 v96, v96
    v_exp_f32 v97, v97
    v_exp_f32 v98, v98
    v_exp_f32 v99, v99
    v_exp_f32 v100, v100
    v_exp_f32 v101, v101
    v_exp_f32 v102, v102
    v_exp_f32 v103, v103
    v_exp_f32 v104, v104
    v_exp_f32 v105, v105
    v_exp_f32 v106, v106
    v_exp_f32 v107, v107
    v_exp_f32 v108, v108
    v_exp_f32 v109, v109
    v_exp_f32 v110, v110
    v_exp_f32 v111, v111
    v_cvt_pk_bf16_f32 v128, v96, v97
    v_cvt_pk_bf16_f32 v129, v98, v99
    v_cvt_pk_bf16_f32 v130, v100, v101
    v_cvt_pk_bf16_f32 v131, v102, v103
    v_cvt_pk_bf16_f32 v132, v104, v105
    v_cvt_pk_bf16_f32 v133, v106, v107
    v_cvt_pk_bf16_f32 v134, v108, v109
    v_cvt_pk_bf16_f32 v135, v110, v111
    v_mfma_f32_32x32x16_bf16 v[64:79], v[156:159], v[128:131], v[64:79]
    s_nop 0
    v_mfma_f32_32x32x16_bf16 v[64:79], v[160:163], v[132:135], v[64:79]
    v_exp_f32 v112, v112
    v_exp_f32 v113, v113
    v_exp_f32 v114, v114
    v_exp_f32 v115, v115
    v_exp_f32 v116, v116
    v_exp_f32 v117, v117
    v_exp_f32 v118, v118
    v_exp_f32 v119, v119
    v_exp_f32 v120, v120
    v_exp_f32 v121, v121
    v_exp_f32 v122, v122
    v_exp_f32 v123, v123
    v_exp_f32 v124, v124
    v_exp_f32 v125, v125
    v_exp_f32 v126, v126
    v_exp_f32 v127, v127
    v_cvt_pk_bf16_f32 v128, v112, v113
    v_cvt_pk_bf16_f32 v129, v114, v115
    v_cvt_pk_bf16_f32 v130, v116, v117
    v_cvt_pk_bf16_f32 v131, v118, v119
    v_cvt_pk_bf16_f32 v132, v120, v121
    v_cvt_pk_bf16_f32 v133, v122, v123
    v_cvt_pk_bf16_f32 v134, v124, v125
    v_cvt_pk_bf16_f32 v135, v126, v127
    v_mfma_f32_32x32x16_bf16 v[80:95], v[156:159], v[128:131], v[80:95]
    s_nop 0
    v_mfma_f32_32x32x16_bf16 v[80:95], v[160:163], v[132:135], v[80:95]
    s_add_u32 s22, s20, 4096
    s_addc_u32 s23, s21, 0
    global_load_dwordx4 v[136:139], v6, s[22:23] sc1
    s_add_u32 s22, s20, 14336
    s_addc_u32 s23, s21, 0
    global_load_dwordx4 v[148:151], v16, s[22:23] sc1
    global_load_dwordx4 v[152:155], v16, s[22:23] offset:640 sc1
    s_waitcnt vmcnt(0)
    v_mfma_f32_32x32x16_bf16 v[96:111], v[136:139], v[176:179], v[32:47]
    v_mfma_f32_32x32x16_bf16 v[112:127], v[136:139], v[180:183], v[48:63]
    s_nop 7
    s_nop 1
    v_mfma_f32_32x32x8_bf16 v[96:111], v[146:147], v[216:217], v[96:111]
    v_mfma_f32_32x32x8_bf16 v[112:127], v[146:147], v[224:225], v[112:127]
    s_nop 10
    v_exp_f32 v96, v96
    v_exp_f32 v97, v97
    v_exp_f32 v98, v98
    v_exp_f32 v99, v99
    v_exp_f32 v100, v100
    v_exp_f32 v101, v101
    v_exp_f32 v102, v102
    v_exp_f32 v103, v103
    v_exp_f32 v104, v104
    v_exp_f32 v105, v105
    v_exp_f32 v106, v106
    v_exp_f32 v107, v107
    v_exp_f32 v108, v108
    v_exp_f32 v109, v109
    v_exp_f32 v110, v110
    v_exp_f32 v111, v111
    v_cvt_pk_bf16_f32 v128, v96, v97
    v_cvt_pk_bf16_f32 v129, v98, v99
    v_cvt_pk_bf16_f32 v130, v100, v101
    v_cvt_pk_bf16_f32 v131, v102, v103
    v_cvt_pk_bf16_f32 v132, v104, v105
    v_cvt_pk_bf16_f32 v133, v106, v107
    v_cvt_pk_bf16_f32 v134, v108, v109
    v_cvt_pk_bf16_f32 v135, v110, v111
    v_mfma_f32_32x32x16_bf16 v[64:79], v[148:151], v[128:131], v[64:79]
    s_nop 0
    v_mfma_f32_32x32x16_bf16 v[64:79], v[152:155], v[132:135], v[64:79]
    v_exp_f32 v112, v112
    v_exp_f32 v113, v113
    v_exp_f32 v114, v114
    v_exp_f32 v115, v115
    v_exp_f32 v116, v116
    v_exp_f32 v117, v117
    v_exp_f32 v118, v118
    v_exp_f32 v119, v119
    v_exp_f32 v120, v120
    v_exp_f32 v121, v121
    v_exp_f32 v122, v122
    v_exp_f32 v123, v123
    v_exp_f32 v124, v124
    v_exp_f32 v125, v125
    v_exp_f32 v126, v126
    v_exp_f32 v127, v127
    v_cvt_pk_bf16_f32 v128, v112, v113
    v_cvt_pk_bf16_f32 v129, v114, v115
    v_cvt_pk_bf16_f32 v130, v116, v117
    v_cvt_pk_bf16_f32 v131, v118, v119
    v_cvt_pk_bf16_f32 v132, v120, v121
    v_cvt_pk_bf16_f32 v133, v122, v123
    v_cvt_pk_bf16_f32 v134, v124, v125
    v_cvt_pk_bf16_f32 v135, v126, v127
    v_mfma_f32_32x32x16_bf16 v[80:95], v[148:151], v[128:131], v[80:95]
    s_nop 0
    v_mfma_f32_32x32x16_bf16 v[80:95], v[152:155], v[132:135], v[80:95]
    s_add_u32 s22, s20, 5120
    s_addc_u32 s23, s21, 0
    global_load_dwordx4 v[140:143], v6, s[22:23] sc1
    s_add_u32 s22, s20, 15616
    s_addc_u32 s23, s21, 0
    global_load_dwordx4 v[156:159], v16, s[22:23] sc1
    global_load_dwordx4 v[160:163], v16, s[22:23] offset:640 sc1
    s_waitcnt vmcnt(0)
    v_mfma_f32_32x32x16_bf16 v[96:111], v[140:143], v[176:179], v[32:47]
    v_mfma_f32_32x32x16_bf16 v[112:127], v[140:143], v[180:183], v[48:63]
    s_nop 7
    s_nop 1
    v_mfma_f32_32x32x8_bf16 v[96:111], v[146:147], v[220:221], v[96:111]
    v_mfma_f32_32x32x8_bf16 v[112:127], v[146:147], v[228:229], v[112:127]
    s_nop 10
    v_exp_f32 v96, v96
    v_exp_f32 v97, v97
    v_exp_f32 v98, v98
    v_exp_f32 v99, v99
    v_exp_f32 v100, v100
    v_exp_f32 v101, v101
    v_exp_f32 v102, v102
    v_exp_f32 v103, v103
    v_exp_f32 v104, v104
    v_exp_f32 v105, v105
    v_exp_f32 v106, v106
    v_exp_f32 v107, v107
    v_exp_f32 v108, v108
    v_exp_f32 v109, v109
    v_exp_f32 v110, v110
    v_exp_f32 v111, v111
    v_cvt_pk_bf16_f32 v128, v96, v97
    v_cvt_pk_bf16_f32 v129, v98, v99
    v_cvt_pk_bf16_f32 v130, v100, v101
    v_cvt_pk_bf16_f32 v131, v102, v103
    v_cvt_pk_bf16_f32 v132, v104, v105
    v_cvt_pk_bf16_f32 v133, v106, v107
    v_cvt_pk_bf16_f32 v134, v108, v109
    v_cvt_pk_bf16_f32 v135, v110, v111
    v_mfma_f32_32x32x16_bf16 v[64:79], v[156:159], v[128:131], v[64:79]
    s_nop 0
    v_mfma_f32_32x32x16_bf16 v[64:79], v[160:163], v[132:135], v[64:79]
    v_exp_f32 v112, v112
    v_exp_f32 v113, v113
    v_exp_f32 v114, v114
    v_exp_f32 v115, v115
    v_exp_f32 v116, v116
    v_exp_f32 v117, v117
    v_exp_f32 v118, v118
    v_exp_f32 v119, v119
    v_exp_f32 v120, v120
    v_exp_f32 v121, v121
    v_exp_f32 v122, v122
    v_exp_f32 v123, v123
    v_exp_f32 v124, v124
    v_exp_f32 v125, v125
    v_exp_f32 v126, v126
    v_exp_f32 v127, v127
    v_cvt_pk_bf16_f32 v128, v112, v113
    v_cvt_pk_bf16_f32 v129, v114, v115
    v_cvt_pk_bf16_f32 v130, v116, v117
    v_cvt_pk_bf16_f32 v131, v118, v119
    v_cvt_pk_bf16_f32 v132, v120, v121
    v_cvt_pk_bf16_f32 v133, v122, v123
    v_cvt_pk_bf16_f32 v134, v124, v125
    v_cvt_pk_bf16_f32 v135, v126, v127
    v_mfma_f32_32x32x16_bf16 v[80:95], v[156:159], v[128:131], v[80:95]
    s_nop 0
    v_mfma_f32_32x32x16_bf16 v[80:95], v[160:163], v[132:135], v[80:95]
    s_add_u32 s22, s20, 6144
    s_addc_u32 s23, s21, 0
    global_load_dwordx4 v[136:139], v6, s[22:23] sc1
    s_add_u32 s22, s20, 16896
    s_addc_u32 s23, s21, 0
    global_load_dwordx4 v[148:151], v16, s[22:23] sc1
    global_load_dwordx4 v[152:155], v16, s[22:23] offset:640 sc1
    s_waitcnt vmcnt(0)
    v_mfma_f32_32x32x16_bf16 v[96:111], v[136:139], v[176:179], v[32:47]
    v_mfma_f32_32x32x16_bf16 v[112:127], v[136:139], v[180:183], v[48:63]
    s_nop 7
    s_nop 1
    v_mfma_f32_32x32x8_bf16 v[96:111], v[146:147], v[218:219], v[96:111]
    v_mfma_f32_32x32x8_bf16 v[112:127], v[146:147], v[226:227], v[112:127]
    s_nop 10
    v_exp_f32 v96, v96
    v_exp_f32 v97, v97
    v_exp_f32 v98, v98
    v_exp_f32 v99, v99
    v_exp_f32 v100, v100
    v_exp_f32 v101, v101
    v_exp_f32 v102, v102
    v_exp_f32 v103, v103
    v_exp_f32 v104, v104
    v_exp_f32 v105, v105
    v_exp_f32 v106, v106
    v_exp_f32 v107, v107
    v_exp_f32 v108, v108
    v_exp_f32 v109, v109
    v_exp_f32 v110, v110
    v_exp_f32 v111, v111
    v_cvt_pk_bf16_f32 v128, v96, v97
    v_cvt_pk_bf16_f32 v129, v98, v99
    v_cvt_pk_bf16_f32 v130, v100, v101
    v_cvt_pk_bf16_f32 v131, v102, v103
    v_cvt_pk_bf16_f32 v132, v104, v105
    v_cvt_pk_bf16_f32 v133, v106, v107
    v_cvt_pk_bf16_f32 v134, v108, v109
    v_cvt_pk_bf16_f32 v135, v110, v111
    v_mfma_f32_32x32x16_bf16 v[64:79], v[148:151], v[128:131], v[64:79]
    s_nop 0
    v_mfma_f32_32x32x16_bf16 v[64:79], v[152:155], v[132:135], v[64:79]
    v_exp_f32 v112, v112
    v_exp_f32 v113, v113
    v_exp_f32 v114, v114
    v_exp_f32 v115, v115
    v_exp_f32 v116, v116
    v_exp_f32 v117, v117
    v_exp_f32 v118, v118
    v_exp_f32 v119, v119
    v_exp_f32 v120, v120
    v_exp_f32 v121, v121
    v_exp_f32 v122, v122
    v_exp_f32 v123, v123
    v_exp_f32 v124, v124
    v_exp_f32 v125, v125
    v_exp_f32 v126, v126
    v_exp_f32 v127, v127
    v_cvt_pk_bf16_f32 v128, v112, v113
    v_cvt_pk_bf16_f32 v129, v114, v115
    v_cvt_pk_bf16_f32 v130, v116, v117
    v_cvt_pk_bf16_f32 v131, v118, v119
    v_cvt_pk_bf16_f32 v132, v120, v121
    v_cvt_pk_bf16_f32 v133, v122, v123
    v_cvt_pk_bf16_f32 v134, v124, v125
    v_cvt_pk_bf16_f32 v135, v126, v127
    v_mfma_f32_32x32x16_bf16 v[80:95], v[148:151], v[128:131], v[80:95]
    s_nop 0
    v_mfma_f32_32x32x16_bf16 v[80:95], v[152:155], v[132:135], v[80:95]
    s_add_u32 s22, s20, 7168
    s_addc_u32 s23, s21, 0
    global_load_dwordx4 v[140:143], v6, s[22:23] sc1
    s_add_u32 s22, s20, 18176
    s_addc_u32 s23, s21, 0
    global_load_dwordx4 v[156:159], v16, s[22:23] sc1
    global_load_dwordx4 v[160:163], v16, s[22:23] offset:640 sc1
    s_waitcnt vmcnt(0)
    v_mfma_f32_32x32x16_bf16 v[96:111], v[140:143], v[176:179], v[32:47]
    v_mfma_f32_32x32x16_bf16 v[112:127], v[140:143], v[180:183], v[48:63]
    s_nop 7
    s_nop 1
    v_mfma_f32_32x32x8_bf16 v[96:111], v[146:147], v[222:223], v[96:111]
    v_mfma_f32_32x32x8_bf16 v[112:127], v[146:147], v[230:231], v[112:127]
    s_nop 10
    v_exp_f32 v96, v96
    v_exp_f32 v97, v97
    v_exp_f32 v98, v98
    v_exp_f32 v99, v99
    v_exp_f32 v100, v100
    v_exp_f32 v101, v101
    v_exp_f32 v102, v102
    v_exp_f32 v103, v103
    v_exp_f32 v104, v104
    v_exp_f32 v105, v105
    v_exp_f32 v106, v106
    v_exp_f32 v107, v107
    v_exp_f32 v108, v108
    v_exp_f32 v109, v109
    v_exp_f32 v110, v110
    v_exp_f32 v111, v111
    v_cvt_pk_bf16_f32 v128, v96, v97
    v_cvt_pk_bf16_f32 v129, v98, v99
    v_cvt_pk_bf16_f32 v130, v100, v101
    v_cvt_pk_bf16_f32 v131, v102, v103
    v_cvt_pk_bf16_f32 v132, v104, v105
    v_cvt_pk_bf16_f32 v133, v106, v107
    v_cvt_pk_bf16_f32 v134, v108, v109
    v_cvt_pk_bf16_f32 v135, v110, v111
    v_mfma_f32_32x32x16_bf16 v[64:79], v[156:159], v[128:131], v[64:79]
    s_nop 0
    v_mfma_f32_32x32x16_bf16 v[64:79], v[160:163], v[132:135], v[64:79]
    v_exp_f32 v112, v112
    v_exp_f32 v113, v113
    v_exp_f32 v114, v114
    v_exp_f32 v115, v115
    v_exp_f32 v116, v116
    v_exp_f32 v117, v117
    v_exp_f32 v118, v118
    v_exp_f32 v119, v119
    v_exp_f32 v120, v120
    v_exp_f32 v121, v121
    v_exp_f32 v122, v122
    v_exp_f32 v123, v123
    v_exp_f32 v124, v124
    v_exp_f32 v125, v125
    v_exp_f32 v126, v126
    v_exp_f32 v127, v127
    v_cvt_pk_bf16_f32 v128, v112, v113
    v_cvt_pk_bf16_f32 v129, v114, v115
    v_cvt_pk_bf16_f32 v130, v116, v117
    v_cvt_pk_bf16_f32 v131, v118, v119
    v_cvt_pk_bf16_f32 v132, v120, v121
    v_cvt_pk_bf16_f32 v133, v122, v123
    v_cvt_pk_bf16_f32 v134, v124, v125
    v_cvt_pk_bf16_f32 v135, v126, v127
    v_mfma_f32_32x32x16_bf16 v[80:95], v[156:159], v[128:131], v[80:95]
    s_nop 0
    v_mfma_f32_32x32x16_bf16 v[80:95], v[160:163], v[132:135], v[80:95]
    s_add_u32 s20, s20, 19456
    s_addc_u32 s21, s21, 0
    s_add_u32 s11, s11, 1
    s_cmp_lt_u32 s11, 8
    s_nop 7
    s_nop 7
    s_cbranch_scc1 L_sl1
    v_mov_b32 v128, v74
    v_mov_b32 v129, v74
    s_nop 1
    v_permlane32_swap_b32 v128, v129
    v_mov_b32 v130, v90
    v_mov_b32 v131, v90
    s_nop 1
    v_permlane32_swap_b32 v130, v131
    s_nop 1
    s_branch L_fin
L_helper:
    s_load_dwordx4 s[12:15], s[0:1], 16
    s_load_dwordx2 s[20:21], s[0:1], 32
    s_load_dwordx2 s[22:23], s[0:1], 88
    s_load_dwordx2 s[18:19], s[0:1], 48
    s_and_b32 s6, s5, 3
    v_and_b32 v7, 255, v0
    s_mul_i32 s7, s4, 144
    s_lshl_b32 s24, s49, 6
    v_mov_b32 v10, 1152
    v_add_u32 v4, 0, v7
    v_mul_u32_u24 v5, 6554, v4
    v_lshrrev_b32 v5, 16, v5
    v_mul_u32_u24 v6, 10, v5
    v_sub_u32 v4, v4, v6
    v_and_b32 v6, 0x73, v5
    v_and_b32 v8, 4, v5
    v_lshl_or_b32 v6, v8, 1, v6
    v_and_b32 v8, 8, v5
    v_lshrrev_b32 v8, 1, v8
    v_add3_u32 v215, v6, v8, s24
    v_cmp_eq_u32 s[26:27], 9, v4
    v_lshl_add_u32 v200, v4, 4, s7
    s_nop 0
    v_cndmask_b32 v210, v10, 36, s[26:27]
    v_add_u32 v4, 256, v7
    v_mul_u32_u24 v5, 6554, v4
    v_lshrrev_b32 v5, 16, v5
    v_mul_u32_u24 v6, 10, v5
    v_sub_u32 v4, v4, v6
    v_and_b32 v6, 0x73, v5
    v_and_b32 v8, 4, v5
    v_lshl_or_b32 v6, v8, 1, v6
    v_and_b32 v8, 8, v5
    v_lshrrev_b32 v8, 1, v8
    v_add3_u32 v216, v6, v8, s24
    v_cmp_eq_u32 s[28:29], 9, v4
    v_lshl_add_u32 v202, v4, 4, s7
    s_nop 0
    v_cndmask_b32 v211, v10, 36, s[28:29]
    v_add_u32 v4, 512, v7
    v_mul_u32_u24 v5, 6554, v4
    v_lshrrev_b32 v5, 16, v5
    v_mul_u32_u24 v6, 10, v5
    v_sub_u32 v4, v4, v6
    v_and_b32 v6, 0x73, v5
    v_and_b32 v8, 4, v5
    v_lshl_or_b32 v6, v8, 1, v6
    v_and_b32 v8, 8, v5
    v_lshrrev_b32 v8, 1, v8
    v_add3_u32 v217, v6, v8, s24
    v_cmp_eq_u32 s[30:31], 9, v4
    v_lshl_add_u32 v204, v4, 4, s7
    s_nop 0
    v_cndmask_b32 v212, v10, 36, s[30:31]
    v_add_u32 v4, 768, v7
    v_mul_u32_u24 v5, 6554, v4
    v_lshrrev_b32 v5, 16, v5
    v_mul_u32_u24 v6, 10, v5
    v_sub_u32 v4, v4, v6
    v_and_b32 v6, 0x73, v5
    v_and_b32 v8, 4, v5
    v_lshl_or_b32 v6, v8, 1, v6
    v_and_b32 v8, 8, v5
    v_lshrrev_b32 v8, 1, v8
    v_add3_u32 v218, v6, v8, s24
    v_cmp_eq_u32 s[32:33], 9, v4
    v_lshl_add_u32 v206, v4, 4, s7
    s_nop 0
    v_cndmask_b32 v213, v10, 36, s[32:33]
    v_add_u32 v4, 1024, v7
    v_mul_u32_u24 v5, 6554, v4
    v_lshrrev_b32 v5, 16, v5
    v_mul_u32_u24 v6, 10, v5
    v_sub_u32 v4, v4, v6
    v_and_b32 v6, 0x73, v5
    v_and_b32 v8, 4, v5
    v_lshl_or_b32 v6, v8, 1, v6
    v_and_b32 v8, 8, v5
    v_lshrrev_b32 v8, 1, v8
    v_add3_u32 v219, v6, v8, s24
    v_cmp_eq_u32 s[34:35], 9, v4
    v_lshl_add_u32 v208, v4, 4, s7
    s_nop 0
    v_cndmask_b32 v214, v10, 36, s[34:35]
    s_mul_i32 s24, s4, 11
    s_lshr_b32 s24, s24, 5
    s_mul_i32 s25, s24, 3
    s_sub_u32 s25, s4, s25
    s_lshl_b32 s25, s25, 4
    s_min_u32 s25, s25, 20
    s_lshl_b32 s37, s6, 10
    v_lshlrev_b32 v7, 4, v7
    v_mov_b32 v12, 0
    v_mov_b32 v16, -1
    v_mov_b32 v13, 0
    v_mov_b32 v17, -1
    v_mov_b32 v14, 0
    v_mov_b32 v18, -1
    v_mov_b32 v15, 0
    v_mov_b32 v19, -1
    s_lshl_b32 s36, s4, 2
    s_add_u32 s36, s36, s6
    s_waitcnt lgkmcnt(0)
    s_cmp_eq_u32 s24, 1
    s_cselect_b32 s12, s14, s12
    s_cselect_b32 s13, s15, s13
    s_add_u32 s12, s12, s25
    s_addc_u32 s13, s13, 0
    v_mov_b32 v8, s12
    v_mov_b32 v9, s13
    v_mov_b32 v11, s11
    s_cmp_lg_u32 s6, 1
    s_cbranch_scc1 L_nw1
    v_lshlrev_b32 v4, 2, v1
    global_load_dword v244, v4, s[18:19] offset:0
    global_load_dword v245, v4, s[18:19] offset:256
    global_load_dword v246, v4, s[18:19] offset:512
    global_load_dword v247, v4, s[18:19] offset:768
    v_mov_b32 v248, 0
    s_mov_b32 exec_hi, 0
    global_load_dword v248, v4, s[18:19] offset:1024
    s_mov_b64 exec, -1
L_nw1:
    v_add_co_u32 v200, vcc, s10, v200
    s_nop 1
    v_addc_co_u32 v201, vcc, 0, v11, vcc
    v_cndmask_b32 v200, v200, v8, s[26:27]
    v_cndmask_b32 v201, v201, v9, s[26:27]
    s_add_u32 m0, s37, 0
    v_mad_u64_u32 v[4:5], vcc, v215, v210, v[200:201]
    global_load_lds_dwordx4 v[4:5], off
    v_add_u32 v215, 128, v215
    v_subrev_u32 v6, 576, v215
    v_min_u32 v215, v215, v6
    v_add_co_u32 v202, vcc, s10, v202
    s_nop 1
    v_addc_co_u32 v203, vcc, 0, v11, vcc
    v_cndmask_b32 v202, v202, v8, s[28:29]
    v_cndmask_b32 v203, v203, v9, s[28:29]
    s_add_u32 m0, s37, 4096
    v_mad_u64_u32 v[4:5], vcc, v216, v211, v[202:203]
    global_load_lds_dwordx4 v[4:5], off
    v_add_u32 v216, 128, v216
    v_subrev_u32 v6, 576, v216
    v_min_u32 v216, v216, v6
    v_add_co_u32 v204, vcc, s10, v204
    s_nop 1
    v_addc_co_u32 v205, vcc, 0, v11, vcc
    v_cndmask_b32 v204, v204, v8, s[30:31]
    v_cndmask_b32 v205, v205, v9, s[30:31]
    s_add_u32 m0, s37, 8192
    v_mad_u64_u32 v[4:5], vcc, v217, v212, v[204:205]
    global_load_lds_dwordx4 v[4:5], off
    v_add_u32 v217, 128, v217
    v_subrev_u32 v6, 576, v217
    v_min_u32 v217, v217, v6
    s_lshl_b32 s24, s3, 6
    s_lshl_b32 s25, s6, 4
    s_add_u32 s24, s24, s25
    v_lshrrev_b32 v4, 2, v1
    v_add_u32 v4, s24, v4
    v_mul_u32_u24 v4, 1152, v4
    v_lshrrev_b32 v5, 5, v1
    v_lshlrev_b32 v5, 1, v5
    v_and_b32 v6, 3, v1
    v_xor_b32 v5, v5, v6
    v_lshl_add_u32 v250, v5, 4, v4
    s_lshl_b32 s53, s49, 7
    s_mov_b64 s[54:55], s[8:9]
    v_add_co_u32 v206, vcc, s10, v206
    s_nop 1
    v_addc_co_u32 v207, vcc, 0, v11, vcc
    v_cndmask_b32 v206, v206, v8, s[32:33]
    v_cndmask_b32 v207, v207, v9, s[32:33]
    v_add_co_u32 v208, vcc, s10, v208
    s_nop 1
    v_addc_co_u32 v209, vcc, 0, v11, vcc
    v_cndmask_b32 v208, v208, v8, s[34:35]
    v_cndmask_b32 v209, v209, v9, s[34:35]
    s_add_u32 m0, s37, 87040
    v_add_u32 v251, s53, v250
    s_add_u32 s53, s53, 128
    global_load_lds_dwordx4 v251, s[54:55]
    s_add_u32 m0, s37, 91072
    s_cmp_eq_u32 s53, 1152
    global_load_lds_dwordx4 v251, s[54:55] offset:64
    s_cselect_b32 s53, 0, s53
    s_load_dwordx4 s[8:11], s[0:1], 56
    s_load_dwordx4 s[12:15], s[0:1], 72
    v_mov_b32 v116, 0
    v_mov_b32 v117, 0
    v_mov_b32 v118, 0
    v_mov_b32 v119, 0
    v_mov_b32 v120, 0
    s_cmp_lg_u32 s6, 2
    s_cbranch_scc1 L_nwa
    s_lshl_b32 s24, s3, 2
    v_add_u32 v4, 0, v1
    v_mul_u32_u24 v5, 6554, v4
    v_lshrrev_b32 v5, 16, v5
    v_mul_u32_u24 v6, 10, v5
    v_sub_u32 v4, v4, v6
    v_min_u32 v4, 8, v4
    v_lshrrev_b32 v6, 4, v5
    v_bfe_u32 v10, v5, 2, 1
    v_lshl_add_u32 v6, v6, 1, v10
    v_add_u32 v6, s24, v6
    v_min_u32 v6, 71, v6
    v_bfe_u32 v10, v5, 1, 1
    v_bfe_u32 v11, v5, 3, 1
    v_lshl_add_u32 v10, v11, 1, v10
    v_mul_u32_u24 v10, 18, v10
    v_and_b32 v11, 1, v5
    v_add3_u32 v10, v10, v11, 16
    v_and_b32 v5, 11, v5
    v_mul_u32_u24 v11, 57, v6
    v_lshrrev_b32 v11, 9, v11
    v_mul_u32_u24 v21, 9, v11
    v_sub_u32 v6, v6, v21
    v_cmp_eq_u32 vcc, 8, v6
    v_lshrrev_b32 v21, 1, v6
    v_mul_u32_u24 v21, 18, v21
    v_and_b32 v6, 1, v6
    v_lshl_add_u32 v21, v6, 2, v21
    v_add_u32 v21, v21, v5
    v_cndmask_b32 v21, v21, v10, vcc
    v_mul_u32_u24 v11, 72, v11
    v_add_u32 v6, v21, v11
    v_mul_u32_u24 v6, 1152, v6
    v_lshl_add_u32 v6, v4, 4, v6
    v_add_u32 v116, s7, v6
    v_add_u32 v4, 64, v1
    v_mul_u32_u24 v5, 6554, v4
    v_lshrrev_b32 v5, 16, v5
    v_mul_u32_u24 v6, 10, v5
    v_sub_u32 v4, v4, v6
    v_min_u32 v4, 8, v4
    v_lshrrev_b32 v6, 4, v5
    v_bfe_u32 v10, v5, 2, 1
    v_lshl_add_u32 v6, v6, 1, v10
    v_add_u32 v6, s24, v6
    v_min_u32 v6, 71, v6
    v_bfe_u32 v10, v5, 1, 1
    v_bfe_u32 v11, v5, 3, 1
    v_lshl_add_u32 v10, v11, 1, v10
    v_mul_u32_u24 v10, 18, v10
    v_and_b32 v11, 1, v5
    v_add3_u32 v10, v10, v11, 16
    v_and_b32 v5, 11, v5
    v_mul_u32_u24 v11, 57, v6
    v_lshrrev_b32 v11, 9, v11
    v_mul_u32_u24 v21, 9, v11
    v_sub_u32 v6, v6, v21
    v_cmp_eq_u32 vcc, 8, v6
    v_lshrrev_b32 v21, 1, v6
    v_mul_u32_u24 v21, 18, v21
    v_and_b32 v6, 1, v6
    v_lshl_add_u32 v21, v6, 2, v21
    v_add_u32 v21, v21, v5
    v_cndmask_b32 v21, v21, v10, vcc
    v_mul_u32_u24 v11, 72, v11
    v_add_u32 v6, v21, v11
    v_mul_u32_u24 v6, 1152, v6
    v_lshl_add_u32 v6, v4, 4, v6
    v_add_u32 v117, s7, v6
    v_add_u32 v4, 128, v1
    v_mul_u32_u24 v5, 6554, v4
    v_lshrrev_b32 v5, 16, v5
    v_mul_u32_u24 v6, 10, v5
    v_sub_u32 v4, v4, v6
    v_min_u32 v4, 8, v4
    v_lshrrev_b32 v6, 4, v5
    v_bfe_u32 v10, v5, 2, 1
    v_lshl_add_u32 v6, v6, 1, v10
    v_add_u32 v6, s24, v6
    v_min_u32 v6, 71, v6
    v_bfe_u32 v10, v5, 1, 1
    v_bfe_u32 v11, v5, 3, 1
    v_lshl_add_u32 v10, v11, 1, v10
    v_mul_u32_u24 v10, 18, v10
    v_and_b32 v11, 1, v5
    v_add3_u32 v10, v10, v11, 16
    v_and_b32 v5, 11, v5
    v_mul_u32_u24 v11, 57, v6
    v_lshrrev_b32 v11, 9, v11
    v_mul_u32_u24 v21, 9, v11
    v_sub_u32 v6, v6, v21
    v_cmp_eq_u32 vcc, 8, v6
    v_lshrrev_b32 v21, 1, v6
    v_mul_u32_u24 v21, 18, v21
    v_and_b32 v6, 1, v6
    v_lshl_add_u32 v21, v6, 2, v21
    v_add_u32 v21, v21, v5
    v_cndmask_b32 v21, v21, v10, vcc
    v_mul_u32_u24 v11, 72, v11
    v_add_u32 v6, v21, v11
    v_mul_u32_u24 v6, 1152, v6
    v_lshl_add_u32 v6, v4, 4, v6
    v_add_u32 v118, s7, v6
    v_add_u32 v4, 192, v1
    v_mul_u32_u24 v5, 6554, v4
    v_lshrrev_b32 v5, 16, v5
    v_mul_u32_u24 v6, 10, v5
    v_sub_u32 v4, v4, v6
    v_min_u32 v4, 8, v4
    v_lshrrev_b32 v6, 4, v5
    v_bfe_u32 v10, v5, 2, 1
    v_lshl_add_u32 v6, v6, 1, v10
    v_add_u32 v6, s24, v6
    v_min_u32 v6, 71, v6
    v_bfe_u32 v10, v5, 1, 1
    v_bfe_u32 v11, v5, 3, 1
    v_lshl_add_u32 v10, v11, 1, v10
    v_mul_u32_u24 v10, 18, v10
    v_and_b32 v11, 1, v5
    v_add3_u32 v10, v10, v11, 16
    v_and_b32 v5, 11, v5
    v_mul_u32_u24 v11, 57, v6
    v_lshrrev_b32 v11, 9, v11
    v_mul_u32_u24 v21, 9, v11
    v_sub_u32 v6, v6, v21
    v_cmp_eq_u32 vcc, 8, v6
    v_lshrrev_b32 v21, 1, v6
    v_mul_u32_u24 v21, 18, v21
    v_and_b32 v6, 1, v6
    v_lshl_add_u32 v21, v6, 2, v21
    v_add_u32 v21, v21, v5
    v_cndmask_b32 v21, v21, v10, vcc
    v_mul_u32_u24 v11, 72, v11
    v_add_u32 v6, v21, v11
    v_mul_u32_u24 v6, 1152, v6
    v_lshl_add_u32 v6, v4, 4, v6
    v_add_u32 v119, s7, v6
    v_add_u32 v4, 256, v1
    v_mul_u32_u24 v5, 6554, v4
    v_lshrrev_b32 v5, 16, v5
    v_mul_u32_u24 v6, 10, v5
    v_sub_u32 v4, v4, v6
    v_min_u32 v4, 8, v4
    v_lshrrev_b32 v6, 4, v5
    v_bfe_u32 v10, v5, 2, 1
    v_lshl_add_u32 v6, v6, 1, v10
    v_add_u32 v6, s24, v6
    v_min_u32 v6, 71, v6
    v_bfe_u32 v10, v5, 1, 1
    v_bfe_u32 v11, v5, 3, 1
    v_lshl_add_u32 v10, v11, 1, v10
    v_mul_u32_u24 v10, 18, v10
    v_and_b32 v11, 1, v5
    v_add3_u32 v10, v10, v11, 16
    v_and_b32 v5, 11, v5
    v_mul_u32_u24 v11, 57, v6
    v_lshrrev_b32 v11, 9, v11
    v_mul_u32_u24 v21, 9, v11
    v_sub_u32 v6, v6, v21
    v_cmp_eq_u32 vcc, 8, v6
    v_lshrrev_b32 v21, 1, v6
    v_mul_u32_u24 v21, 18, v21
    v_and_b32 v6, 1, v6
    v_lshl_add_u32 v21, v6, 2, v21
    v_add_u32 v21, v21, v5
    v_cndmask_b32 v21, v21, v10, vcc
    v_mul_u32_u24 v11, 72, v11
    v_add_u32 v6, v21, v11
    v_mul_u32_u24 v6, 1152, v6
    v_lshl_add_u32 v6, v4, 4, v6
    v_add_u32 v120, s7, v6
L_nwa:
    s_cmp_lg_u32 s6, 0
    s_cbranch_scc1 L_noz
    v_add_u32 v8, 160768, v7
    ds_write_b128 v8, v[12:15]
    ds_write_b128 v8, v[12:15] offset:1024
    ds_write_b128 v8, v[16:19] offset:2048
    v_mov_b32 v8, 162784
    v_mov_b32 v9, 0x3f80
    ds_write_b32 v8, v9
L_noz:
    s_cmp_eq_u32 s3, 30
    s_cselect_b32 s50, 1, 4
    s_cselect_b32 s51, 4, 1
    s_cmp_eq_u32 s6, 1
    s_cselect_b32 s50, s50, s6
    s_and_b32 s52, s3, 24
    s_add_u32 s52, s52, s4
    v_lshrrev_b32 v8, 1, v2
    v_lshlrev_b32 v8, 4, v8
    v_and_b32 v9, 1, v2
    v_lshl_add_u32 v8, v9, 2, v8
    v_lshrrev_b32 v9, 2, v3
    v_add_u32 v8, v8, v9
    v_mul_u32_u24 v20, 160, v8
    v_and_b32 v9, 3, v3
    v_lshl_add_u32 v8, v9, 3, v20
    s_lshl_b32 s24, s51, 5
    v_add_u32 v10, s24, v8
    v_add_u32 v11, 46080, v10
    s_lshl_b32 s24, s50, 5
    v_add_u32 v8, s24, v8
    v_add_u32 v9, 46080, v8
    v_mov_b32 v192, 0x3f803f80
    v_mov_b32 v193, 0x3f803f80
    v_mov_b32 v194, 0x3f803f80
    v_mov_b32 v195, 0x3f803f80
    s_lshl_b32 s24, s3, 2
    v_add_u32 v21, s24, v2
    v_min_u32 v21, 71, v21
    s_and_b32 s25, s6, 1
    v_bfe_u32 v22, v1, 2, 2
    s_mul_i32 s24, s25, 36
    s_add_u32 s24, s24, 16
    v_lshrrev_b32 v23, 1, v22
    v_mul_u32_u24 v23, 18, v23
    v_and_b32 v4, 1, v22
    v_add3_u32 v23, v23, v4, s24
    s_lshl_b32 s24, s25, 3
    v_add_u32 v22, s24, v22
    v_mul_u32_u24 v4, 57, v21
    v_lshrrev_b32 v4, 9, v4
    v_mul_u32_u24 v5, 9, v4
    v_sub_u32 v21, v21, v5
    v_cmp_eq_u32 vcc, 8, v21
    v_lshrrev_b32 v5, 1, v21
    v_mul_u32_u24 v5, 18, v5
    v_and_b32 v21, 1, v21
    v_lshl_add_u32 v5, v21, 2, v5
    v_add_u32 v5, v5, v22
    v_cndmask_b32 v5, v5, v23, vcc
    v_mul_u32_u24 v4, 72, v4
    v_add_u32 v21, v5, v4
    v_mul_u32_u24 v21, 1152, v21
    v_lshrrev_b32 v4, 5, v1
    v_lshlrev_b32 v4, 1, v4
    v_and_b32 v5, 3, v1
    v_xor_b32 v4, v4, v5
    v_lshl_add_u32 v21, v4, 4, v21
    s_lshr_b32 s24, s6, 1
    s_lshl_b32 s26, s24, 6
    v_add_u32 v21, s26, v21
    s_lshl_b32 s24, s24, 11
    s_lshl_b32 s25, s25, 10
    s_add_u32 s24, s24, s25
    s_add_u32 s27, s24, 94208
    v_and_b32 v22, 7, v1
    v_lshlrev_b32 v22, 2, v22
    s_setprio 3
    s_add_u32 m0, s37, 95232
    v_add_u32 v251, s53, v250
    s_add_u32 s53, s53, 128
    global_load_lds_dwordx4 v251, s[54:55]
    s_add_u32 m0, s37, 99264
    s_cmp_eq_u32 s53, 1152
    global_load_lds_dwordx4 v251, s[54:55] offset:64
    s_cselect_b32 s53, 0, s53
    s_add_u32 m0, s37, 103424
    v_add_u32 v251, s53, v250
    s_add_u32 s53, s53, 128
    global_load_lds_dwordx4 v251, s[54:55]
    s_add_u32 m0, s37, 107456
    s_cmp_eq_u32 s53, 1152
    global_load_lds_dwordx4 v251, s[54:55] offset:64
    s_cselect_b32 s53, 0, s53
    s_add_u32 m0, s37, 12288
    v_mad_u64_u32 v[4:5], vcc, v218, v213, v[206:207]
    global_load_lds_dwordx4 v[4:5], off
    v_add_u32 v218, 128, v218
    v_subrev_u32 v6, 576, v218
    v_min_u32 v218, v218, v6
    s_add_u32 m0, s37, 16384
    v_mad_u64_u32 v[4:5], vcc, v219, v214, v[208:209]
    global_load_lds_dwordx4 v[4:5], off
    v_add_u32 v219, 128, v219
    v_subrev_u32 v6, 576, v219
    v_min_u32 v219, v219, v6
    s_add_u32 m0, s37, 111616
    v_add_u32 v251, s53, v250
    s_add_u32 s53, s53, 128
    global_load_lds_dwordx4 v251, s[54:55]
    s_add_u32 m0, s37, 115648
    s_cmp_eq_u32 s53, 1152
    global_load_lds_dwordx4 v251, s[54:55] offset:64
    s_cselect_b32 s53, 0, s53
    s_add_u32 m0, s37, 20480
    v_mad_u64_u32 v[4:5], vcc, v215, v210, v[200:201]
    global_load_lds_dwordx4 v[4:5], off
    v_add_u32 v215, 128, v215
    v_subrev_u32 v6, 576, v215
    v_min_u32 v215, v215, v6
    s_waitcnt vmcnt(5) lgkmcnt(0)
    s_barrier
    ds_read_b64_tr_b16 v[24:25], v8 offset:0
    ds_read_b64_tr_b16 v[26:27], v8 offset:1280
    ds_read_b64_tr_b16 v[28:29], v8 offset:5120
    ds_read_b64_tr_b16 v[30:31], v8 offset:6400
    s_cmp_lg_u32 s6, 1
    s_cbranch_scc1 L_g1
    ds_read_b64_tr_b16 v[96:97], v10 offset:0
    ds_read_b64_tr_b16 v[98:99], v10 offset:1280
    ds_read_b64_tr_b16 v[100:101], v10 offset:5120
    ds_read_b64_tr_b16 v[102:103], v10 offset:6400
L_g1:
    s_add_u32 m0, s37, 24576
    v_mad_u64_u32 v[4:5], vcc, v216, v211, v[202:203]
    global_load_lds_dwordx4 v[4:5], off
    v_add_u32 v216, 128, v216
    v_subrev_u32 v6, 576, v216
    v_min_u32 v216, v216, v6
    s_add_u32 m0, s37, 28672
    v_mad_u64_u32 v[4:5], vcc, v217, v212, v[204:205]
    global_load_lds_dwordx4 v[4:5], off
    v_add_u32 v217, 128, v217
    v_subrev_u32 v6, 576, v217
    v_min_u32 v217, v217, v6
    s_add_u32 m0, s37, 119808
    v_add_u32 v251, s53, v250
    s_add_u32 s53, s53, 128
    global_load_lds_dwordx4 v251, s[54:55]
    s_add_u32 m0, s37, 123840
    s_cmp_eq_u32 s53, 1152
    global_load_lds_dwordx4 v251, s[54:55] offset:64
    s_cselect_b32 s53, 0, s53
    s_waitcnt lgkmcnt(0)
    v_mfma_f32_16x16x32_bf16 v[168:171], v[24:27], v[192:195], 0
    v_mfma_f32_16x16x32_bf16 v[168:171], v[28:31], v[192:195], v[168:171]
    s_cmp_lg_u32 s6, 1
    s_cbranch_scc1 L_g2
    v_mfma_f32_16x16x32_bf16 v[172:175], v[96:99], v[192:195], 0
    v_mfma_f32_16x16x32_bf16 v[172:175], v[100:103], v[192:195], v[172:175]
L_g2:
    s_cmp_lg_u32 s6, 1
    s_cbranch_scc1 L_nw2
    v_mov_b32 v4, 0
    v_dot2c_f32_bf16 v4, v244, v192
    v_dot2c_f32_bf16 v4, v245, v192
    v_dot2c_f32_bf16 v4, v246, v192
    v_dot2c_f32_bf16 v4, v247, v192
    v_dot2c_f32_bf16 v4, v248, v192
    s_nop 2
    v_add_f32 v4, 0, v4
    v_mov_b32 v5, v4
    s_nop 1
    v_permlane16_swap_b32 v4, v5
    v_add_f32 v4, v4, v5
    v_mov_b32 v5, v4
    s_nop 1
    v_permlane32_swap_b32 v4, v5
    v_add_f32 v4, v4, v5
    s_nop 1
    v_add_f32_dpp v4, v4, v4 row_ror:8 row_mask:0xf bank_mask:0xf
    s_nop 1
    v_add_f32_dpp v4, v4, v4 row_ror:4 row_mask:0xf bank_mask:0xf
    s_nop 1
    v_add_f32_dpp v4, v4, v4 row_ror:2 row_mask:0xf bank_mask:0xf
    s_nop 1
    v_add_f32_dpp v4, v4, v4 row_ror:1 row_mask:0xf bank_mask:0xf
    v_mov_b32 v5, 160768
    v_readfirstlane_b32 s33, v4
    ds_write_b32 v5, v4
L_nw2:
    s_waitcnt vmcnt(5) lgkmcnt(0)
    s_barrier
    ds_read_b64_tr_b16 v[32:33], v8 offset:10240
    ds_read_b64_tr_b16 v[34:35], v8 offset:11520
    ds_read_b64_tr_b16 v[36:37], v8 offset:15360
    ds_read_b64_tr_b16 v[38:39], v8 offset:16640
    s_cmp_lg_u32 s6, 1
    s_cbranch_scc1 L_g3
    ds_read_b64_tr_b16 v[104:105], v10 offset:10240
    ds_read_b64_tr_b16 v[106:107], v10 offset:11520
    ds_read_b64_tr_b16 v[108:109], v10 offset:15360
    ds_read_b64_tr_b16 v[110:111], v10 offset:16640
L_g3:
    s_add_u32 m0, s37, 32768
    v_mad_u64_u32 v[4:5], vcc, v218, v213, v[206:207]
    global_load_lds_dwordx4 v[4:5], off
    v_add_u32 v218, 128, v218
    v_subrev_u32 v6, 576, v218
    v_min_u32 v218, v218, v6
    s_add_u32 m0, s37, 36864
    v_mad_u64_u32 v[4:5], vcc, v219, v214, v[208:209]
    global_load_lds_dwordx4 v[4:5], off
    v_add_u32 v219, 128, v219
    v_subrev_u32 v6, 576, v219
    v_min_u32 v219, v219, v6
    s_add_u32 m0, s37, 128000
    v_add_u32 v251, s53, v250
    s_add_u32 s53, s53, 128
    global_load_lds_dwordx4 v251, s[54:55]
    s_add_u32 m0, s37, 132032
    s_cmp_eq_u32 s53, 1152
    global_load_lds_dwordx4 v251, s[54:55] offset:64
    s_cselect_b32 s53, 0, s53
    s_add_u32 m0, s37, 40960
    v_mad_u64_u32 v[4:5], vcc, v215, v210, v[200:201]
    global_load_lds_dwordx4 v[4:5], off
    v_add_u32 v215, 128, v215
    v_subrev_u32 v6, 576, v215
    v_min_u32 v215, v215, v6
    s_waitcnt lgkmcnt(0)
    v_mfma_f32_16x16x32_bf16 v[168:171], v[32:35], v[192:195], v[168:171]
    v_mfma_f32_16x16x32_bf16 v[168:171], v[36:39], v[192:195], v[168:171]
    s_cmp_lg_u32 s6, 1
    s_cbranch_scc1 L_g4
    v_mfma_f32_16x16x32_bf16 v[172:175], v[104:107], v[192:195], v[172:175]
    v_mfma_f32_16x16x32_bf16 v[172:175], v[108:111], v[192:195], v[172:175]
L_g4:
    s_waitcnt vmcnt(5) lgkmcnt(0)
    s_barrier
    ds_read_b64_tr_b16 v[40:41], v8 offset:20480
    ds_read_b64_tr_b16 v[42:43], v8 offset:21760
    ds_read_b64_tr_b16 v[44:45], v8 offset:25600
    ds_read_b64_tr_b16 v[46:47], v8 offset:26880
    s_cmp_lg_u32 s6, 1
    s_cbranch_scc1 L_g5
    ds_read_b64_tr_b16 v[112:113], v10 offset:20480
    ds_read_b64_tr_b16 v[114:115], v10 offset:21760
    ds_read_b64_tr_b16 v[116:117], v10 offset:25600
    ds_read_b64_tr_b16 v[118:119], v10 offset:26880
L_g5:
    s_add_u32 m0, s37, 45056
    v_mad_u64_u32 v[4:5], vcc, v216, v211, v[202:203]
    global_load_lds_dwordx4 v[4:5], off
    v_add_u32 v216, 128, v216
    v_subrev_u32 v6, 576, v216
    v_min_u32 v216, v216, v6
    s_add_u32 m0, s37, 49152
    v_mad_u64_u32 v[4:5], vcc, v217, v212, v[204:205]
    global_load_lds_dwordx4 v[4:5], off
    v_add_u32 v217, 128, v217
    v_subrev_u32 v6, 576, v217
    v_min_u32 v217, v217, v6
    s_add_u32 m0, s37, 136192
    v_add_u32 v251, s53, v250
    s_add_u32 s53, s53, 128
    global_load_lds_dwordx4 v251, s[54:55]
    s_add_u32 m0, s37, 140224
    s_cmp_eq_u32 s53, 1152
    global_load_lds_dwordx4 v251, s[54:55] offset:64
    s_cselect_b32 s53, 0, s53
    s_waitcnt lgkmcnt(0)
    v_mfma_f32_16x16x32_bf16 v[168:171], v[40:43], v[192:195], v[168:171]
    v_mfma_f32_16x16x32_bf16 v[168:171], v[44:47], v[192:195], v[168:171]
    s_cmp_lg_u32 s6, 1
    s_cbranch_scc1 L_g6
    v_mfma_f32_16x16x32_bf16 v[172:175], v[112:115], v[192:195], v[172:175]
    v_mfma_f32_16x16x32_bf16 v[172:175], v[116:119], v[192:195], v[172:175]
L_g6:
    s_waitcnt vmcnt(5) lgkmcnt(0)
    s_barrier
    ds_read_b64_tr_b16 v[48:49], v8 offset:30720
    ds_read_b64_tr_b16 v[50:51], v8 offset:32000
    ds_read_b64_tr_b16 v[52:53], v8 offset:35840
    ds_read_b64_tr_b16 v[54:55], v8 offset:37120
    s_cmp_lg_u32 s6, 1
    s_cbranch_scc1 L_g7
    ds_read_b64_tr_b16 v[120:121], v10 offset:30720
    ds_read_b64_tr_b16 v[122:123], v10 offset:32000
    ds_read_b64_tr_b16 v[124:125], v10 offset:35840
    ds_read_b64_tr_b16 v[126:127], v10 offset:37120
L_g7:
    s_add_u32 m0, s37, 53248
    v_mad_u64_u32 v[4:5], vcc, v218, v213, v[206:207]
    global_load_lds_dwordx4 v[4:5], off
    v_add_u32 v218, 128, v218
    v_subrev_u32 v6, 576, v218
    v_min_u32 v218, v218, v6
    s_add_u32 m0, s37, 57344
    v_mad_u64_u32 v[4:5], vcc, v219, v214, v[208:209]
    global_load_lds_dwordx4 v[4:5], off
    v_add_u32 v219, 128, v219
    v_subrev_u32 v6, 576, v219
    v_min_u32 v219, v219, v6
    s_add_u32 m0, s37, 144384
    v_add_u32 v251, s53, v250
    s_add_u32 s53, s53, 128
    global_load_lds_dwordx4 v251, s[54:55]
    s_add_u32 m0, s37, 148416
    s_cmp_eq_u32 s53, 1152
    global_load_lds_dwordx4 v251, s[54:55] offset:64
    s_cselect_b32 s53, 0, s53
    s_add_u32 m0, s37, 61440
    v_mad_u64_u32 v[4:5], vcc, v215, v210, v[200:201]
    global_load_lds_dwordx4 v[4:5], off
    v_add_u32 v215, 128, v215
    v_subrev_u32 v6, 576, v215
    v_min_u32 v215, v215, v6
    s_waitcnt lgkmcnt(0)
    v_mfma_f32_16x16x32_bf16 v[168:171], v[48:51], v[192:195], v[168:171]
    v_mfma_f32_16x16x32_bf16 v[168:171], v[52:55], v[192:195], v[168:171]
    s_cmp_lg_u32 s6, 1
    s_cbranch_scc1 L_g8
    v_mfma_f32_16x16x32_bf16 v[172:175], v[120:123], v[192:195], v[172:175]
    v_mfma_f32_16x16x32_bf16 v[172:175], v[124:127], v[192:195], v[172:175]
L_g8:
    s_waitcnt vmcnt(5) lgkmcnt(0)
    s_barrier
    ds_read_b64_tr_b16 v[56:57], v8 offset:40960
    ds_read_b64_tr_b16 v[58:59], v8 offset:42240
    ds_read_b64_tr_b16 v[60:61], v9 offset:0
    ds_read_b64_tr_b16 v[62:63], v9 offset:1280
    s_cmp_lg_u32 s6, 1
    s_cbranch_scc1 L_g9
    ds_read_b64_tr_b16 v[128:129], v10 offset:40960
    ds_read_b64_tr_b16 v[130:131], v10 offset:42240
    ds_read_b64_tr_b16 v[132:133], v11 offset:0
    ds_read_b64_tr_b16 v[134:135], v11 offset:1280
L_g9:
    s_add_u32 m0, s37, 65536
    v_mad_u64_u32 v[4:5], vcc, v216, v211, v[202:203]
    global_load_lds_dwordx4 v[4:5], off
    v_add_u32 v216, 128, v216
    v_subrev_u32 v6, 576, v216
    v_min_u32 v216, v216, v6
    s_add_u32 m0, s37, 69632
    v_mad_u64_u32 v[4:5], vcc, v217, v212, v[204:205]
    global_load_lds_dwordx4 v[4:5], off
    v_add_u32 v217, 128, v217
    v_subrev_u32 v6, 576, v217
    v_min_u32 v217, v217, v6
    s_add_u32 m0, s37, 152576
    v_add_u32 v251, s53, v250
    s_add_u32 s53, s53, 128
    global_load_lds_dwordx4 v251, s[54:55]
    s_add_u32 m0, s37, 156608
    s_cmp_eq_u32 s53, 1152
    global_load_lds_dwordx4 v251, s[54:55] offset:64
    s_cselect_b32 s53, 0, s53
    s_waitcnt lgkmcnt(0)
    v_mfma_f32_16x16x32_bf16 v[168:171], v[56:59], v[192:195], v[168:171]
    v_mfma_f32_16x16x32_bf16 v[168:171], v[60:63], v[192:195], v[168:171]
    s_cmp_lg_u32 s6, 1
    s_cbranch_scc1 L_g10
    v_mfma_f32_16x16x32_bf16 v[172:175], v[128:131], v[192:195], v[172:175]
    v_mfma_f32_16x16x32_bf16 v[172:175], v[132:135], v[192:195], v[172:175]
L_g10:
    s_waitcnt vmcnt(5) lgkmcnt(0)
    s_barrier
    ds_read_b64_tr_b16 v[64:65], v9 offset:5120
    ds_read_b64_tr_b16 v[66:67], v9 offset:6400
    ds_read_b64_tr_b16 v[68:69], v9 offset:10240
    ds_read_b64_tr_b16 v[70:71], v9 offset:11520
    s_cmp_lg_u32 s6, 1
    s_cbranch_scc1 L_g11
    ds_read_b64_tr_b16 v[136:137], v11 offset:5120
    ds_read_b64_tr_b16 v[138:139], v11 offset:6400
    ds_read_b64_tr_b16 v[140:141], v11 offset:10240
    ds_read_b64_tr_b16 v[142:143], v11 offset:11520
L_g11:
    s_add_u32 m0, s37, 73728
    v_mad_u64_u32 v[4:5], vcc, v218, v213, v[206:207]
    global_load_lds_dwordx4 v[4:5], off
    s_add_u32 m0, s37, 77824
    v_mad_u64_u32 v[4:5], vcc, v219, v214, v[208:209]
    global_load_lds_dwordx4 v[4:5], off
    s_add_u32 m0, s37, 81920
    v_mad_u64_u32 v[4:5], vcc, v215, v210, v[200:201]
    global_load_lds_dwordx4 v[4:5], off
    s_add_u32 m0, s37, 86016
    v_mad_u64_u32 v[4:5], vcc, v216, v211, v[202:203]
    global_load_lds_dwordx4 v[4:5], off
    s_add_u32 m0, s37, 90112
    v_mad_u64_u32 v[4:5], vcc, v217, v212, v[204:205]
    global_load_lds_dwordx4 v[4:5], off
    s_waitcnt lgkmcnt(0)
    v_mfma_f32_16x16x32_bf16 v[168:171], v[64:67], v[192:195], v[168:171]
    v_mfma_f32_16x16x32_bf16 v[168:171], v[68:71], v[192:195], v[168:171]
    s_cmp_lg_u32 s6, 1
    s_cbranch_scc1 L_g12
    v_mfma_f32_16x16x32_bf16 v[172:175], v[136:139], v[192:195], v[172:175]
    v_mfma_f32_16x16x32_bf16 v[172:175], v[140:143], v[192:195], v[172:175]
L_g12:
    s_waitcnt vmcnt(5) lgkmcnt(0)
    s_barrier
    ds_read_b64_tr_b16 v[72:73], v9 offset:15360
    ds_read_b64_tr_b16 v[74:75], v9 offset:16640
    ds_read_b64_tr_b16 v[76:77], v9 offset:20480
    ds_read_b64_tr_b16 v[78:79], v9 offset:21760
    s_cmp_lg_u32 s6, 1
    s_cbranch_scc1 L_g13
    ds_read_b64_tr_b16 v[144:145], v11 offset:15360
    ds_read_b64_tr_b16 v[146:147], v11 offset:16640
    ds_read_b64_tr_b16 v[148:149], v11 offset:20480
    ds_read_b64_tr_b16 v[150:151], v11 offset:21760
L_g13:
    s_waitcnt lgkmcnt(0)
    v_mfma_f32_16x16x32_bf16 v[168:171], v[72:75], v[192:195], v[168:171]
    v_mfma_f32_16x16x32_bf16 v[168:171], v[76:79], v[192:195], v[168:171]
    s_cmp_lg_u32 s6, 1
    s_cbranch_scc1 L_g14
    v_mfma_f32_16x16x32_bf16 v[172:175], v[144:147], v[192:195], v[172:175]
    v_mfma_f32_16x16x32_bf16 v[172:175], v[148:151], v[192:195], v[172:175]
L_g14:
    s_waitcnt vmcnt(3) lgkmcnt(0)
    s_barrier
    ds_read_b64_tr_b16 v[80:81], v9 offset:25600
    ds_read_b64_tr_b16 v[82:83], v9 offset:26880
    ds_read_b64_tr_b16 v[84:85], v9 offset:30720
    ds_read_b64_tr_b16 v[86:87], v9 offset:32000
    s_cmp_lg_u32 s6, 1
    s_cbranch_scc1 L_g15
    ds_read_b64_tr_b16 v[152:153], v11 offset:25600
    ds_read_b64_tr_b16 v[154:155], v11 offset:26880
    ds_read_b64_tr_b16 v[156:157], v11 offset:30720
    ds_read_b64_tr_b16 v[158:159], v11 offset:32000
L_g15:
    s_cmp_lg_u32 s6, 3
    s_cbranch_scc1 L_nd1
    s_load_dwordx8 s[40:47], s[22:23], 0
L_nd1:
    s_cmp_ge_u32 s3, 18
    s_cbranch_scc1 L_nwr
    s_lshl_b32 s26, s49, 7
    s_mov_b32 m0, s27
    v_add_u32 v4, s26, v21
    s_add_u32 s26, s26, 128
    global_load_lds_dwordx4 v4, s[20:21]
    s_add_u32 m0, m0, 4096
    s_cmp_eq_u32 s26, 1152
    s_cselect_b32 s26, 0, s26
    v_add_u32 v4, s26, v21
    s_add_u32 s26, s26, 128
    global_load_lds_dwordx4 v4, s[20:21]
    s_add_u32 m0, m0, 4096
    s_cmp_eq_u32 s26, 1152
    s_cselect_b32 s26, 0, s26
    v_add_u32 v4, s26, v21
    s_add_u32 s26, s26, 128
    global_load_lds_dwordx4 v4, s[20:21]
    s_add_u32 m0, m0, 4096
    s_cmp_eq_u32 s26, 1152
    s_cselect_b32 s26, 0, s26
    v_add_u32 v4, s26, v21
    s_add_u32 s26, s26, 128
    global_load_lds_dwordx4 v4, s[20:21]
    s_add_u32 m0, m0, 4096
    s_cmp_eq_u32 s26, 1152
    s_cselect_b32 s26, 0, s26
    v_add_u32 v4, s26, v21
    s_add_u32 s26, s26, 128
    global_load_lds_dwordx4 v4, s[20:21]
    s_add_u32 m0, m0, 4096
    s_cmp_eq_u32 s26, 1152
    s_cselect_b32 s26, 0, s26
    v_add_u32 v4, s26, v21
    s_add_u32 s26, s26, 128
    global_load_lds_dwordx4 v4, s[20:21]
    s_add_u32 m0, m0, 4096
    s_cmp_eq_u32 s26, 1152
    s_cselect_b32 s26, 0, s26
    v_add_u32 v4, s26, v21
    s_add_u32 s26, s26, 128
    global_load_lds_dwordx4 v4, s[20:21]
    s_add_u32 m0, m0, 4096
    s_cmp_eq_u32 s26, 1152
    s_cselect_b32 s26, 0, s26
    v_add_u32 v4, s26, v21
    s_add_u32 s26, s26, 128
    global_load_lds_dwordx4 v4, s[20:21]
    s_add_u32 m0, m0, 4096
    s_cmp_eq_u32 s26, 1152
    s_cselect_b32 s26, 0, s26
    v_add_u32 v4, s26, v21
    s_add_u32 s26, s26, 128
    global_load_lds_dwordx4 v4, s[20:21]
    s_add_u32 m0, m0, 4096
    s_cmp_eq_u32 s26, 1152
    s_cselect_b32 s26, 0, s26
L_nwr:
    s_waitcnt lgkmcnt(0)
    v_mfma_f32_16x16x32_bf16 v[168:171], v[80:83], v[192:195], v[168:171]
    v_mfma_f32_16x16x32_bf16 v[168:171], v[84:87], v[192:195], v[168:171]
    s_cmp_lg_u32 s6, 1
    s_cbranch_scc1 L_g16
    v_mfma_f32_16x16x32_bf16 v[172:175], v[152:155], v[192:195], v[172:175]
    v_mfma_f32_16x16x32_bf16 v[172:175], v[156:159], v[192:195], v[172:175]
L_g16:
    s_cmp_ge_u32 s3, 18
    s_waitcnt vmcnt(10)
    s_cbranch_scc0 L_w2_17
    s_waitcnt vmcnt(1)
L_w2_17:
    s_barrier
    ds_read_b64_tr_b16 v[88:89], v9 offset:35840
    ds_read_b64_tr_b16 v[90:91], v9 offset:37120
    s_cmp_lg_u32 s6, 1
    s_cbranch_scc1 L_g18
    ds_read_b64_tr_b16 v[160:161], v11 offset:35840
    ds_read_b64_tr_b16 v[162:163], v11 offset:37120
L_g18:
    s_waitcnt lgkmcnt(0)
    v_mfma_f32_16x16x32_bf16 v[168:171], v[88:91], v[192:195], v[168:171]
    s_cmp_lg_u32 s6, 1
    s_cbranch_scc1 L_g19
    v_mfma_f32_16x16x32_bf16 v[172:175], v[160:163], v[192:195], v[172:175]
L_g19:
    s_cmp_ge_u32 s3, 18
    s_waitcnt vmcnt(9)
    s_cbranch_scc0 L_w2_20
    s_waitcnt vmcnt(0)
L_w2_20:
    s_barrier
    s_setprio 3
    ds_read_b64_tr_b16 v[92:93], v9 offset:40960
    ds_read_b64_tr_b16 v[94:95], v9 offset:42240
    s_cmp_lg_u32 s6, 1
    s_cbranch_scc1 L_g21
    ds_read_b64_tr_b16 v[164:165], v11 offset:40960
    ds_read_b64_tr_b16 v[166:167], v11 offset:42240
L_g21:
    s_waitcnt lgkmcnt(0)
    v_mfma_f32_16x16x32_bf16 v[168:171], v[92:95], v[192:195], v[168:171]
    s_cmp_lg_u32 s6, 1
    s_cbranch_scc1 L_g22
    v_mfma_f32_16x16x32_bf16 v[172:175], v[164:167], v[192:195], v[172:175]
L_g22:
    s_lshl_b32 s24, s50, 6
    s_add_u32 s24, s24, 162368
    v_lshl_add_u32 v4, v2, 4, s24
    s_lshl_b32 s24, s51, 6
    s_add_u32 s24, s24, 162368
    v_lshl_add_u32 v5, v2, 4, s24
    s_mov_b32 exec_lo, 0x00010001
    s_mov_b32 exec_hi, 0x00010001
    s_nop 1
    ds_write_b128 v4, v[168:171]
    s_cmp_lg_u32 s6, 1
    s_cbranch_scc1 L_ncs
    ds_write_b128 v5, v[172:175]
L_ncs:
    s_mov_b64 exec, -1
    s_cmp_lg_u32 s6, 3
    s_cbranch_scc1 L_polld_ok
    s_and_b64 s[40:41], s[40:41], s[42:43]
    s_and_b64 s[44:45], s[44:45], s[46:47]
    s_and_b64 s[40:41], s[40:41], s[44:45]
    s_cmp_eq_u64 s[40:41], -1
    s_cbranch_scc1 L_polld_ok
    s_mov_b32 s40, 30000
L_polld:
    s_sleep 4
    global_load_dword v23, v22, s[22:23] sc1
    s_waitcnt vmcnt(0)
    v_cmp_ne_u32 vcc, -1, v23
    s_cmp_eq_u64 vcc, 0
    s_cbranch_scc1 L_polld_ok
    s_sub_u32 s40, s40, 1
    s_cbranch_scc0 L_polld
L_polld_ok:
    s_waitcnt lgkmcnt(0)
    s_barrier
    s_cmp_ge_u32 s3, 18
    s_cbranch_scc1 L_nimg
    s_lshl_b32 s24, s6, 2
    s_add_u32 s24, s24, 160784
    v_mov_b32 v4, s24
    v_mov_b32 v5, 160784
    v_lshrrev_b32 v6, 3, v3
    v_lshlrev_b32 v6, 1, v6
    v_xor_b32 v6, v6, v2
    v_lshlrev_b32 v6, 4, v6
    v_lshl_add_u32 v6, v3, 6, v6
    v_add_u32 v6, 94208, v6
    s_waitcnt vmcnt(0)
    ds_write_b32 v4, v16
    s_cmp_lg_u32 s6, 2
    s_cbranch_scc1 L_nws
    s_mov_b32 m0, 131072
    s_nop 0
    global_load_lds_dwordx4 v116, s[20:21]
    s_mov_b32 m0, 132096
    s_nop 0
    global_load_lds_dwordx4 v117, s[20:21]
    s_mov_b32 m0, 133120
    s_nop 0
    global_load_lds_dwordx4 v118, s[20:21]
    s_mov_b32 m0, 134144
    s_nop 0
    global_load_lds_dwordx4 v119, s[20:21]
    s_mov_b32 m0, 135168
    s_nop 0
    global_load_lds_dwordx4 v120, s[20:21]
L_nws:
    s_mov_b32 s40, 524288
L_pollj:
    ds_read_b128 v[8:11], v5
    s_waitcnt lgkmcnt(0)
    v_and_b32 v8, v8, v9
    v_and_b32 v10, v10, v11
    v_and_b32 v8, v8, v10
    s_nop 0
    v_readfirstlane_b32 s24, v8
    s_cmp_lg_u32 s24, 0
    s_cbranch_scc1 L_pollj_ok
    s_sub_u32 s40, s40, 1
    s_cbranch_scc0 L_pollj
L_pollj_ok:
    ds_read_b128 v[220:223], v6 offset:0
    ds_read_b128 v[224:227], v6 offset:1024
    ds_read_b128 v[228:231], v6 offset:2048
    ds_read_b128 v[232:235], v6 offset:3072
    ds_read_b128 v[236:239], v6 offset:4096
    ds_read_b128 v[240:243], v6 offset:5120
    ds_read_b128 v[244:247], v6 offset:6144
    ds_read_b128 v[248:251], v6 offset:7168
    s_waitcnt lgkmcnt(6)
    v_mfma_f32_16x16x32_bf16 v[176:179], v[220:223], v[24:27], 0
    v_mfma_f32_16x16x32_bf16 v[180:183], v[224:227], v[24:27], 0
    ds_read_b128 v[220:223], v6 offset:8192
    ds_read_b128 v[224:227], v6 offset:9216
    s_waitcnt lgkmcnt(6)
    v_mfma_f32_16x16x32_bf16 v[176:179], v[228:231], v[28:31], v[176:179]
    v_mfma_f32_16x16x32_bf16 v[180:183], v[232:235], v[28:31], v[180:183]
    ds_read_b128 v[228:231], v6 offset:10240
    ds_read_b128 v[232:235], v6 offset:11264
    s_waitcnt lgkmcnt(6)
    v_mfma_f32_16x16x32_bf16 v[176:179], v[236:239], v[32:35], v[176:179]
    v_mfma_f32_16x16x32_bf16 v[180:183], v[240:243], v[32:35], v[180:183]
    ds_read_b128 v[236:239], v6 offset:12288
    ds_read_b128 v[240:243], v6 offset:13312
    s_waitcnt lgkmcnt(6)
    v_mfma_f32_16x16x32_bf16 v[176:179], v[244:247], v[36:39], v[176:179]
    v_mfma_f32_16x16x32_bf16 v[180:183], v[248:251], v[36:39], v[180:183]
    ds_read_b128 v[244:247], v6 offset:14336
    ds_read_b128 v[248:251], v6 offset:15360
    s_waitcnt lgkmcnt(6)
    v_mfma_f32_16x16x32_bf16 v[176:179], v[220:223], v[40:43], v[176:179]
    v_mfma_f32_16x16x32_bf16 v[180:183], v[224:227], v[40:43], v[180:183]
    ds_read_b128 v[220:223], v6 offset:16384
    ds_read_b128 v[224:227], v6 offset:17408
    s_waitcnt lgkmcnt(6)
    v_mfma_f32_16x16x32_bf16 v[176:179], v[228:231], v[44:47], v[176:179]
    v_mfma_f32_16x16x32_bf16 v[180:183], v[232:235], v[44:47], v[180:183]
    ds_read_b128 v[228:231], v6 offset:18432
    ds_read_b128 v[232:235], v6 offset:19456
    s_waitcnt lgkmcnt(6)
    v_mfma_f32_16x16x32_bf16 v[176:179], v[236:239], v[48:51], v[176:179]
    v_mfma_f32_16x16x32_bf16 v[180:183], v[240:243], v[48:51], v[180:183]
    ds_read_b128 v[236:239], v6 offset:20480
    ds_read_b128 v[240:243], v6 offset:21504
    s_waitcnt lgkmcnt(6)
    v_mfma_f32_16x16x32_bf16 v[176:179], v[244:247], v[52:55], v[176:179]
    v_mfma_f32_16x16x32_bf16 v[180:183], v[248:251], v[52:55], v[180:183]
    ds_read_b128 v[244:247], v6 offset:22528
    ds_read_b128 v[248:251], v6 offset:23552
    s_waitcnt lgkmcnt(6)
    v_mfma_f32_16x16x32_bf16 v[176:179], v[220:223], v[56:59], v[176:179]
    v_mfma_f32_16x16x32_bf16 v[180:183], v[224:227], v[56:59], v[180:183]
    ds_read_b128 v[220:223], v6 offset:24576
    ds_read_b128 v[224:227], v6 offset:25600
    s_waitcnt lgkmcnt(6)
    v_mfma_f32_16x16x32_bf16 v[176:179], v[228:231], v[60:63], v[176:179]
    v_mfma_f32_16x16x32_bf16 v[180:183], v[232:235], v[60:63], v[180:183]
    ds_read_b128 v[228:231], v6 offset:26624
    ds_read_b128 v[232:235], v6 offset:27648
    s_waitcnt lgkmcnt(6)
    v_mfma_f32_16x16x32_bf16 v[176:179], v[236:239], v[64:67], v[176:179]
    v_mfma_f32_16x16x32_bf16 v[180:183], v[240:243], v[64:67], v[180:183]
    ds_read_b128 v[236:239], v6 offset:28672
    ds_read_b128 v[240:243], v6 offset:29696
    s_waitcnt lgkmcnt(6)
    v_mfma_f32_16x16x32_bf16 v[176:179], v[244:247], v[68:71], v[176:179]
    v_mfma_f32_16x16x32_bf16 v[180:183], v[248:251], v[68:71], v[180:183]
    ds_read_b128 v[244:247], v6 offset:30720
    ds_read_b128 v[248:251], v6 offset:31744
    s_waitcnt lgkmcnt(6)
    v_mfma_f32_16x16x32_bf16 v[176:179], v[220:223], v[72:75], v[176:179]
    v_mfma_f32_16x16x32_bf16 v[180:183], v[224:227], v[72:75], v[180:183]
    ds_read_b128 v[220:223], v6 offset:32768
    ds_read_b128 v[224:227], v6 offset:33792
    s_waitcnt lgkmcnt(6)
    v_mfma_f32_16x16x32_bf16 v[176:179], v[228:231], v[76:79], v[176:179]
    v_mfma_f32_16x16x32_bf16 v[180:183], v[232:235], v[76:79], v[180:183]
    ds_read_b128 v[228:231], v6 offset:34816
    ds_read_b128 v[232:235], v6 offset:35840
    s_waitcnt lgkmcnt(6)
    v_mfma_f32_16x16x32_bf16 v[176:179], v[236:239], v[80:83], v[176:179]
    v_mfma_f32_16x16x32_bf16 v[180:183], v[240:243], v[80:83], v[180:183]
    s_waitcnt lgkmcnt(4)
    v_mfma_f32_16x16x32_bf16 v[176:179], v[244:247], v[84:87], v[176:179]
    v_mfma_f32_16x16x32_bf16 v[180:183], v[248:251], v[84:87], v[180:183]
    s_waitcnt lgkmcnt(2)
    v_mfma_f32_16x16x32_bf16 v[176:179], v[220:223], v[88:91], v[176:179]
    v_mfma_f32_16x16x32_bf16 v[180:183], v[224:227], v[88:91], v[180:183]
    s_waitcnt lgkmcnt(0)
    v_mfma_f32_16x16x32_bf16 v[176:179], v[228:231], v[92:95], v[176:179]
    v_mfma_f32_16x16x32_bf16 v[180:183], v[232:235], v[92:95], v[180:183]
    s_nop 6
    v_cvt_pk_bf16_f32 v176, v176, v177
    v_cvt_pk_bf16_f32 v177, v178, v179
    v_cvt_pk_bf16_f32 v178, v180, v181
    v_cvt_pk_bf16_f32 v179, v182, v183
    s_cmp_lg_u32 s6, 2
    s_cbranch_scc1 L_nimg
    v_add_u32 v9, 131072, v20
    v_and_b32 v4, 1, v3
    v_lshl_add_u32 v10, v4, 3, v9
    v_and_b32 v4, 3, v3
    v_lshl_add_u32 v9, v4, 4, v9
    s_waitcnt vmcnt(0)
    ds_read_b64_tr_b16 v[96:97], v9 offset:0
    ds_read_b64_tr_b16 v[98:99], v9 offset:1280
    ds_read_b64_tr_b16 v[100:101], v9 offset:8
    ds_read_b64_tr_b16 v[102:103], v9 offset:1288
    ds_read_b64_tr_b16 v[104:105], v9 offset:64
    ds_read_b64_tr_b16 v[106:107], v9 offset:1344
    ds_read_b64_tr_b16 v[108:109], v9 offset:72
    ds_read_b64_tr_b16 v[110:111], v9 offset:1352
    ds_read_b64_tr_b16 v[112:113], v10 offset:128
    ds_read_b64_tr_b16 v[114:115], v10 offset:1408
L_nimg:
    v_add_u32 v8, 4096, v7
    v_add_u32 v9, 12288, v7
    s_cmp_eq_u32 s6, 3
    s_cselect_b32 s41, 0, 4096
    v_add_u32 v10, s41, v9
    v_add_u32 v12, 58368, v7
    v_add_u32 v14, 58368, v10
    v_add_u32 v13, 116736, v7
    v_add_u32 v15, 116736, v10
    s_and_b32 s34, s3, 7
    s_lshr_b32 s24, s2, 3
    s_mul_i32 s25, s24, 37
    s_lshr_b32 s25, s25, 8
    s_mul_i32 s25, s25, 7
    s_sub_u32 s38, s24, s25
    s_mul_i32 s24, s34, 19456
    s_add_u32 s24, s24, 10485760
    s_add_u32 s28, s16, s24
    s_addc_u32 s29, s17, 0
    s_mov_b32 s40, 30007
    s_waitcnt lgkmcnt(0)
    s_barrier
L_kv0_p:
    s_and_b32 s24, s40, 7
    s_cselect_b32 s24, 155648, 0
    s_add_u32 s18, s28, s24
    s_addc_u32 s19, s29, 0
    global_load_dwordx4 v[192:195], v8, s[18:19] offset:-4096 sc1
    global_load_dwordx4 v[196:199], v8, s[18:19] offset:0 sc1
    global_load_dwordx4 v[200:203], v9, s[18:19] offset:-4096 sc1
    global_load_dwordx4 v[204:207], v9, s[18:19] offset:0 sc1
    global_load_dwordx4 v[208:211], v10, s[18:19] offset:0 sc1
    s_waitcnt vmcnt(0)
L_kv0_p1:
    v_max3_u32 v5, v192, v193, v194
    v_max3_u32 v5, v195, v196, v5
    v_max3_u32 v5, v197, v198, v5
    v_max3_u32 v5, v199, v200, v5
    v_max3_u32 v5, v201, v202, v5
    v_max3_u32 v5, v203, v204, v5
    v_max3_u32 v5, v205, v206, v5
    v_max3_u32 v5, v207, v208, v5
    v_max3_u32 v5, v209, v210, v5
    v_max_u32 v5, v211, v5
    v_cmp_eq_u32 vcc, -1, v5
    s_cmp_eq_u64 vcc, 0
    s_cbranch_scc1 L_kv0_p_ok
    s_sub_u32 s40, s40, 1
    s_cbranch_scc0 L_kv0_p
L_kv0_p_ok:
    ds_write_b128 v7, v[192:195] offset:0
    ds_write_b128 v7, v[196:199] offset:4096
    ds_write_b128 v7, v[200:203] offset:8192
    ds_write_b128 v7, v[204:207] offset:12288
    ds_write_b128 v10, v[208:211]
    s_waitcnt lgkmcnt(0)
    s_barrier
    s_mov_b32 s40, 30000
    s_mov_b32 s42, 1
L_kv0_f1:
    s_add_u32 s24, s38, s42
    s_sub_u32 s25, s24, 7
    s_cmp_gt_u32 s24, 7
    s_cselect_b32 s24, s25, s24
    s_add_u32 s24, s24, s34
    s_and_b32 s24, s24, 7
    s_mul_i32 s24, s24, 19456
    s_add_u32 s24, s24, 10485760
    s_add_u32 s18, s16, s24
    s_addc_u32 s19, s17, 0
    s_mul_i32 s24, s42, 19456
    s_lshl_b32 s25, s6, 10
    s_add_u32 m0, s24, s25
    s_add_u32 s42, s42, 1
    global_load_lds_dwordx4 v7, s[18:19] sc1
    s_add_u32 m0, m0, 4096
    s_add_u32 s18, s18, 4096
    s_addc_u32 s19, s19, 0
    global_load_lds_dwordx4 v7, s[18:19] sc1
    s_add_u32 m0, m0, 4096
    s_add_u32 s18, s18, 4096
    s_addc_u32 s19, s19, 0
    global_load_lds_dwordx4 v7, s[18:19] sc1
    s_add_u32 m0, m0, 4096
    s_add_u32 s18, s18, 4096
    s_addc_u32 s19, s19, 0
    global_load_lds_dwordx4 v7, s[18:19] sc1
    s_add_u32 m0, m0, s41
    s_add_u32 s18, s18, s41
    s_addc_u32 s19, s19, 0
    global_load_lds_dwordx4 v7, s[18:19] sc1
    s_cmp_lt_u32 s42, 4
    s_cbranch_scc1 L_kv0_f1
    s_mov_b32 s42, 7
L_kv0_f2:
    s_add_u32 s24, s38, s42
    s_sub_u32 s25, s24, 7
    s_cmp_gt_u32 s24, 7
    s_cselect_b32 s24, s25, s24
    s_add_u32 s24, s24, s34
    s_and_b32 s24, s24, 7
    s_mul_i32 s24, s24, 19456
    s_add_u32 s24, s24, 10485760
    s_add_u32 s18, s16, s24
    s_addc_u32 s19, s17, 0
    s_mul_i32 s24, s42, 19456
    s_lshl_b32 s25, s6, 10
    s_add_u32 m0, s24, s25
    s_add_u32 s42, s42, 1
    global_load_lds_dwordx4 v7, s[18:19] sc1
    s_add_u32 m0, m0, 4096
    s_add_u32 s18, s18, 4096
    s_addc_u32 s19, s19, 0
    global_load_lds_dwordx4 v7, s[18:19] sc1
    s_add_u32 m0, m0, 4096
    s_add_u32 s18, s18, 4096
    s_addc_u32 s19, s19, 0
    global_load_lds_dwordx4 v7, s[18:19] sc1
    s_add_u32 m0, m0, 4096
    s_add_u32 s18, s18, 4096
    s_addc_u32 s19, s19, 0
    global_load_lds_dwordx4 v7, s[18:19] sc1
    s_add_u32 m0, m0, s41
    s_add_u32 s18, s18, s41
    s_addc_u32 s19, s19, 0
    global_load_lds_dwordx4 v7, s[18:19] sc1
    s_waitcnt vmcnt(15)
L_kv0_v1:
    ds_read2st64_b32 v[192:193], v7 offset0:76 offset1:92
    ds_read2st64_b32 v[194:195], v7 offset0:108 offset1:124
    ds_read_b32 v225, v10 offset:19456
    s_waitcnt lgkmcnt(0)
    v_max3_u32 v5, v192, v193, v194
    v_max3_u32 v5, v195, v225, v5
    v_cmp_eq_u32 vcc, -1, v5
    s_cbranch_vccnz L_kv0_r1
L_kv0_b1:
    v_mov_b32 v5, 160832
    v_mov_b32 v11, -1
    s_mov_b64 exec, 1
    ds_inc_u32 v5, v11
    s_mov_b64 exec, -1
    s_cmp_ge_u32 s3, 18
    s_cbranch_scc1 L_np2
    v_mov_b32 v5, 162800
    s_cmp_lg_u32 s6, 1
    s_cbranch_scc1 L_np2
    ds_read_b128 v[24:27], v6 offset:0
    ds_read_b128 v[28:31], v6 offset:1024
    ds_read_b128 v[32:35], v6 offset:2048
    ds_read_b128 v[36:39], v6 offset:3072
    ds_read_b128 v[40:43], v6 offset:4096
    ds_read_b128 v[44:47], v6 offset:5120
    ds_read_b128 v[48:51], v6 offset:6144
    ds_read_b128 v[52:55], v6 offset:7168
    s_waitcnt lgkmcnt(6)
    v_mfma_f32_16x16x32_bf16 v[184:187], v[24:27], v[96:99], 0
    v_mfma_f32_16x16x32_bf16 v[188:191], v[28:31], v[96:99], 0
    ds_read_b128 v[24:27], v6 offset:8192
    ds_read_b128 v[28:31], v6 offset:9216
    s_waitcnt lgkmcnt(6)
    v_mfma_f32_16x16x32_bf16 v[184:187], v[32:35], v[100:103], v[184:187]
    v_mfma_f32_16x16x32_bf16 v[188:191], v[36:39], v[100:103], v[188:191]
    ds_read_b128 v[32:35], v6 offset:10240
    ds_read_b128 v[36:39], v6 offset:11264
    s_waitcnt lgkmcnt(6)
    v_mfma_f32_16x16x32_bf16 v[184:187], v[40:43], v[104:107], v[184:187]
    v_mfma_f32_16x16x32_bf16 v[188:191], v[44:47], v[104:107], v[188:191]
    ds_read_b128 v[40:43], v6 offset:12288
    ds_read_b128 v[44:47], v6 offset:13312
    s_waitcnt lgkmcnt(6)
    v_mfma_f32_16x16x32_bf16 v[184:187], v[48:51], v[108:111], v[184:187]
    v_mfma_f32_16x16x32_bf16 v[188:191], v[52:55], v[108:111], v[188:191]
    ds_read_b128 v[48:51], v6 offset:14336
    ds_read_b128 v[52:55], v6 offset:15360
    s_waitcnt lgkmcnt(6)
    v_mfma_f32_16x16x32_bf16 v[184:187], v[24:27], v[112:115], v[184:187]
    v_mfma_f32_16x16x32_bf16 v[188:191], v[28:31], v[112:115], v[188:191]
    ds_read_b128 v[24:27], v6 offset:16384
    ds_read_b128 v[28:31], v6 offset:17408
    s_waitcnt lgkmcnt(6)
    v_mfma_f32_16x16x32_bf16 v[184:187], v[32:35], v[116:119], v[184:187]
    v_mfma_f32_16x16x32_bf16 v[188:191], v[36:39], v[116:119], v[188:191]
    ds_read_b128 v[32:35], v6 offset:18432
    ds_read_b128 v[36:39], v6 offset:19456
    s_waitcnt lgkmcnt(6)
    v_mfma_f32_16x16x32_bf16 v[184:187], v[40:43], v[120:123], v[184:187]
    v_mfma_f32_16x16x32_bf16 v[188:191], v[44:47], v[120:123], v[188:191]
    ds_read_b128 v[40:43], v6 offset:20480
    ds_read_b128 v[44:47], v6 offset:21504
    s_waitcnt lgkmcnt(6)
    v_mfma_f32_16x16x32_bf16 v[184:187], v[48:51], v[124:127], v[184:187]
    v_mfma_f32_16x16x32_bf16 v[188:191], v[52:55], v[124:127], v[188:191]
    ds_read_b128 v[48:51], v6 offset:22528
    ds_read_b128 v[52:55], v6 offset:23552
    s_waitcnt lgkmcnt(6)
    v_mfma_f32_16x16x32_bf16 v[184:187], v[24:27], v[128:131], v[184:187]
    v_mfma_f32_16x16x32_bf16 v[188:191], v[28:31], v[128:131], v[188:191]
    ds_read_b128 v[24:27], v6 offset:24576
    ds_read_b128 v[28:31], v6 offset:25600
    s_waitcnt lgkmcnt(6)
    v_mfma_f32_16x16x32_bf16 v[184:187], v[32:35], v[132:135], v[184:187]
    v_mfma_f32_16x16x32_bf16 v[188:191], v[36:39], v[132:135], v[188:191]
    ds_read_b128 v[32:35], v6 offset:26624
    ds_read_b128 v[36:39], v6 offset:27648
    s_waitcnt lgkmcnt(6)
    v_mfma_f32_16x16x32_bf16 v[184:187], v[40:43], v[136:139], v[184:187]
    v_mfma_f32_16x16x32_bf16 v[188:191], v[44:47], v[136:139], v[188:191]
    ds_read_b128 v[40:43], v6 offset:28672
    ds_read_b128 v[44:47], v6 offset:29696
    s_waitcnt lgkmcnt(6)
    v_mfma_f32_16x16x32_bf16 v[184:187], v[48:51], v[140:143], v[184:187]
    v_mfma_f32_16x16x32_bf16 v[188:191], v[52:55], v[140:143], v[188:191]
    ds_read_b128 v[48:51], v6 offset:30720
    ds_read_b128 v[52:55], v6 offset:31744
    s_waitcnt lgkmcnt(6)
    v_mfma_f32_16x16x32_bf16 v[184:187], v[24:27], v[144:147], v[184:187]
    v_mfma_f32_16x16x32_bf16 v[188:191], v[28:31], v[144:147], v[188:191]
    ds_read_b128 v[24:27], v6 offset:32768
    ds_read_b128 v[28:31], v6 offset:33792
    s_waitcnt lgkmcnt(6)
    v_mfma_f32_16x16x32_bf16 v[184:187], v[32:35], v[148:151], v[184:187]
    v_mfma_f32_16x16x32_bf16 v[188:191], v[36:39], v[148:151], v[188:191]
    ds_read_b128 v[32:35], v6 offset:34816
    ds_read_b128 v[36:39], v6 offset:35840
    s_waitcnt lgkmcnt(6)
    v_mfma_f32_16x16x32_bf16 v[184:187], v[40:43], v[152:155], v[184:187]
    v_mfma_f32_16x16x32_bf16 v[188:191], v[44:47], v[152:155], v[188:191]
    s_waitcnt lgkmcnt(4)
    v_mfma_f32_16x16x32_bf16 v[184:187], v[48:51], v[156:159], v[184:187]
    v_mfma_f32_16x16x32_bf16 v[188:191], v[52:55], v[156:159], v[188:191]
    s_waitcnt lgkmcnt(2)
    v_mfma_f32_16x16x32_bf16 v[184:187], v[24:27], v[160:163], v[184:187]
    v_mfma_f32_16x16x32_bf16 v[188:191], v[28:31], v[160:163], v[188:191]
    s_waitcnt lgkmcnt(0)
    v_mfma_f32_16x16x32_bf16 v[184:187], v[32:35], v[164:167], v[184:187]
    v_mfma_f32_16x16x32_bf16 v[188:191], v[36:39], v[164:167], v[188:191]
    s_nop 6
    v_cvt_pk_bf16_f32 v184, v184, v185
    v_cvt_pk_bf16_f32 v185, v186, v187
    v_cvt_pk_bf16_f32 v186, v188, v189
    v_cvt_pk_bf16_f32 v187, v190, v191
    ds_write_b32 v5, v16
L_np2:
    s_waitcnt vmcnt(5)
L_kv0_v2:
    ds_read2st64_b32 v[192:193], v7 offset0:152 offset1:168
    ds_read2st64_b32 v[194:195], v7 offset0:184 offset1:200
    ds_read_b32 v226, v10 offset:38912
    ds_read2st64_b32 v[196:197], v12 offset0:0 offset1:16
    ds_read2st64_b32 v[198:199], v12 offset0:32 offset1:48
    ds_read_b32 v227, v14 offset:0
    s_waitcnt lgkmcnt(0)
    v_max3_u32 v5, v192, v193, v194
    v_max3_u32 v5, v195, v196, v5
    v_max3_u32 v5, v197, v198, v5
    v_max3_u32 v5, v199, v226, v5
    v_max_u32 v5, v227, v5
    v_cmp_eq_u32 vcc, -1, v5
    s_cbranch_vccnz L_kv0_r2
L_kv0_b2:
    v_lshlrev_b32 v5, 2, v1
    v_add_u32 v5, 160836, v5
    v_mov_b32 v11, -1
    s_mov_b64 exec, 3
    ds_inc_u32 v5, v11
    s_mov_b64 exec, -1
    s_cmp_ge_u32 s3, 18
    s_cbranch_scc1 L_pollj3_ok
    v_mov_b32 v5, 162800
    s_mul_i32 s24, s4, 9
    s_lshr_b32 s24, s24, 2
    s_sub_u32 s24, s3, s24
    s_add_u32 s24, s24, 15
    s_sub_u32 s25, s24, 18
    s_min_u32 s24, s24, s25
    s_mul_i32 s24, s24, 5120
    s_mul_i32 s25, s4, 92160
    s_add_u32 s24, s24, s25
    s_add_u32 s24, s24, 8388608
    s_add_u32 s18, s16, s24
    s_addc_u32 s19, s17, 0
    s_cmp_eq_u32 s6, 1
    s_cbranch_scc1 L_nst1
    global_store_dwordx4 v7, v[176:179], s[18:19] sc1
    s_cmp_lg_u32 s6, 2
    s_cbranch_scc1 L_nst
    s_add_u32 s18, s18, 786432
    s_addc_u32 s19, s19, 0
    global_store_dwordx4 v7, v[96:99], s[18:19] offset:-2048 sc1
    global_store_dwordx4 v7, v[100:103], s[18:19] offset:-1024 sc1
    global_store_dwordx4 v7, v[104:107], s[18:19] offset:0 sc1
    global_store_dwordx4 v7, v[108:111], s[18:19] offset:1024 sc1
    global_store_dwordx4 v7, v[112:115], s[18:19] offset:2048 sc1
    s_branch L_nst
L_nst1:
    global_store_dwordx4 v7, v[176:179], s[18:19] offset:3072 sc1
    global_store_dwordx4 v7, v[184:187], s[18:19] sc1
L_nst:
L_pollj3:
    s_sleep 1
    ds_read_b32 v11, v5
    s_waitcnt lgkmcnt(0)
    v_readfirstlane_b32 s24, v11
    s_cmp_lg_u32 s24, 0
    s_cbranch_scc1 L_pollj3_ok
    s_sub_u32 s40, s40, 1
    s_cbranch_scc0 L_pollj3
L_pollj3_ok:
    s_mov_b32 s42, 4
L_kv0_f3:
    s_add_u32 s24, s38, s42
    s_sub_u32 s25, s24, 7
    s_cmp_gt_u32 s24, 7
    s_cselect_b32 s24, s25, s24
    s_add_u32 s24, s24, s34
    s_and_b32 s24, s24, 7
    s_mul_i32 s24, s24, 19456
    s_add_u32 s24, s24, 10485760
    s_add_u32 s18, s16, s24
    s_addc_u32 s19, s17, 0
    s_mul_i32 s24, s42, 19456
    s_lshl_b32 s25, s6, 10
    s_add_u32 m0, s24, s25
    s_add_u32 s42, s42, 1
    global_load_lds_dwordx4 v7, s[18:19] sc1
    s_add_u32 m0, m0, 4096
    s_add_u32 s18, s18, 4096
    s_addc_u32 s19, s19, 0
    global_load_lds_dwordx4 v7, s[18:19] sc1
    s_add_u32 m0, m0, 4096
    s_add_u32 s18, s18, 4096
    s_addc_u32 s19, s19, 0
    global_load_lds_dwordx4 v7, s[18:19] sc1
    s_add_u32 m0, m0, 4096
    s_add_u32 s18, s18, 4096
    s_addc_u32 s19, s19, 0
    global_load_lds_dwordx4 v7, s[18:19] sc1
    s_add_u32 m0, m0, s41
    s_add_u32 s18, s18, s41
    s_addc_u32 s19, s19, 0
    global_load_lds_dwordx4 v7, s[18:19] sc1
    s_cmp_lt_u32 s42, 7
    s_cbranch_scc1 L_kv0_f3
    global_load_dword v232, v8, s[28:29] offset:-4096 sc1
    global_load_dword v233, v8, s[28:29] offset:0 sc1
    global_load_dword v234, v9, s[28:29] offset:-4096 sc1
    global_load_dword v235, v9, s[28:29] offset:0 sc1
    global_load_dword v236, v10, s[28:29] offset:0 sc1
    s_waitcnt vmcnt(0)
L_kv0_v4:
    ds_read2st64_b32 v[192:193], v12 offset0:76 offset1:92
    ds_read2st64_b32 v[194:195], v12 offset0:108 offset1:124
    ds_read_b32 v228, v14 offset:19456
    ds_read2st64_b32 v[196:197], v12 offset0:152 offset1:168
    ds_read2st64_b32 v[198:199], v12 offset0:184 offset1:200
    ds_read_b32 v229, v14 offset:38912
    ds_read2st64_b32 v[200:201], v13 offset0:0 offset1:16
    ds_read2st64_b32 v[202:203], v13 offset0:32 offset1:48
    ds_read_b32 v230, v15 offset:0
    ds_read2st64_b32 v[204:205], v13 offset0:76 offset1:92
    ds_read2st64_b32 v[206:207], v13 offset0:108 offset1:124
    ds_read_b32 v231, v15 offset:19456
    s_waitcnt lgkmcnt(0)
    v_max3_u32 v5, v192, v193, v194
    v_max3_u32 v5, v195, v196, v5
    v_max3_u32 v5, v197, v198, v5
    v_max3_u32 v5, v199, v200, v5
    v_max3_u32 v5, v201, v202, v5
    v_max3_u32 v5, v203, v204, v5
    v_max3_u32 v5, v205, v206, v5
    v_max3_u32 v5, v207, v228, v5
    v_max3_u32 v5, v229, v230, v5
    v_max3_u32 v5, v231, v232, v5
    v_max3_u32 v5, v233, v234, v5
    v_max3_u32 v5, v235, v236, v5
    v_cmp_eq_u32 vcc, -1, v5
    s_cbranch_vccnz L_kv0_r4
L_kv0_b4:
    v_lshlrev_b32 v5, 2, v1
    v_add_u32 v5, 160844, v5
    v_mov_b32 v11, -1
    s_mov_b64 exec, 31
    ds_inc_u32 v5, v11
    s_mov_b64 exec, -1
    s_and_b32 s25, s2, 7
    s_mul_i32 s24, s52, 162
    v_lshrrev_b32 v6, 4, v7
    v_min_u32 v6, 161, v6
    v_add_u32 v6, s24, v6
    v_mul_u32_u24 v5, 7282, v6
    v_lshrrev_b32 v5, 16, v5
    s_mul_i32 s25, s25, 1152
    v_lshl_add_u32 v6, v6, 7, s25
    s_mov_b32 s24, 8064
    v_mad_u32_u24 v5, v5, s24, v6
    global_load_dword v253, v5, s[8:9] nt
    global_load_dword v254, v5, s[10:11] nt
    s_and_b32 s26, s2, 7
    s_mul_i32 s24, s26, 18
    s_add_u32 s39, s24, s52
    s_cmp_lt_u32 s52, 18
    s_cbranch_scc1 L_nres
    s_sub_u32 s39, s52, 18
    s_lshl_b32 s39, s39, 3
    s_add_u32 s39, s39, s26
    s_setprio 0
    s_mul_i32 s24, s39, 36864
    s_add_u32 s24, s24, 4096
    s_add_u32 s18, s16, s24
    s_addc_u32 s19, s17, 0
    global_store_dwordx4 v7, v[16:19], s[18:19] offset:-4096 sc1
    global_store_dwordx4 v7, v[16:19], s[18:19] offset:0 sc1
    s_add_u32 s18, s18, 8192
    s_addc_u32 s19, s19, 0
    global_store_dwordx4 v7, v[16:19], s[18:19] offset:-4096 sc1
    global_store_dwordx4 v7, v[16:19], s[18:19] offset:0 sc1
    s_add_u32 s18, s18, 8192
    s_addc_u32 s19, s19, 0
    global_store_dwordx4 v7, v[16:19], s[18:19] offset:-4096 sc1
    global_store_dwordx4 v7, v[16:19], s[18:19] offset:0 sc1
    s_add_u32 s18, s18, 8192
    s_addc_u32 s19, s19, 0
    global_store_dwordx4 v7, v[16:19], s[18:19] offset:-4096 sc1
    global_store_dwordx4 v7, v[16:19], s[18:19] offset:0 sc1
    s_add_u32 s18, s18, 8192
    s_addc_u32 s19, s19, 0
    global_store_dwordx4 v7, v[16:19], s[18:19] offset:-4096 sc1
    s_setprio 3
    s_waitcnt vmcnt(0)
L_nres:
    s_getreg_b32 s37, hwreg(HW_REG_XCC_ID)
    s_and_b32 s37, s37, 15
    s_lshl_b32 s24, s6, 2
    s_add_u32 s24, s24, 160816
    v_mov_b32 v4, s24
    ds_write_b32 v4, v16
    s_cmp_lg_u32 s6, 3
    s_cbranch_scc1 L_nrdy
    v_mov_b32 v5, 160816
    s_mov_b32 s40, 524288
L_pollj2:
    ds_read_b128 v[8:11], v5
    s_waitcnt lgkmcnt(0)
    v_and_b32 v8, v8, v9
    v_and_b32 v10, v10, v11
    v_and_b32 v8, v8, v10
    s_nop 0
    v_readfirstlane_b32 s24, v8
    s_cmp_lg_u32 s24, 0
    s_cbranch_scc1 L_pollj2_ok
    s_sub_u32 s40, s40, 1
    s_cbranch_scc0 L_pollj2
L_pollj2_ok:
    s_lshl_b32 s24, s3, 7
    s_lshl_b32 s25, s4, 2
    s_add_u32 s24, s24, s25
    s_add_u32 s24, s24, 10797056
    v_mov_b32 v9, s24
    v_mov_b32 v10, s37
    s_mov_b64 exec, 1
    global_store_dword v9, v10, s[16:17] sc1
    s_mov_b64 exec, -1
L_nrdy:
    s_cmp_ge_u32 s52, 18
    s_cbranch_scc1 L_nold
    s_lshl_b32 s24, s39, 6
    s_mul_i32 s25, s6, 1327104
    s_add_u32 s24, s24, s25
    v_and_b32 v9, 3, v1
    v_lshl_add_u32 v9, v9, 4, s24
    v_lshrrev_b32 v5, 2, v1
    v_lshl_add_u32 v4, v2, 2, v5
    s_movk_i32 s24, 9216
    v_mad_u32_u24 v4, v4, s24, v9
    v_mad_u32_u24 v5, v5, s24, v9
    global_load_dwordx4 v[32:35], v4, s[8:9]
    s_add_u32 s8, s8, 36864
    s_addc_u32 s9, s9, 0
    global_load_dwordx4 v[40:43], v4, s[10:11]
    s_add_u32 s10, s10, 36864
    s_addc_u32 s11, s11, 0
    global_load_dwordx4 v[36:39], v4, s[8:9]
    s_add_u32 s8, s8, 258048
    s_addc_u32 s9, s9, 0
    global_load_dwordx4 v[44:47], v4, s[10:11]
    s_add_u32 s10, s10, 258048
    s_addc_u32 s11, s11, 0
    global_load_dwordx4 v[48:51], v4, s[8:9]
    s_add_u32 s8, s8, 36864
    s_addc_u32 s9, s9, 0
    global_load_dwordx4 v[56:59], v4, s[10:11]
    s_add_u32 s10, s10, 36864
    s_addc_u32 s11, s11, 0
    global_load_dwordx4 v[52:55], v4, s[8:9]
    s_add_u32 s8, s8, 258048
    s_addc_u32 s9, s9, 0
    global_load_dwordx4 v[60:63], v4, s[10:11]
    s_add_u32 s10, s10, 258048
    s_addc_u32 s11, s11, 0
    global_load_dwordx4 v[64:67], v4, s[8:9]
    s_add_u32 s8, s8, 36864
    s_addc_u32 s9, s9, 0
    global_load_dwordx4 v[72:75], v4, s[10:11]
    s_add_u32 s10, s10, 36864
    s_addc_u32 s11, s11, 0
    global_load_dwordx4 v[68:71], v4, s[8:9]
    s_add_u32 s8, s8, 258048
    s_addc_u32 s9, s9, 0
    global_load_dwordx4 v[76:79], v4, s[10:11]
    s_add_u32 s10, s10, 258048
    s_addc_u32 s11, s11, 0
    global_load_dwordx4 v[80:83], v4, s[8:9]
    s_add_u32 s8, s8, 36864
    s_addc_u32 s9, s9, 0
    global_load_dwordx4 v[88:91], v4, s[10:11]
    s_add_u32 s10, s10, 36864
    s_addc_u32 s11, s11, 0
    global_load_dwordx4 v[84:87], v4, s[8:9]
    s_add_u32 s8, s8, 258048
    s_addc_u32 s9, s9, 0
    global_load_dwordx4 v[92:95], v4, s[10:11]
    s_add_u32 s10, s10, 258048
    s_addc_u32 s11, s11, 0
    global_load_dwordx4 v[96:99], v5, s[8:9]
    global_load_dwordx4 v[100:103], v5, s[10:11]
    s_mul_i32 s24, s39, 36864
    s_mul_i32 s25, s6, 288
    s_add_u32 s24, s24, s25
    s_add_u32 s12, s12, s24
    s_addc_u32 s13, s13, 0
    v_lshrrev_b32 v9, 1, v1
    v_mul_u32_u24 v8, 1152, v9
    v_and_b32 v11, 1, v1
    v_lshl_add_u32 v8, v11, 4, v8
    global_load_dwordx4 v[104:107], v8, s[12:13] offset:0
    global_load_dwordx4 v[120:123], v8, s[12:13] offset:128
    global_load_dwordx4 v[136:139], v8, s[12:13] offset:256
    global_load_dwordx4 v[108:111], v8, s[12:13] offset:32
    global_load_dwordx4 v[112:115], v8, s[12:13] offset:64
    global_load_dwordx4 v[116:119], v8, s[12:13] offset:96
    global_load_dwordx4 v[124:127], v8, s[12:13] offset:160
    global_load_dwordx4 v[128:131], v8, s[12:13] offset:192
    global_load_dwordx4 v[132:135], v8, s[12:13] offset:224
L_nold:
    s_add_u32 s18, s16, 10797056
    s_addc_u32 s19, s17, 0
    v_mov_b32 v10, 4096
    s_lshl_b32 s24, s6, 8
    s_add_u32 s24, s24, s2
    s_mov_b32 s40, 30000
    s_cmp_lg_u32 s24, 1023
    s_cbranch_scc1 L_pollg
    v_lshrrev_b32 v9, 1, v1
    v_lshlrev_b32 v9, 7, v9
    v_and_b32 v11, 1, v1
    v_lshl_add_u32 v9, v11, 4, v9
L_pollr0:
    s_sleep 4
    global_load_dwordx4 v[12:15], v9, s[18:19] sc1
    s_waitcnt vmcnt(0)
    v_max3_u32 v11, v12, v13, v14
    v_max_u32 v11, v15, v11
    v_cmp_eq_u32 vcc, -1, v11
    s_cmp_eq_u64 vcc, 0
    s_cbranch_scc1 L_pollr0_ok
    s_sub_u32 s40, s40, 1
    s_cbranch_scc0 L_pollr0
L_pollr0_ok:
    s_mov_b64 exec, 1
    global_store_dword v10, v10, s[18:19] sc1
    s_mov_b64 exec, -1
    s_mov_b32 s40, 30000
L_pollg:
L_pollg0:
    s_sleep 12
    global_load_dword v11, v10, s[18:19] sc1
    s_waitcnt vmcnt(0)
    v_readfirstlane_b32 s24, v11
    s_cmp_lg_u32 s24, -1
    s_cbranch_scc1 L_pollg0_ok
    s_sub_u32 s40, s40, 1
    s_cbranch_scc0 L_pollg0
L_pollg0_ok:
    s_cmp_lg_u32 s6, 2
    s_cbranch_scc1 L_nmode
    s_lshl_b32 s24, s3, 7
    v_and_b32 v9, 7, v1
    v_lshl_add_u32 v9, v9, 2, s24
    global_load_dword v11, v9, s[18:19] sc1
    s_waitcnt vmcnt(0)
    v_cmp_ne_u32 vcc, s37, v11
    s_cmp_eq_u64 vcc, 0
    s_cselect_b32 s55, 1, 2
    v_mov_b32 v11, s55
    v_mov_b32 v9, 160772
    ds_write_b32 v9, v11
L_nmode:
    s_mul_i32 s24, s4, 92160
    s_add_u32 s25, s24, 8388608
    s_add_u32 s18, s16, s25
    s_addc_u32 s19, s17, 0
    global_load_dwordx4 v[140:143], v7, s[18:19] sc1
    s_add_u32 s18, s18, 4096
    s_addc_u32 s19, s19, 0
    global_load_dwordx4 v[144:147], v7, s[18:19] sc1
    s_add_u32 s18, s18, 4096
    s_addc_u32 s19, s19, 0
    global_load_dwordx4 v[148:151], v7, s[18:19] sc1
    s_add_u32 s18, s18, 4096
    s_addc_u32 s19, s19, 0
    global_load_dwordx4 v[152:155], v7, s[18:19] sc1
    s_add_u32 s18, s18, 4096
    s_addc_u32 s19, s19, 0
    global_load_dwordx4 v[156:159], v7, s[18:19] sc1
    s_add_u32 s18, s18, 4096
    s_addc_u32 s19, s19, 0
    global_load_dwordx4 v[160:163], v7, s[18:19] sc1
    s_add_u32 s18, s18, 4096
    s_addc_u32 s19, s19, 0
    global_load_dwordx4 v[164:167], v7, s[18:19] sc1
    s_add_u32 s18, s18, 4096
    s_addc_u32 s19, s19, 0
    global_load_dwordx4 v[168:171], v7, s[18:19] sc1
    s_add_u32 s18, s18, 4096
    s_addc_u32 s19, s19, 0
    global_load_dwordx4 v[172:175], v7, s[18:19] sc1
    s_add_u32 s18, s18, 4096
    s_addc_u32 s19, s19, 0
    global_load_dwordx4 v[176:179], v7, s[18:19] sc1
    s_add_u32 s18, s18, 4096
    s_addc_u32 s19, s19, 0
    global_load_dwordx4 v[180:183], v7, s[18:19] sc1
    s_add_u32 s18, s18, 4096
    s_addc_u32 s19, s19, 0
    global_load_dwordx4 v[184:187], v7, s[18:19] sc1
    s_add_u32 s18, s18, 4096
    s_addc_u32 s19, s19, 0
    global_load_dwordx4 v[188:191], v7, s[18:19] sc1
    s_add_u32 s18, s18, 4096
    s_addc_u32 s19, s19, 0
    global_load_dwordx4 v[192:195], v7, s[18:19] sc1
    s_add_u32 s18, s18, 4096
    s_addc_u32 s19, s19, 0
    global_load_dwordx4 v[196:199], v7, s[18:19] sc1
    s_add_u32 s18, s18, 4096
    s_addc_u32 s19, s19, 0
    global_load_dwordx4 v[200:203], v7, s[18:19] sc1
    s_add_u32 s18, s18, 4096
    s_addc_u32 s19, s19, 0
    global_load_dwordx4 v[204:207], v7, s[18:19] sc1
    s_add_u32 s18, s18, 4096
    s_addc_u32 s19, s19, 0
    global_load_dwordx4 v[208:211], v7, s[18:19] sc1
    s_add_u32 s18, s18, 4096
    s_addc_u32 s19, s19, 0
    global_load_dwordx4 v[212:215], v7, s[18:19] sc1
    s_add_u32 s18, s18, 4096
    s_addc_u32 s19, s19, 0
    global_load_dwordx4 v[216:219], v7, s[18:19] sc1
    s_add_u32 s18, s18, 4096
    s_addc_u32 s19, s19, 0
    global_load_dwordx4 v[220:223], v7, s[18:19] sc1
    s_add_u32 s18, s18, 4096
    s_addc_u32 s19, s19, 0
    global_load_dwordx4 v[224:227], v7, s[18:19] sc1
    s_add_u32 s18, s18, 4096
    s_addc_u32 s19, s19, 0
    global_load_dwordx4 v[228:231], v7, s[18:19] sc1
    s_cmp_lt_u32 s52, 18
    s_cbranch_scc1 L_tr
    s_setprio 0
    s_mul_i32 s24, s39, 36864
    s_add_u32 s24, s24, 4198400
    s_add_u32 s18, s16, s24
    s_addc_u32 s19, s17, 0
    global_store_dwordx4 v7, v[16:19], s[18:19] offset:-4096 sc1
    global_store_dwordx4 v7, v[16:19], s[18:19] offset:0 sc1
    s_add_u32 s18, s18, 8192
    s_addc_u32 s19, s19, 0
    global_store_dwordx4 v7, v[16:19], s[18:19] offset:-4096 sc1
    global_store_dwordx4 v7, v[16:19], s[18:19] offset:0 sc1
    s_add_u32 s18, s18, 8192
    s_addc_u32 s19, s19, 0
    global_store_dwordx4 v7, v[16:19], s[18:19] offset:-4096 sc1
    global_store_dwordx4 v7, v[16:19], s[18:19] offset:0 sc1
    s_add_u32 s18, s18, 8192
    s_addc_u32 s19, s19, 0
    global_store_dwordx4 v7, v[16:19], s[18:19] offset:-4096 sc1
    global_store_dwordx4 v7, v[16:19], s[18:19] offset:0 sc1
    s_add_u32 s18, s18, 8192
    s_addc_u32 s19, s19, 0
    global_store_dwordx4 v7, v[16:19], s[18:19] offset:-4096 sc1
    s_setprio 3
    s_branch L_notr
L_tr:
    s_lshl_b32 s24, s6, 10
    s_add_u32 s24, s24, 155648
    v_lshrrev_b32 v8, 2, v1
    v_lshlrev_b32 v8, 6, v8
    v_and_b32 v9, 3, v1
    v_lshl_add_u32 v8, v9, 3, v8
    v_add_u32 v8, s24, v8
    v_lshl_add_u32 v9, v1, 4, s24
    v_lshlrev_b32 v10, 8, v2
    v_lshrrev_b32 v11, 2, v3
    v_lshl_add_u32 v10, v11, 5, v10
    v_and_b32 v11, 3, v3
    v_lshl_add_u32 v10, v11, 3, v10
    v_add_u32 v10, s24, v10
    s_waitcnt vmcnt(23)
    s_setprio 0
    ds_write_b128 v9, v[32:35]
    ds_read_b64_tr_b16 v[24:25], v8
    ds_read_b64_tr_b16 v[28:29], v8 offset:32
    ds_write_b128 v9, v[36:39]
    ds_read_b64_tr_b16 v[26:27], v8
    ds_read_b64_tr_b16 v[30:31], v8 offset:32
    ds_write_b128 v9, v[40:43]
    ds_read_b64_tr_b16 v[32:33], v8
    ds_read_b64_tr_b16 v[36:37], v8 offset:32
    ds_write_b128 v9, v[44:47]
    ds_read_b64_tr_b16 v[34:35], v8
    ds_read_b64_tr_b16 v[38:39], v8 offset:32
    ds_write_b128 v9, v[48:51]
    ds_read_b64_tr_b16 v[40:41], v8
    ds_read_b64_tr_b16 v[44:45], v8 offset:32
    ds_write_b128 v9, v[52:55]
    ds_read_b64_tr_b16 v[42:43], v8
    ds_read_b64_tr_b16 v[46:47], v8 offset:32
    ds_write_b128 v9, v[56:59]
    ds_read_b64_tr_b16 v[48:49], v8
    ds_read_b64_tr_b16 v[52:53], v8 offset:32
    ds_write_b128 v9, v[60:63]
    ds_read_b64_tr_b16 v[50:51], v8
    ds_read_b64_tr_b16 v[54:55], v8 offset:32
    ds_write_b128 v9, v[64:67]
    ds_read_b64_tr_b16 v[56:57], v8
    ds_read_b64_tr_b16 v[60:61], v8 offset:32
    ds_write_b128 v9, v[68:71]
    ds_read_b64_tr_b16 v[58:59], v8
    ds_read_b64_tr_b16 v[62:63], v8 offset:32
    ds_write_b128 v9, v[72:75]
    ds_read_b64_tr_b16 v[64:65], v8
    ds_read_b64_tr_b16 v[68:69], v8 offset:32
    ds_write_b128 v9, v[76:79]
    ds_read_b64_tr_b16 v[66:67], v8
    ds_read_b64_tr_b16 v[70:71], v8 offset:32
    ds_write_b128 v9, v[80:83]
    ds_read_b64_tr_b16 v[72:73], v8
    ds_read_b64_tr_b16 v[76:77], v8 offset:32
    ds_write_b128 v9, v[84:87]
    ds_read_b64_tr_b16 v[74:75], v8
    ds_read_b64_tr_b16 v[78:79], v8 offset:32
    ds_write_b128 v9, v[88:91]
    ds_read_b64_tr_b16 v[80:81], v8
    ds_read_b64_tr_b16 v[84:85], v8 offset:32
    ds_write_b128 v9, v[92:95]
    ds_read_b64_tr_b16 v[82:83], v8
    ds_read_b64_tr_b16 v[86:87], v8 offset:32
    ds_write_b128 v9, v[96:99]
    ds_read_b64_tr_b16 v[96:97], v8
    ds_read_b64_tr_b16 v[98:99], v8 offset:32
    ds_write_b128 v9, v[100:103]
    ds_read_b64_tr_b16 v[100:101], v8
    ds_read_b64_tr_b16 v[102:103], v8 offset:32
    ds_write_b128 v9, v[104:107]
    ds_read_b64_tr_b16 v[104:105], v10
    ds_read_b64_tr_b16 v[106:107], v10 offset:128
    ds_write_b128 v9, v[108:111]
    ds_read_b64_tr_b16 v[108:109], v10
    ds_read_b64_tr_b16 v[110:111], v10 offset:128
    ds_write_b128 v9, v[112:115]
    ds_read_b64_tr_b16 v[112:113], v10
    ds_read_b64_tr_b16 v[114:115], v10 offset:128
    ds_write_b128 v9, v[116:119]
    ds_read_b64_tr_b16 v[116:117], v10
    ds_read_b64_tr_b16 v[118:119], v10 offset:128
    ds_write_b128 v9, v[120:123]
    ds_read_b64_tr_b16 v[120:121], v10
    ds_read_b64_tr_b16 v[122:123], v10 offset:128
    ds_write_b128 v9, v[124:127]
    ds_read_b64_tr_b16 v[124:125], v10
    ds_read_b64_tr_b16 v[126:127], v10 offset:128
    ds_write_b128 v9, v[128:131]
    ds_read_b64_tr_b16 v[128:129], v10
    ds_read_b64_tr_b16 v[130:131], v10 offset:128
    ds_write_b128 v9, v[132:135]
    ds_read_b64_tr_b16 v[132:133], v10
    ds_read_b64_tr_b16 v[134:135], v10 offset:128
    ds_write_b128 v9, v[136:139]
    ds_read_b64_tr_b16 v[136:137], v10
    ds_read_b64_tr_b16 v[138:139], v10 offset:128
    s_setprio 3
L_notr:
    s_mul_i32 s24, s4, 92160
    s_add_u32 s24, s24, 9175040
    s_add_u32 s18, s16, s24
    s_addc_u32 s19, s17, 0
    s_lshl_b32 m0, s6, 10
    v_mov_b32 v4, 159744
    s_mov_b32 s40, 524288
    s_branch L_pp0_c
L_pp0:
    s_sleep 20
L_pp0_c:
    ds_read2st64_b32 v[12:13], v4 offset0:0 offset1:1
    ds_read2st64_b32 v[14:15], v4 offset0:2 offset1:3
    s_waitcnt lgkmcnt(0)
    v_min3_u32 v12, v12, v13, v14
    v_min_u32 v12, v12, v15
    s_nop 0
    v_readfirstlane_b32 s24, v12
    s_cmp_ge_u32 s24, 77824
    s_cbranch_scc1 L_pp0_ok
    s_sub_u32 s40, s40, 1
    s_cbranch_scc0 L_pp0
L_pp0_ok:
    global_load_lds_dwordx4 v7, s[18:19] sc1
    s_add_u32 m0, m0, 4096
    s_add_u32 s18, s18, 4096
    s_addc_u32 s19, s19, 0
    global_load_lds_dwordx4 v7, s[18:19] sc1
    s_add_u32 m0, m0, 4096
    s_add_u32 s18, s18, 4096
    s_addc_u32 s19, s19, 0
    global_load_lds_dwordx4 v7, s[18:19] sc1
    s_add_u32 m0, m0, 4096
    s_add_u32 s18, s18, 4096
    s_addc_u32 s19, s19, 0
    global_load_lds_dwordx4 v7, s[18:19] sc1
    s_add_u32 m0, m0, 4096
    s_add_u32 s18, s18, 4096
    s_addc_u32 s19, s19, 0
    global_load_lds_dwordx4 v7, s[18:19] sc1
    s_add_u32 m0, m0, 4096
    s_add_u32 s18, s18, 4096
    s_addc_u32 s19, s19, 0
    global_load_lds_dwordx4 v7, s[18:19] sc1
    s_add_u32 m0, m0, 4096
    s_add_u32 s18, s18, 4096
    s_addc_u32 s19, s19, 0
    global_load_lds_dwordx4 v7, s[18:19] sc1
    s_add_u32 m0, m0, 4096
    s_add_u32 s18, s18, 4096
    s_addc_u32 s19, s19, 0
    global_load_lds_dwordx4 v7, s[18:19] sc1
    s_add_u32 m0, m0, 4096
    s_add_u32 s18, s18, 4096
    s_addc_u32 s19, s19, 0
    global_load_lds_dwordx4 v7, s[18:19] sc1
    s_add_u32 m0, m0, 4096
    s_add_u32 s18, s18, 4096
    s_addc_u32 s19, s19, 0
    global_load_lds_dwordx4 v7, s[18:19] sc1
    s_add_u32 m0, m0, 4096
    s_add_u32 s18, s18, 4096
    s_addc_u32 s19, s19, 0
    global_load_lds_dwordx4 v7, s[18:19] sc1
    s_add_u32 m0, m0, 4096
    s_add_u32 s18, s18, 4096
    s_addc_u32 s19, s19, 0
    global_load_lds_dwordx4 v7, s[18:19] sc1
    s_add_u32 m0, m0, 4096
    s_add_u32 s18, s18, 4096
    s_addc_u32 s19, s19, 0
    global_load_lds_dwordx4 v7, s[18:19] sc1
    s_add_u32 m0, m0, 4096
    s_add_u32 s18, s18, 4096
    s_addc_u32 s19, s19, 0
    global_load_lds_dwordx4 v7, s[18:19] sc1
    s_add_u32 m0, m0, 4096
    s_add_u32 s18, s18, 4096
    s_addc_u32 s19, s19, 0
    global_load_lds_dwordx4 v7, s[18:19] sc1
    s_add_u32 m0, m0, 4096
    s_add_u32 s18, s18, 4096
    s_addc_u32 s19, s19, 0
    global_load_lds_dwordx4 v7, s[18:19] sc1
    s_add_u32 m0, m0, 4096
    s_add_u32 s18, s18, 4096
    s_addc_u32 s19, s19, 0
    global_load_lds_dwordx4 v7, s[18:19] sc1
    s_add_u32 m0, m0, 4096
    s_add_u32 s18, s18, 4096
    s_addc_u32 s19, s19, 0
    global_load_lds_dwordx4 v7, s[18:19] sc1
    s_add_u32 m0, m0, 4096
    s_add_u32 s18, s18, 4096
    s_addc_u32 s19, s19, 0
    global_load_lds_dwordx4 v7, s[18:19] sc1
    s_add_u32 m0, m0, 4096
    s_add_u32 s18, s18, 4096
    s_addc_u32 s19, s19, 0
    global_load_lds_dwordx4 v7, s[18:19] sc1
    s_add_u32 m0, m0, 4096
    s_add_u32 s18, s18, 4096
    s_addc_u32 s19, s19, 0
    global_load_lds_dwordx4 v7, s[18:19] sc1
    s_add_u32 m0, m0, 4096
    s_add_u32 s18, s18, 4096
    s_addc_u32 s19, s19, 0
    global_load_lds_dwordx4 v7, s[18:19] sc1
    s_add_u32 m0, m0, 4096
    s_add_u32 s18, s18, 4096
    s_addc_u32 s19, s19, 0
    global_load_lds_dwordx4 v7, s[18:19] sc1
    s_add_u32 m0, m0, 4096
    s_add_u32 s18, s18, 4096
    s_addc_u32 s19, s19, 0
    v_add_u32 v9, 92160, v7
    v_add_u32 v10, 157696, v7
    v_subrev_u32 v11, 1024, v7
    s_cmp_eq_u32 s6, 0
    s_cselect_b64 vcc, -1, 0
    v_cndmask_b32 v10, v11, v10, vcc
    s_waitcnt vmcnt(0) lgkmcnt(0)
    s_barrier
    v_mov_b32 v12, 158736
    v_mov_b32 v13, 0
    ds_write2_b32 v12, v13, v13 offset0:0 offset1:1
    ds_write2_b32 v12, v13, v13 offset0:2 offset1:3
    s_barrier
    ds_write_b128 v9, v[140:143] offset:0
    ds_write_b128 v9, v[144:147] offset:4096
    ds_write_b128 v9, v[148:151] offset:8192
    ds_write_b128 v9, v[152:155] offset:12288
    ds_write_b128 v9, v[156:159] offset:16384
    ds_write_b128 v9, v[160:163] offset:20480
    ds_write_b128 v9, v[164:167] offset:24576
    ds_write_b128 v9, v[168:171] offset:28672
    ds_write_b128 v9, v[172:175] offset:32768
    ds_write_b128 v9, v[176:179] offset:36864
    ds_write_b128 v9, v[180:183] offset:40960
    ds_write_b128 v9, v[184:187] offset:45056
    ds_write_b128 v9, v[188:191] offset:49152
    ds_write_b128 v9, v[192:195] offset:53248
    ds_write_b128 v9, v[196:199] offset:57344
    ds_write_b128 v9, v[200:203] offset:61440
    ds_write_b128 v10, v[204:207]
    ds_write_b128 v7, v[208:211] offset:3072
    ds_write_b128 v7, v[212:215] offset:7168
    ds_write_b128 v7, v[216:219] offset:11264
    ds_write_b128 v7, v[220:223] offset:15360
    ds_write_b128 v7, v[224:227] offset:19456
    s_cmp_ge_u32 s6, 2
    s_cbranch_scc1 L_nolast
    ds_write_b128 v7, v[228:231] offset:23552
L_nolast:
    s_waitcnt lgkmcnt(0)
    s_barrier
    s_mov_b32 s44, 0
    s_mov_b32 s47, 160776
    s_mov_b32 s51, 0
    s_cmp_ge_u32 s52, 18
    s_cbranch_scc1 L_nfc
    v_lshlrev_b32 v180, 4, v2
    v_cmp_eq_u32 vcc, 0, v2
    v_add_u32 v181, 368, v180
    v_add_u32 v182, 496, v180
    v_mov_b32 v8, 256
    v_cndmask_b32 v181, v181, v8, vcc
    v_mov_b32 v8, 432
    v_cndmask_b32 v182, v182, v8, vcc
    v_lshrrev_b32 v8, 1, v2
    v_lshlrev_b32 v8, 6, v8
    v_lshl_add_u32 v183, v2, 3, v8
    v_add_u32 v183, 560, v183
    s_lshl_b32 s24, s6, 8
    s_add_u32 s24, s24, 162816
    v_add_u32 v184, s24, v180
    s_lshl2_add_u32 s24, s6, 158736
    v_mov_b32 v185, s24
    v_lshlrev_b32 v186, 2, v1
    v_add_u32 v186, 162816, v186
    v_lshlrev_b32 v187, 2, v2
    v_add_u32 v187, 158736, v187
    v_mov_b32 v191, 255
    v_add_u32 v188, 161792, v180
    v_lshlrev_b32 v8, 6, v3
    v_sub_u32 v188, v188, v8
    v_and_b32 v189, 31, v1
    v_lshlrev_b32 v189, 1, v189
    v_add_u32 v189, 161792, v189
    s_mul_i32 s24, s6, 92160
    s_lshl_b32 s25, s39, 7
    s_add_u32 s24, s24, s25
    s_add_u32 s24, s24, 3162112
    v_lshrrev_b32 v190, 1, v3
    v_mul_u32_u24 v190, 18304, v190
    v_add3_u32 v190, v190, v8, v180
    v_add_u32 v190, s24, v190
L_nfc:
    s_cmp_eq_u32 s36, 29
    s_cbranch_scc1 L_key
L_keyb:
    v_add_u32 v8, 4096, v7
    v_add_u32 v9, 12288, v7
    s_cmp_eq_u32 s6, 3
    s_cselect_b32 s41, 0, 4096
    v_add_u32 v10, s41, v9
    v_add_u32 v12, 58368, v7
    v_add_u32 v14, 58368, v10
    v_add_u32 v13, 116736, v7
    v_add_u32 v15, 116736, v10
    s_and_b32 s34, s3, 7
    s_lshr_b32 s24, s2, 3
    s_mul_i32 s25, s24, 37
    s_lshr_b32 s25, s25, 8
    s_mul_i32 s25, s25, 7
    s_sub_u32 s38, s24, s25
    s_mul_i32 s24, s34, 19456
    s_add_u32 s24, s24, 3551232
    s_add_u32 s28, s16, s24
    s_addc_u32 s29, s17, 0
    v_and_b32 v21, 31, v1
    v_lshlrev_b32 v21, 7, v21
    v_add_u32 v21, 3543040, v21
    s_mov_b32 s40, 30007
    s_waitcnt lgkmcnt(0)
    s_barrier
    s_cmp_lg_u32 s6, 0
    s_cbranch_scc1 L_kv1_p0
    global_load_dword v252, v21, s[16:17] sc1
L_kv1_p0:
L_kv1_p:
    s_and_b32 s24, s40, 7
    s_cselect_b32 s24, 155648, 0
    s_add_u32 s18, s28, s24
    s_addc_u32 s19, s29, 0
    global_load_dwordx4 v[192:195], v8, s[18:19] offset:-4096 sc1
    global_load_dwordx4 v[196:199], v8, s[18:19] offset:0 sc1
    global_load_dwordx4 v[200:203], v9, s[18:19] offset:-4096 sc1
    global_load_dwordx4 v[204:207], v9, s[18:19] offset:0 sc1
    global_load_dwordx4 v[208:211], v10, s[18:19] offset:0 sc1
    s_waitcnt vmcnt(0)
L_kv1_p1:
    v_max3_u32 v5, v192, v193, v194
    v_max3_u32 v5, v195, v196, v5
    v_max3_u32 v5, v197, v198, v5
    v_max3_u32 v5, v199, v200, v5
    v_max3_u32 v5, v201, v202, v5
    v_max3_u32 v5, v203, v204, v5
    v_max3_u32 v5, v205, v206, v5
    v_max3_u32 v5, v207, v208, v5
    v_max3_u32 v5, v209, v210, v5
    v_max_u32 v5, v211, v5
    v_cmp_eq_u32 vcc, -1, v5
    s_cmp_eq_u64 vcc, 0
    s_cbranch_scc1 L_kv1_p_ok
    s_sub_u32 s40, s40, 1
    s_cbranch_scc0 L_kv1_p
L_kv1_p_ok:
    ds_write_b128 v7, v[192:195] offset:0
    ds_write_b128 v7, v[196:199] offset:4096
    ds_write_b128 v7, v[200:203] offset:8192
    ds_write_b128 v7, v[204:207] offset:12288
    ds_write_b128 v10, v[208:211]
    s_mov_b32 s42, 1
L_kv1_f1:
    s_add_u32 s24, s38, s42
    s_sub_u32 s25, s24, 7
    s_cmp_gt_u32 s24, 7
    s_cselect_b32 s24, s25, s24
    s_add_u32 s24, s24, s34
    s_and_b32 s24, s24, 7
    s_mul_i32 s24, s24, 19456
    s_add_u32 s24, s24, 3551232
    s_add_u32 s18, s16, s24
    s_addc_u32 s19, s17, 0
    s_mul_i32 s24, s42, 19456
    s_lshl_b32 s25, s6, 10
    s_add_u32 m0, s24, s25
    s_add_u32 s42, s42, 1
    global_load_lds_dwordx4 v7, s[18:19] sc1
    s_add_u32 m0, m0, 4096
    s_add_u32 s18, s18, 4096
    s_addc_u32 s19, s19, 0
    global_load_lds_dwordx4 v7, s[18:19] sc1
    s_add_u32 m0, m0, 4096
    s_add_u32 s18, s18, 4096
    s_addc_u32 s19, s19, 0
    global_load_lds_dwordx4 v7, s[18:19] sc1
    s_add_u32 m0, m0, 4096
    s_add_u32 s18, s18, 4096
    s_addc_u32 s19, s19, 0
    global_load_lds_dwordx4 v7, s[18:19] sc1
    s_add_u32 m0, m0, s41
    s_add_u32 s18, s18, s41
    s_addc_u32 s19, s19, 0
    global_load_lds_dwordx4 v7, s[18:19] sc1
    v_mov_b32 v5, 160800
    v_mov_b32 v11, -1
    s_mov_b64 exec, 1
    ds_inc_u32 v5, v11
    s_mov_b64 exec, -1
    s_cmp_lg_u32 s6, 0
    s_cbranch_scc1 L_kv1_n0
    s_mov_b32 s40, 30000
    s_branch L_kv1_k1
L_kv1_k:
    s_sleep 2
    global_load_dword v252, v21, s[16:17] sc1
    s_waitcnt vmcnt(0)
L_kv1_k1:
    v_cmp_eq_u32 vcc, -1, v252
    s_cmp_eq_u64 vcc, 0
    s_cbranch_scc1 L_kv1_k_ok
    s_sub_u32 s40, s40, 1
    s_cbranch_scc0 L_kv1_k
L_kv1_k_ok:
    v_max_u32_dpp v252, v252, v252 row_ror:8 row_mask:0xf bank_mask:0xf
    s_nop 1
    v_max_u32_dpp v252, v252, v252 row_ror:4 row_mask:0xf bank_mask:0xf
    s_nop 1
    v_max_u32_dpp v252, v252, v252 row_ror:2 row_mask:0xf bank_mask:0xf
    s_nop 1
    v_max_u32_dpp v252, v252, v252 row_ror:1 row_mask:0xf bank_mask:0xf
    v_mov_b32 v5, v252
    s_nop 1
    v_permlane16_swap_b32 v252, v5
    v_max_u32 v252, v252, v5
    v_or_b32 v252, 0xf800, v252
    s_nop 0
    v_readfirstlane_b32 s30, v252
    s_not_b32 s31, s30
    s_and_b32 s31, s31, 0x7ff
    v_mov_b32 v4, 160776
    ds_write_b32 v4, v252
    s_bfe_u32 s24, s31, 0x30006
    s_cmp_eq_u32 s24, s34
    s_cbranch_scc1 L_kv1_own
L_kv1_n0:
    s_waitcnt lgkmcnt(0)
    s_barrier
    s_mov_b32 s40, 30000
    v_mov_b32 v4, 160776
    ds_read_b32 v5, v4
    s_mov_b32 s42, 2
L_kv1_f2:
    s_add_u32 s24, s38, s42
    s_sub_u32 s25, s24, 7
    s_cmp_gt_u32 s24, 7
    s_cselect_b32 s24, s25, s24
    s_add_u32 s24, s24, s34
    s_and_b32 s24, s24, 7
    s_mul_i32 s24, s24, 19456
    s_add_u32 s24, s24, 3551232
    s_add_u32 s18, s16, s24
    s_addc_u32 s19, s17, 0
    s_mul_i32 s24, s42, 19456
    s_lshl_b32 s25, s6, 10
    s_add_u32 m0, s24, s25
    s_add_u32 s42, s42, 1
    global_load_lds_dwordx4 v7, s[18:19] sc1
    s_add_u32 m0, m0, 4096
    s_add_u32 s18, s18, 4096
    s_addc_u32 s19, s19, 0
    global_load_lds_dwordx4 v7, s[18:19] sc1
    s_add_u32 m0, m0, 4096
    s_add_u32 s18, s18, 4096
    s_addc_u32 s19, s19, 0
    global_load_lds_dwordx4 v7, s[18:19] sc1
    s_add_u32 m0, m0, 4096
    s_add_u32 s18, s18, 4096
    s_addc_u32 s19, s19, 0
    global_load_lds_dwordx4 v7, s[18:19] sc1
    s_add_u32 m0, m0, s41
    s_add_u32 s18, s18, s41
    s_addc_u32 s19, s19, 0
    global_load_lds_dwordx4 v7, s[18:19] sc1
    s_cmp_lt_u32 s42, 8
    s_cbranch_scc1 L_kv1_f2
    global_load_dword v232, v8, s[28:29] offset:-4096 sc1
    global_load_dword v233, v8, s[28:29] offset:0 sc1
    global_load_dword v234, v9, s[28:29] offset:-4096 sc1
    global_load_dword v235, v9, s[28:29] offset:0 sc1
    global_load_dword v236, v10, s[28:29] offset:0 sc1
    s_waitcnt lgkmcnt(0)
    v_readfirstlane_b32 s30, v5
    s_not_b32 s31, s30
    s_and_b32 s31, s31, 0x7ff
    s_bfe_u32 s24, s31, 0x30006
    s_mul_i32 s53, s24, 19456
    s_lshr_b32 s24, s31, 9
    s_lshl_b32 s24, s24, 6
    s_and_b32 s25, s31, 63
    s_add_u32 s56, s24, s25
    s_lshr_b32 s24, s56, 4
    s_mul_i32 s24, s24, 640
    s_and_b32 s25, s31, 3
    s_lshl_b32 s25, s25, 1
    s_add_u32 s24, s24, s25
    s_and_b32 s25, s31, 8
    s_add_u32 s24, s24, s25
    s_add_u32 s54, s24, 9216
    s_bfe_u32 s25, s31, 0x10002
    v_min_u32 v23, 19, v1
    v_mov_b32 v22, s25
    v_lshrrev_b32 v4, 3, v23
    v_cmp_gt_u32 vcc, 16, v23
    v_and_b32 v23, 7, v23
    v_lshlrev_b32 v23, 4, v23
    v_lshl_add_u32 v23, v4, 8, v23
    v_xor_b32 v4, v4, v22
    v_lshlrev_b32 v4, 7, v4
    v_lshlrev_b32 v5, 6, v22
    v_cndmask_b32 v4, v5, v4, vcc
    v_add_u32 v23, v23, v4
    v_add_u32 v23, s54, v23
    v_mov_b32 v22, 0
    s_bfe_u32 s24, s31, 0x30006
    s_sub_u32 s24, s24, s34
    s_and_b32 s24, s24, 7
    s_sub_u32 s25, s24, s38
    s_sub_u32 s25, s25, 1
    s_add_u32 s26, s25, 7
    s_min_u32 s25, s25, s26
    s_add_u32 s25, s25, 1
    s_cmp_eq_u32 s24, 0
    s_cselect_b32 s24, 0, s25
    s_mul_i32 s26, s24, 19456
    v_bfe_u32 v4, v23, 10, 2
    v_cmp_eq_u32 vcc, s6, v4
    v_add_u32 v23, s26, v23
    v_mov_b32 v4, 162786
    v_cndmask_b32 v23, v4, v23, vcc
    s_waitcnt vmcnt(35)
L_kv1_v1:
    ds_read2st64_b32 v[192:193], v7 offset0:76 offset1:92
    ds_read2st64_b32 v[194:195], v7 offset0:108 offset1:124
    ds_read_b32 v225, v10 offset:19456
    s_cmp_lg_u32 s26, 19456
    s_cbranch_scc1 L_kv1_n1
    ds_write_b16 v23, v22
L_kv1_n1:
    s_waitcnt lgkmcnt(0)
    v_max3_u32 v5, v192, v193, v194
    v_max3_u32 v5, v195, v225, v5
    v_cmp_eq_u32 vcc, -1, v5
    s_cbranch_vccnz L_kv1_r1
L_kv1_b1:
    v_mov_b32 v5, 160832
    v_mov_b32 v11, -1
    s_mov_b64 exec, 1
    ds_inc_u32 v5, v11
    s_mov_b64 exec, -1
    s_waitcnt vmcnt(0)
L_kv1_v2:
    ds_read2st64_b32 v[192:193], v7 offset0:152 offset1:168
    ds_read2st64_b32 v[194:195], v7 offset0:184 offset1:200
    ds_read_b32 v226, v10 offset:38912
    ds_read2st64_b32 v[196:197], v12 offset0:0 offset1:16
    ds_read2st64_b32 v[198:199], v12 offset0:32 offset1:48
    ds_read_b32 v227, v14 offset:0
    ds_read2st64_b32 v[200:201], v12 offset0:76 offset1:92
    ds_read2st64_b32 v[202:203], v12 offset0:108 offset1:124
    ds_read_b32 v228, v14 offset:19456
    ds_read2st64_b32 v[204:205], v12 offset0:152 offset1:168
    ds_read2st64_b32 v[206:207], v12 offset0:184 offset1:200
    ds_read_b32 v229, v14 offset:38912
    ds_read2st64_b32 v[208:209], v13 offset0:0 offset1:16
    ds_read2st64_b32 v[210:211], v13 offset0:32 offset1:48
    ds_read_b32 v230, v15 offset:0
    ds_read2st64_b32 v[212:213], v13 offset0:76 offset1:92
    ds_read2st64_b32 v[214:215], v13 offset0:108 offset1:124
    ds_read_b32 v231, v15 offset:19456
    ds_write_b16 v23, v22
L_kv1_n2:
    s_waitcnt lgkmcnt(0)
    v_max3_u32 v5, v192, v193, v194
    v_max3_u32 v5, v195, v196, v5
    v_max3_u32 v5, v197, v198, v5
    v_max3_u32 v5, v199, v200, v5
    v_max3_u32 v5, v201, v202, v5
    v_max3_u32 v5, v203, v204, v5
    v_max3_u32 v5, v205, v206, v5
    v_max3_u32 v5, v207, v208, v5
    v_max3_u32 v5, v209, v210, v5
    v_max3_u32 v5, v211, v212, v5
    v_max3_u32 v5, v213, v214, v5
    v_max3_u32 v5, v215, v226, v5
    v_max3_u32 v5, v227, v228, v5
    v_max3_u32 v5, v229, v230, v5
    v_max3_u32 v5, v231, v232, v5
    v_max3_u32 v5, v233, v234, v5
    v_max3_u32 v5, v235, v236, v5
    v_cmp_eq_u32 vcc, -1, v5
    s_cbranch_vccnz L_kv1_r2
L_kv1_b2:
    v_lshlrev_b32 v5, 2, v1
    v_add_u32 v5, 160836, v5
    v_mov_b32 v11, -1
    s_mov_b64 exec, 127
    ds_inc_u32 v5, v11
    s_mov_b64 exec, -1
    s_cmp_lt_u32 s52, 18
    s_cbranch_scc1 L_ffn
    s_lshl_b32 s24, s6, 8
    s_add_u32 s24, s24, s39
    s_cmp_lt_u32 s24, 36
    s_cbranch_scc1 L_red
    s_cmp_eq_u32 s3, 31
    s_cbranch_scc1 L_r3
    s_cmp_lg_u32 s6, 1
    s_cbranch_scc1 L_back
    s_cmp_eq_u32 s3, 30
    s_cbranch_scc1 L_r3
    s_lshr_b32 s24, s3, 2
    s_cmp_eq_u32 s24, 6
    s_cbranch_scc1 L_r4
L_back:
    s_mov_b64 exec, -1
    s_cmp_eq_u32 s6, 3
    s_cbranch_scc1 L_kvx
L_back2:
    s_mov_b64 exec, -1
    s_lshl_b32 s24, s6, 8
    s_add_u32 s24, s24, s2
    s_cmp_ge_u32 s24, 8
    s_cbranch_scc1 L_nwb
    buffer_wbl2 sc1
L_nwb:
    s_mul_i32 s24, s4, 92160
    s_add_u32 s24, s24, 9175040
    s_add_u32 s18, s16, s24
    s_addc_u32 s19, s17, 0
    s_lshl_b32 m0, s6, 10
    v_mov_b32 v4, 159744
    s_mov_b32 s40, 524288
    s_branch L_pp1_c
L_pp1:
    s_sleep 20
L_pp1_c:
    ds_read2st64_b32 v[12:13], v4 offset0:0 offset1:1
    ds_read2st64_b32 v[14:15], v4 offset0:2 offset1:3
    s_waitcnt lgkmcnt(0)
    v_min3_u32 v12, v12, v13, v14
    v_min_u32 v12, v12, v15
    s_nop 0
    v_readfirstlane_b32 s24, v12
    s_cmp_ge_u32 s24, 77824
    s_cbranch_scc1 L_pp1_ok
    s_sub_u32 s40, s40, 1
    s_cbranch_scc0 L_pp1
L_pp1_ok:
    global_load_lds_dwordx4 v7, s[18:19] sc1
    s_add_u32 m0, m0, 4096
    s_add_u32 s18, s18, 4096
    s_addc_u32 s19, s19, 0
    global_load_lds_dwordx4 v7, s[18:19] sc1
    s_add_u32 m0, m0, 4096
    s_add_u32 s18, s18, 4096
    s_addc_u32 s19, s19, 0
    global_load_lds_dwordx4 v7, s[18:19] sc1
    s_add_u32 m0, m0, 4096
    s_add_u32 s18, s18, 4096
    s_addc_u32 s19, s19, 0
    global_load_lds_dwordx4 v7, s[18:19] sc1
    s_add_u32 m0, m0, 4096
    s_add_u32 s18, s18, 4096
    s_addc_u32 s19, s19, 0
    global_load_lds_dwordx4 v7, s[18:19] sc1
    s_add_u32 m0, m0, 4096
    s_add_u32 s18, s18, 4096
    s_addc_u32 s19, s19, 0
    global_load_lds_dwordx4 v7, s[18:19] sc1
    s_add_u32 m0, m0, 4096
    s_add_u32 s18, s18, 4096
    s_addc_u32 s19, s19, 0
    global_load_lds_dwordx4 v7, s[18:19] sc1
    s_add_u32 m0, m0, 4096
    s_add_u32 s18, s18, 4096
    s_addc_u32 s19, s19, 0
    global_load_lds_dwordx4 v7, s[18:19] sc1
    s_add_u32 m0, m0, 4096
    s_add_u32 s18, s18, 4096
    s_addc_u32 s19, s19, 0
    global_load_lds_dwordx4 v7, s[18:19] sc1
    s_add_u32 m0, m0, 4096
    s_add_u32 s18, s18, 4096
    s_addc_u32 s19, s19, 0
    global_load_lds_dwordx4 v7, s[18:19] sc1
    s_add_u32 m0, m0, 4096
    s_add_u32 s18, s18, 4096
    s_addc_u32 s19, s19, 0
    global_load_lds_dwordx4 v7, s[18:19] sc1
    s_add_u32 m0, m0, 4096
    s_add_u32 s18, s18, 4096
    s_addc_u32 s19, s19, 0
    global_load_lds_dwordx4 v7, s[18:19] sc1
    s_add_u32 m0, m0, 4096
    s_add_u32 s18, s18, 4096
    s_addc_u32 s19, s19, 0
    global_load_lds_dwordx4 v7, s[18:19] sc1
    s_add_u32 m0, m0, 4096
    s_add_u32 s18, s18, 4096
    s_addc_u32 s19, s19, 0
    global_load_lds_dwordx4 v7, s[18:19] sc1
    s_add_u32 m0, m0, 4096
    s_add_u32 s18, s18, 4096
    s_addc_u32 s19, s19, 0
    global_load_lds_dwordx4 v7, s[18:19] sc1
    s_add_u32 m0, m0, 4096
    s_add_u32 s18, s18, 4096
    s_addc_u32 s19, s19, 0
    global_load_lds_dwordx4 v7, s[18:19] sc1
    s_add_u32 m0, m0, 4096
    s_add_u32 s18, s18, 4096
    s_addc_u32 s19, s19, 0
    global_load_lds_dwordx4 v7, s[18:19] sc1
    s_add_u32 m0, m0, 4096
    s_add_u32 s18, s18, 4096
    s_addc_u32 s19, s19, 0
    global_load_lds_dwordx4 v7, s[18:19] sc1
    s_add_u32 m0, m0, 4096
    s_add_u32 s18, s18, 4096
    s_addc_u32 s19, s19, 0
    global_load_lds_dwordx4 v7, s[18:19] sc1
    s_add_u32 m0, m0, 4096
    s_add_u32 s18, s18, 4096
    s_addc_u32 s19, s19, 0
    global_load_lds_dwordx4 v7, s[18:19] sc1
    s_add_u32 m0, m0, 4096
    s_add_u32 s18, s18, 4096
    s_addc_u32 s19, s19, 0
    global_load_lds_dwordx4 v7, s[18:19] sc1
    s_add_u32 m0, m0, 4096
    s_add_u32 s18, s18, 4096
    s_addc_u32 s19, s19, 0
    global_load_lds_dwordx4 v7, s[18:19] sc1
    s_add_u32 m0, m0, 4096
    s_add_u32 s18, s18, 4096
    s_addc_u32 s19, s19, 0
    global_load_lds_dwordx4 v7, s[18:19] sc1
    s_add_u32 m0, m0, 4096
    s_add_u32 s18, s18, 4096
    s_addc_u32 s19, s19, 0
    s_cmp_lg_u32 s6, 2
    s_cbranch_scc1 L_back5
    s_lshr_b32 s24, s31, 6
    s_cmp_eq_u32 s24, s3
    s_cbranch_scc1 L_r5
L_back5:
    s_mov_b64 exec, -1
    s_waitcnt vmcnt(0) lgkmcnt(0)
    s_barrier
    v_lshlrev_b32 v8, 2, v3
    v_add_u32 v8, 158720, v8
    v_mov_b32 v10, 0
    ds_write_b32 v8, v10
    s_mov_b32 s44, 4194304
    v_add_u32 v190, 4194304, v190
    s_mov_b32 s46, 0
    s_mov_b32 s43, 0
    s_mov_b32 s47, 158728
    s_cmp_eq_u32 s6, 0
    s_cselect_b32 s51, 1, 0
    s_mov_b32 s48, 524288
    s_cmov_b32 s48, 30000
    v_cmp_gt_u32 vcc, 32, v1
    s_nop 1
    v_cndmask_b32 v200, 48, v1, vcc
    s_add_u32 s24, s44, 3543040
    v_lshl_add_u32 v200, v200, 7, s24
    v_mov_b32 v201, 158720
    s_mov_b32 s42, 0
    s_mov_b32 s35, 1
    s_waitcnt lgkmcnt(0)
    s_barrier
    s_barrier
    s_cmp_lt_u32 s52, 18
    s_cbranch_scc1 L_fw0
    s_lshl_b32 s24, s6, 8
    s_add_u32 s24, s24, s2
    s_cmp_eq_u32 s24, 284
    s_cbranch_scc1 L_agg
    s_cmp_lg_u32 s6, 0
    s_cbranch_scc1 L_end
L_pollk:
    s_sub_u32 s48, s48, 1
    s_cbranch_scc1 L_end
    s_max_u32 s24, s35, 1
    s_cmp_eq_u32 s42, s24
    s_cbranch_scc1 L_pollk2
    s_cmp_eq_u32 s4, 7
    s_cbranch_scc1 L_pollk2
    s_sleep 24
L_pollk2:
    global_load_dword v202, v200, s[16:17] sc1
    s_waitcnt vmcnt(0)
    v_add_u32 v204, 1, v202
    ds_read_b32 v209, v201 offset:40
    v_readlane_b32 s42, v204, s3
    v_readlane_b32 s43, v204, 32
    v_max_u32_dpp v204, v204, v204 row_ror:8 row_mask:0xf bank_mask:0xf
    s_nop 1
    v_max_u32_dpp v204, v204, v204 row_ror:4 row_mask:0xf bank_mask:0xf
    s_nop 1
    v_max_u32_dpp v204, v204, v204 row_ror:2 row_mask:0xf bank_mask:0xf
    s_nop 1
    v_max_u32_dpp v204, v204, v204 row_ror:1 row_mask:0xf bank_mask:0xf
    s_nop 0
    v_readlane_b32 s35, v204, 0
    v_readlane_b32 s41, v204, 16
    s_mov_b64 exec, 1
    v_mov_b32 v205, s43
    s_max_u32 s35, s35, s43
    s_max_u32 s35, s35, s41
    v_mov_b32 v204, s35
    s_sub_u32 s30, s35, 1
    ds_write_b64 v201, v[204:205]
    s_not_b32 s31, s30
    s_and_b32 s31, s31, 0x7ff
    s_mov_b64 exec, -1
    s_cmp_lt_u32 s39, 36
    s_cbranch_scc1 L_kred
    s_cmp_lg_u32 s43, 0
    s_cbranch_scc1 L_kend
    s_waitcnt lgkmcnt(0)
    v_readfirstlane_b32 s24, v209
    s_cmp_eq_u32 s24, 4
    s_cbranch_scc0 L_pollk
L_kend:
    s_waitcnt lgkmcnt(0)
    s_branch L_end
L_kred:
    s_cmp_lg_u32 s35, 0
    s_cbranch_scc1 L_red
    s_branch L_pollk
L_fw0:
L_fw:
    s_add_u32 s24, s46, 1
    s_cmp_eq_u32 s24, s43
    s_cbranch_scc1 L_kend
    s_sub_u32 s48, s48, 1
    s_cbranch_scc1 L_end
    s_cmp_eq_u32 s51, 0
    s_cbranch_scc1 L_fw1
    global_load_dword v202, v200, s[16:17] sc1
    s_waitcnt vmcnt(0)
L_fwa:
    s_waitcnt vmcnt(1)
L_fwb:
    v_add_u32 v204, 1, v202
    s_nop 0
    v_readlane_b32 s43, v204, 32
    v_max_u32_dpp v204, v204, v204 row_ror:8 row_mask:0xf bank_mask:0xf
    s_nop 1
    v_max_u32_dpp v204, v204, v204 row_ror:4 row_mask:0xf bank_mask:0xf
    s_nop 1
    v_max_u32_dpp v204, v204, v204 row_ror:2 row_mask:0xf bank_mask:0xf
    s_nop 1
    v_max_u32_dpp v204, v204, v204 row_ror:1 row_mask:0xf bank_mask:0xf
    s_nop 0
    v_readlane_b32 s35, v204, 0
    v_readlane_b32 s41, v204, 16
    s_mov_b64 exec, 1
    v_mov_b32 v205, s43
    s_max_u32 s35, s35, s43
    s_max_u32 s35, s35, s41
    v_mov_b32 v204, s35
    s_sub_u32 s30, s35, 1
    s_cselect_b32 s30, 0, s30
    s_max_u32 s30, s30, s46
    v_mov_b32 v206, s30
    ds_write_b96 v201, v[204:206]
    s_mov_b64 exec, -1
    s_branch L_fw2
L_fw1:
    ds_read2_b32 v[8:9], v201 offset0:1 offset1:2
    s_waitcnt lgkmcnt(0)
    v_readfirstlane_b32 s43, v8
    v_readfirstlane_b32 s30, v9
L_fw2:
    s_cmp_le_u32 s30, s46
    s_cbranch_scc1 L_fw
L_ffn:
    s_mov_b32 s46, s30
    s_not_b32 s31, s30
    s_and_b32 s31, s31, 0x7ff
    s_add_u32 s45, s46, 1
    s_cmp_eq_u32 s45, s43
    s_cmov_b32 s51, 0
    s_lshr_b32 s26, s31, 4
    s_mul_i32 s24, s26, 4224
    s_add_u32 s24, s24, s44
    s_add_u32 s24, s24, 2621440
    s_mul_i32 s25, s6, 768
    s_add_u32 s24, s24, s25
    s_add_u32 s18, s16, s24
    s_addc_u32 s19, s17, 0
    s_mov_b32 s40, 30000
    v_mov_b32 v10, s47
    v_mov_b32 v11, s46
L_pollc:
    s_cmp_eq_u32 s51, 0
    s_cbranch_scc1 L_pc1
    global_load_dword v202, v200, s[16:17] sc1
L_pc1:
    v_mov_b32 v140, -2
    global_load_dwordx4 v[140:143], v180, s[18:19] offset:0 sc1
    global_load_dwordx4 v[144:147], v180, s[18:19] offset:128 sc1
    global_load_dwordx4 v[148:151], v181, s[18:19] offset:0 sc1
    global_load_dwordx4 v[152:155], v182, s[18:19] offset:0 sc1
    global_load_dwordx2 v[156:157], v183, s[18:19] sc1
    s_cbranch_scc1 L_asp
    s_waitcnt vmcnt(5)
    v_add_u32 v204, 1, v202
    v_cmp_lt_u32 vcc, s45, v204
    s_cbranch_vccnz L_fwb
L_pc2:
    s_waitcnt vmcnt(4)
    ds_read_b32 v13, v10
    v_mfma_f32_16x16x32_bf16 v[160:163], v[24:27], v[140:143], 0
    v_max_u32 v12, v140, v141
    v_mfma_f32_16x16x32_bf16 v[164:167], v[28:31], v[140:143], 0
    v_max3_u32 v12, v142, v143, v12
    v_mfma_f32_16x16x32_bf16 v[168:171], v[32:35], v[140:143], 0
    v_mfma_f32_16x16x32_bf16 v[172:175], v[36:39], v[140:143], 0
    s_waitcnt vmcnt(3)
    v_mfma_f32_16x16x32_bf16 v[160:163], v[40:43], v[144:147], v[160:163]
    v_max3_u32 v12, v144, v145, v12
    v_mfma_f32_16x16x32_bf16 v[164:167], v[44:47], v[144:147], v[164:167]
    v_max3_u32 v12, v146, v147, v12
    v_mfma_f32_16x16x32_bf16 v[168:171], v[48:51], v[144:147], v[168:171]
    v_mfma_f32_16x16x32_bf16 v[172:175], v[52:55], v[144:147], v[172:175]
    s_waitcnt vmcnt(2)
    v_mfma_f32_16x16x32_bf16 v[160:163], v[56:59], v[148:151], v[160:163]
    v_max3_u32 v12, v148, v149, v12
    v_mfma_f32_16x16x32_bf16 v[164:167], v[60:63], v[148:151], v[164:167]
    v_max3_u32 v12, v150, v151, v12
    v_mfma_f32_16x16x32_bf16 v[168:171], v[64:67], v[148:151], v[168:171]
    v_mfma_f32_16x16x32_bf16 v[172:175], v[68:71], v[148:151], v[172:175]
    s_waitcnt vmcnt(1)
    v_mfma_f32_16x16x32_bf16 v[160:163], v[72:75], v[152:155], v[160:163]
    v_max3_u32 v12, v152, v153, v12
    v_mfma_f32_16x16x32_bf16 v[164:167], v[76:79], v[152:155], v[164:167]
    v_max3_u32 v12, v154, v155, v12
    v_mfma_f32_16x16x32_bf16 v[168:171], v[80:83], v[152:155], v[168:171]
    v_mfma_f32_16x16x32_bf16 v[172:175], v[84:87], v[152:155], v[172:175]
    s_waitcnt vmcnt(0)
    s_cbranch_scc1 L_pc3
    global_load_dword v202, v200, s[16:17] sc1
L_pc3:
    v_max3_u32 v12, v156, v157, v12
    v_cmp_ne_u32 vcc, -1, v12
    s_waitcnt lgkmcnt(0)
    v_readfirstlane_b32 s30, v13
    v_mfma_f32_16x16x16_bf16 v[160:163], v[96:97], v[156:157], v[160:163]
    v_mfma_f32_16x16x16_bf16 v[164:167], v[98:99], v[156:157], v[164:167]
    v_mfma_f32_16x16x16_bf16 v[168:171], v[100:101], v[156:157], v[168:171]
    v_mfma_f32_16x16x16_bf16 v[172:175], v[102:103], v[156:157], v[172:175]
    s_cmp_gt_u32 s30, s46
    s_cbranch_scc1 L_ffn
    s_cmp_eq_u64 vcc, -1
    s_cbranch_scc1 L_pollc_ok
    s_sub_u32 s40, s40, 1
    s_cbranch_scc0 L_pollc
L_pollc_ok:
    s_mov_b32 exec_lo, 0x00010001
    s_mov_b32 exec_hi, 0x00010001
    s_nop 3
    ds_write_b128 v184, v[160:163] offset:0
    ds_write_b128 v184, v[164:167] offset:64
    ds_write_b128 v184, v[168:171] offset:128
    ds_write_b128 v184, v[172:175] offset:192
    ds_write_b32 v185, v11
    s_mov_b64 exec, -1
    s_mov_b32 s40, 524288
    s_cmp_eq_u32 s51, 0
    s_cbranch_scc1 L_pollh1
    s_waitcnt vmcnt(0)
    v_add_u32 v204, 1, v202
    v_cmp_lt_u32 vcc, s45, v204
    s_cbranch_vccnz L_fwb
    global_load_dword v202, v200, s[16:17] sc1
    s_branch L_pollh1
L_pollh:
    s_sleep 1
L_pollh1:
    ds_read_b32 v16, v187
    ds_read2st64_b32 v[12:13], v186 offset0:0 offset1:1
    ds_read2st64_b32 v[14:15], v186 offset0:2 offset1:3
    ds_read_b32 v19, v10
    s_waitcnt lgkmcnt(0)
    v_readfirstlane_b32 s30, v19
    v_cmp_eq_u32 vcc, s46, v16
    s_cmp_gt_u32 s30, s46
    s_cbranch_scc1 L_ffn
    s_cmp_eq_u64 vcc, -1
    s_cbranch_scc1 L_pollh_ok
    s_sub_u32 s40, s40, 1
    s_cbranch_scc0 L_pollh
L_pollh_ok:
    v_add_f32 v12, v12, v13
    v_add_f32 v14, v14, v15
    v_add_f32 v12, v12, v14
    v_cvt_pk_bf16_f32 v12, v12, v12
    v_and_b32 v12, 0xffff0000, v12
    v_mov_b32 v13, v12
    s_nop 1
    v_permlane32_swap_b32 v12, v13
    v_mul_f32 v14, 0xbfb8aa3b, v12
    v_exp_f32 v14, v14
    s_nop 0
    v_add_f32 v14, 1.0, v14
    v_rcp_f32 v14, v14
    s_nop 0
    v_mul_f32 v12, v12, v14
    v_cvt_pk_bf16_f32 v12, v12, v12
    v_and_b32 v12, 0xffff0000, v12
    v_mul_f32 v12, v12, v13
    v_cvt_pk_bf16_f32 v12, v12, v12
    ds_write_b16 v189, v12
    ds_read_b128 v[140:143], v188 offset:0
    ds_read_b128 v[144:147], v188 offset:64
    ds_read_b128 v[148:151], v188 offset:128
    ds_read_b128 v[152:155], v188 offset:192
    ds_read_b128 v[156:159], v188 offset:256
    ds_read_b128 v[160:163], v188 offset:320
    ds_read_b128 v[164:167], v188 offset:384
    ds_read_b128 v[168:171], v188 offset:448
    ds_read_b128 v[172:175], v188 offset:512
    s_waitcnt lgkmcnt(8)
    v_mfma_f32_16x16x32_bf16 v[12:15], v[104:107], v[140:143], 0
    s_waitcnt lgkmcnt(7)
    v_mfma_f32_16x16x32_bf16 v[12:15], v[108:111], v[144:147], v[12:15]
    s_waitcnt lgkmcnt(6)
    v_mfma_f32_16x16x32_bf16 v[12:15], v[112:115], v[148:151], v[12:15]
    s_waitcnt lgkmcnt(5)
    v_mfma_f32_16x16x32_bf16 v[12:15], v[116:119], v[152:155], v[12:15]
    s_waitcnt lgkmcnt(4)
    v_mfma_f32_16x16x32_bf16 v[12:15], v[120:123], v[156:159], v[12:15]
    s_waitcnt lgkmcnt(3)
    v_mfma_f32_16x16x32_bf16 v[12:15], v[124:127], v[160:163], v[12:15]
    s_waitcnt lgkmcnt(2)
    v_mfma_f32_16x16x32_bf16 v[12:15], v[128:131], v[164:167], v[12:15]
    s_waitcnt lgkmcnt(1)
    v_mfma_f32_16x16x32_bf16 v[12:15], v[132:135], v[168:171], v[12:15]
    s_waitcnt lgkmcnt(0)
    v_mfma_f32_16x16x32_bf16 v[12:15], v[136:139], v[172:175], v[12:15]
    s_mov_b32 exec_lo, 0x01ff01ff
    s_mov_b32 exec_hi, 0x01ff01ff
    s_nop 5
    v_bfi_b32 v12, v191, s26, v12
    global_store_dwordx4 v190, v[12:15], s[16:17] sc1
    s_cmp_eq_u32 s44, 0
    s_cbranch_scc1 L_back
    s_mov_b64 exec, -1
    s_cmp_eq_u32 s51, 0
    s_cbranch_scc1 L_fw
    s_branch L_fwa
L_asp:
    s_cmp_eq_u32 s44, 0
    s_cbranch_scc1 L_pc2
    s_mov_b32 s24, 12
L_asp1:
    ds_read_b32 v13, v10
    s_waitcnt lgkmcnt(0)
    v_readfirstlane_b32 s30, v13
    v_readfirstlane_b32 s25, v140
    s_cmp_gt_u32 s30, s46
    s_cbranch_scc1 L_ffn
    s_cmp_lg_u32 s25, -2
    s_cbranch_scc1 L_pc2
    s_sub_u32 s24, s24, 1
    s_cbranch_scc0 L_asp1
    s_branch L_pc2
L_redo:
    v_add_u32 v204, 1, v202
    ds_read_b32 v209, v201 offset:40
    v_readlane_b32 s42, v204, s3
    v_readlane_b32 s43, v204, 32
    v_max_u32_dpp v204, v204, v204 row_ror:8 row_mask:0xf bank_mask:0xf
    s_nop 1
    v_max_u32_dpp v204, v204, v204 row_ror:4 row_mask:0xf bank_mask:0xf
    s_nop 1
    v_max_u32_dpp v204, v204, v204 row_ror:2 row_mask:0xf bank_mask:0xf
    s_nop 1
    v_max_u32_dpp v204, v204, v204 row_ror:1 row_mask:0xf bank_mask:0xf
    s_nop 0
    v_readlane_b32 s35, v204, 0
    v_readlane_b32 s41, v204, 16
    s_mov_b64 exec, 1
    v_mov_b32 v205, s43
    s_max_u32 s35, s35, s43
    s_max_u32 s35, s35, s41
    v_mov_b32 v204, s35
    s_sub_u32 s30, s35, 1
    ds_write_b64 v201, v[204:205]
    s_not_b32 s31, s30
    s_and_b32 s31, s31, 0x7ff
    s_mov_b64 exec, -1
    s_sub_u32 s48, s48, 1
    s_cbranch_scc1 L_end
L_red:
    s_add_u32 s45, s30, 1
    v_mov_b32 v201, 158720
    v_cmp_gt_u32 vcc, 32, v1
    s_nop 1
    v_cndmask_b32 v200, 48, v1, vcc
    s_add_u32 s24, s44, 3543040
    v_lshl_add_u32 v200, v200, 7, s24
    s_lshr_b32 s24, s31, 4
    s_mul_i32 s24, s24, 4224
    s_lshl_b32 s25, s39, 5
    s_add_u32 s24, s24, s44
    s_add_u32 s24, s24, 2621440
    v_and_b32 v9, 3, v1
    v_lshrrev_b32 v8, 1, v2
    v_lshl_add_u32 v9, v9, 1, v8
    v_lshl_add_u32 v8, v9, 2, s25
    v_lshrrev_b32 v12, 4, v8
    v_mul_u32_u24 v13, 57, v12
    v_lshrrev_b32 v13, 9, v13
    v_mul_u32_u24 v14, 9, v13
    v_sub_u32 v12, v12, v14
    v_lshrrev_b32 v12, 2, v12
    v_add_u32 v8, s24, v8
    v_mul_u32_u24 v13, 240, v13
    v_lshl_add_u32 v13, v12, 6, v13
    v_add_u32 v16, v13, v8
    s_and_b32 s26, s30, 0xffff0000
    s_ashr_i32 s27, s26, 31
    s_not_b32 s27, s27
    s_or_b32 s27, s27, 0x80000000
    s_xor_b32 s26, s26, s27
    s_and_b32 s26, s26, 0xffff0000
    v_mov_b32 v10, s26
    v_mul_f32 v10, 0xbfb8aa3b, v10
    v_exp_f32 v10, v10
    s_nop 0
    v_add_f32 v10, 1.0, v10
    v_rcp_f32 v10, v10
    s_nop 0
    v_cvt_pk_bf16_f32 v10, v10, v10
    v_and_b32 v10, 0xffff0000, v10
    s_mov_b32 s40, 30000
L_pollr:
    global_load_dword v12, v16, s[16:17] sc1
    global_load_dword v13, v8, s[16:17] offset:3072 sc1
    s_waitcnt vmcnt(0)
    v_max_u32 v11, v12, v13
    v_cmp_eq_u32 vcc, -1, v11
    s_cmp_eq_u64 vcc, 0
    s_cbranch_scc1 L_pollr_ok
    s_sub_u32 s40, s40, 1
    s_cbranch_scc0 L_pollr
L_pollr_ok:
    v_and_b32 v11, 1, v2
    v_lshlrev_b32 v11, 4, v11
    v_lshrrev_b32 v12, v11, v12
    v_lshlrev_b32 v16, 16, v12
    v_lshrrev_b32 v13, v11, v13
    v_lshlrev_b32 v17, 16, v13
    s_mul_i32 s24, s31, 1152
    s_add_u32 s24, s24, s25
    s_lshl_b32 s25, s25, 2
    s_add_u32 s25, s25, 3530752
    s_cmp_eq_u32 s44, 0
    s_cselect_b32 s24, s25, s24
    v_and_b32 v8, 3, v1
    v_lshlrev_b32 v8, 4, v8
    v_lshl_add_u32 v9, v9, 2, s24
    s_mul_i32 s24, s39, 57
    s_lshr_b32 s24, s24, 9
    s_add_u32 s24, s24, s39
    s_lshr_b32 s25, s24, 1
    s_mul_i32 s25, s25, 18432
    s_and_b32 s24, s24, 1
    s_lshl_b32 s24, s24, 6
    s_add_u32 s24, s24, s25
    s_add_u32 s24, s24, s44
    s_add_u32 s24, s24, 3166208
    v_lshrrev_b32 v12, 2, v1
    v_lshl_add_u32 v8, v12, 7, v8
    v_add_u32 v8, s24, v8
    v_add_u32 v12, 8192, v8
    v_add_u32 v14, 12288, v8
    s_mov_b32 s40, 30000
    s_lshr_b32 s26, s31, 4
    s_sleep 12
    s_cmp_eq_u32 s44, 0
    s_cbranch_scc1 L_polly
    global_load_dword v202, v200, s[16:17] sc1
    global_load_dwordx4 v[24:27], v8, s[16:17] offset:-4096 sc1
    global_load_dwordx4 v[28:31], v8, s[16:17] offset:-2048 sc1
    global_load_dwordx4 v[32:35], v8, s[16:17] offset:0 sc1
    global_load_dwordx4 v[36:39], v8, s[16:17] offset:2048 sc1
    global_load_dwordx4 v[40:43], v12, s[16:17] offset:-4096 sc1
    global_load_dwordx4 v[44:47], v12, s[16:17] offset:-2048 sc1
    global_load_dwordx4 v[48:51], v12, s[16:17] offset:0 sc1
    global_load_dwordx4 v[52:55], v12, s[16:17] offset:2048 sc1
    global_load_dwordx4 v[56:59], v14, s[16:17] sc1
    s_sleep 8
L_polly:
    global_load_dword v202, v200, s[16:17] sc1
    global_load_dwordx4 v[24:27], v8, s[16:17] offset:-4096 sc1
    global_load_dwordx4 v[28:31], v8, s[16:17] offset:-2048 sc1
    global_load_dwordx4 v[32:35], v8, s[16:17] offset:0 sc1
    global_load_dwordx4 v[36:39], v8, s[16:17] offset:2048 sc1
    global_load_dwordx4 v[40:43], v12, s[16:17] offset:-4096 sc1
    global_load_dwordx4 v[44:47], v12, s[16:17] offset:-2048 sc1
    global_load_dwordx4 v[48:51], v12, s[16:17] offset:0 sc1
    global_load_dwordx4 v[52:55], v12, s[16:17] offset:2048 sc1
    global_load_dwordx4 v[56:59], v14, s[16:17] sc1
L_pyw:
    s_waitcnt vmcnt(10)
    s_cmp_lg_u32 s44, 0
    s_cbranch_scc1 L_py1
    s_waitcnt vmcnt(0)
L_py1:
    v_add_u32 v204, 1, v202
    v_cmp_lt_u32 vcc, s45, v204
    s_cbranch_vccnz L_redo
    v_xor_b32 v11, s26, v24
    v_bitop3_b32 v11, v28, s26, v11 bitop3:0xbe
    v_bitop3_b32 v11, v32, s26, v11 bitop3:0xbe
    v_bitop3_b32 v11, v36, s26, v11 bitop3:0xbe
    v_bitop3_b32 v11, v40, s26, v11 bitop3:0xbe
    v_bitop3_b32 v11, v44, s26, v11 bitop3:0xbe
    v_bitop3_b32 v11, v48, s26, v11 bitop3:0xbe
    v_bitop3_b32 v11, v52, s26, v11 bitop3:0xbe
    v_bitop3_b32 v11, v56, s26, v11 bitop3:0xbe
    v_and_b32 v11, 255, v11
    v_cmp_ne_u32 vcc, 0, v11
    s_cmp_eq_u64 vcc, 0
    s_cbranch_scc1 L_polly_ok
    s_sub_u32 s40, s40, 1
    s_cbranch_scc0 L_polly
L_polly_ok:
    v_pk_add_f32 v[64:65], v[24:25], v[28:29]
    v_pk_add_f32 v[66:67], v[26:27], v[30:31]
    v_pk_add_f32 v[68:69], v[32:33], v[36:37]
    v_pk_add_f32 v[70:71], v[34:35], v[38:39]
    v_pk_add_f32 v[72:73], v[40:41], v[44:45]
    v_pk_add_f32 v[74:75], v[42:43], v[46:47]
    v_pk_add_f32 v[76:77], v[48:49], v[52:53]
    v_pk_add_f32 v[78:79], v[50:51], v[54:55]
    v_pk_add_f32 v[64:65], v[64:65], v[68:69]
    v_pk_add_f32 v[66:67], v[66:67], v[70:71]
    v_pk_add_f32 v[72:73], v[72:73], v[76:77]
    v_pk_add_f32 v[74:75], v[74:75], v[78:79]
    v_pk_add_f32 v[64:65], v[64:65], v[72:73]
    v_pk_add_f32 v[66:67], v[66:67], v[74:75]
    v_pk_add_f32 v[64:65], v[64:65], v[56:57]
    v_pk_add_f32 v[66:67], v[66:67], v[58:59]
    s_nop 1
    v_permlane32_swap_b32 v64, v66
    v_permlane32_swap_b32 v65, v67
    v_pk_add_f32 v[64:65], v[64:65], v[66:67]
    s_nop 1
    v_permlane16_swap_b32 v64, v65
    v_add_f32 v64, v64, v65
    s_nop 1
    v_add_f32_dpp v64, v64, v64 row_ror:4 row_mask:0xf bank_mask:0xf
    s_nop 1
    v_add_f32_dpp v64, v64, v64 row_ror:8 row_mask:0xf bank_mask:0xf
    v_cvt_pk_bf16_f32 v64, v64, v64
    v_and_b32 v64, 0xffff0000, v64
    v_mul_f32 v64, v64, v10
    v_cvt_pk_bf16_f32 v64, v64, v64
    v_and_b32 v64, 0xffff0000, v64
    v_add_f32 v64, v64, v16
    v_cvt_pk_bf16_f32 v64, v64, v64
    v_and_b32 v64, 0xffff0000, v64
    v_add_f32 v64, v64, v17
    v_mov_b32 v65, v64
    s_nop 1
    v_permlane16_swap_b32 v64, v65
    v_cvt_pk_bf16_f32 v64, v64, v65
    s_cmp_eq_u32 s44, 0
    s_cbranch_scc1 L_red0
L_pollw:
    v_add_u32 v204, 1, v202
    v_cmp_lt_u32 vcc, s45, v204
    s_cbranch_vccnz L_redo
    v_readlane_b32 s43, v204, 32
    s_cmp_eq_u32 s43, s45
    s_cbranch_scc1 L_won
    global_load_dword v202, v200, s[16:17] sc1
    s_waitcnt vmcnt(1)
    s_sub_u32 s48, s48, 1
    s_cbranch_scc0 L_pollw
L_won:
    s_mov_b32 exec_lo, 15
    s_mov_b32 exec_hi, 15
    global_store_dword v9, v64, s[14:15]
    v_mov_b32 v204, s45
    ds_write_b32 v201, v204 offset:4
    s_waitcnt lgkmcnt(0)
L_end:
    s_endpgm
L_red0:
    s_mov_b32 exec_lo, 15
    s_mov_b32 exec_hi, 15
    global_store_dword v9, v64, s[16:17] sc1
    s_branch L_back
L_r3:
    v_lshlrev_b32 v8, 4, v2
    s_lshl_b32 s24, s50, 6
    s_add_u32 s24, s24, 162368
    v_add_u32 v9, s24, v8
    ds_read_b128 v[232:235], v9
    v_lshrrev_b32 v10, 1, v2
    v_mul_u32_u24 v10, 96, v10
    v_add_u32 v8, 3532800, v8
    v_add_u32 v8, v8, v10
    v_mov_b32 v236, 0x3f803f80
    v_mov_b32 v237, 0x3f803f80
    v_mov_b32 v238, 0x3f803f80
    v_mov_b32 v239, 0x3f803f80
    s_mov_b32 s40, 30000
    s_sleep 40
L_pollf:
    s_sleep 6
    global_load_dwordx4 v[140:143], v8, s[16:17] offset:-2048 sc1
    global_load_dwordx4 v[144:147], v8, s[16:17] offset:-1792 sc1
    global_load_dwordx4 v[148:151], v8, s[16:17] offset:-1536 sc1
    global_load_dwordx4 v[152:155], v8, s[16:17] offset:-1280 sc1
    global_load_dwordx4 v[156:159], v8, s[16:17] offset:-1024 sc1
    global_load_dwordx4 v[160:163], v8, s[16:17] offset:-768 sc1
    global_load_dwordx4 v[164:167], v8, s[16:17] offset:-512 sc1
    global_load_dwordx4 v[168:171], v8, s[16:17] offset:-256 sc1
    global_load_dwordx4 v[172:175], v8, s[16:17] offset:0 sc1
    global_load_dwordx4 v[176:179], v8, s[16:17] offset:256 sc1
    global_load_dwordx4 v[180:183], v8, s[16:17] offset:512 sc1
    global_load_dwordx4 v[184:187], v8, s[16:17] offset:768 sc1
    global_load_dwordx4 v[188:191], v8, s[16:17] offset:1024 sc1
    global_load_dwordx4 v[192:195], v8, s[16:17] offset:1280 sc1
    global_load_dwordx4 v[196:199], v8, s[16:17] offset:1536 sc1
    global_load_dwordx4 v[200:203], v8, s[16:17] offset:1792 sc1
    global_load_dwordx4 v[204:207], v8, s[16:17] offset:2048 sc1
    global_load_dwordx4 v[208:211], v8, s[16:17] offset:2304 sc1
    s_waitcnt vmcnt(0)
    v_max3_u32 v11, v140, v141, v142
    v_max3_u32 v11, v143, v144, v11
    v_max3_u32 v11, v145, v146, v11
    v_max3_u32 v11, v147, v148, v11
    v_max3_u32 v11, v149, v150, v11
    v_max3_u32 v11, v151, v152, v11
    v_max3_u32 v11, v153, v154, v11
    v_max3_u32 v11, v155, v156, v11
    v_max3_u32 v11, v157, v158, v11
    v_max3_u32 v11, v159, v160, v11
    v_max3_u32 v11, v161, v162, v11
    v_max3_u32 v11, v163, v164, v11
    v_max3_u32 v11, v165, v166, v11
    v_max3_u32 v11, v167, v168, v11
    v_max3_u32 v11, v169, v170, v11
    v_max3_u32 v11, v171, v172, v11
    v_max3_u32 v11, v173, v174, v11
    v_max3_u32 v11, v175, v176, v11
    v_max3_u32 v11, v177, v178, v11
    v_max3_u32 v11, v179, v180, v11
    v_max3_u32 v11, v181, v182, v11
    v_max3_u32 v11, v183, v184, v11
    v_max3_u32 v11, v185, v186, v11
    v_max3_u32 v11, v187, v188, v11
    v_max3_u32 v11, v189, v190, v11
    v_max3_u32 v11, v191, v192, v11
    v_max3_u32 v11, v193, v194, v11
    v_max3_u32 v11, v195, v196, v11
    v_max3_u32 v11, v197, v198, v11
    v_max3_u32 v11, v199, v200, v11
    v_max3_u32 v11, v201, v202, v11
    v_max3_u32 v11, v203, v204, v11
    v_max3_u32 v11, v205, v206, v11
    v_max3_u32 v11, v207, v208, v11
    v_max3_u32 v11, v209, v210, v11
    v_max_u32 v11, v211, v11
    v_cmp_eq_u32 vcc, -1, v11
    s_cmp_eq_u64 vcc, 0
    s_cbranch_scc1 L_pollf_ok
    s_sub_u32 s40, s40, 1
    s_cbranch_scc0 L_pollf
L_pollf_ok:
    v_mfma_f32_16x16x32_bf16 v[12:15], v[236:239], v[140:143], 0
    v_mfma_f32_16x16x32_bf16 v[16:19], v[140:143], v[140:143], 0
    v_mfma_f32_16x16x32_bf16 v[240:243], v[24:27], v[140:143], 0
    v_mfma_f32_16x16x32_bf16 v[12:15], v[236:239], v[144:147], v[12:15]
    v_mfma_f32_16x16x32_bf16 v[16:19], v[144:147], v[144:147], v[16:19]
    v_mfma_f32_16x16x32_bf16 v[240:243], v[28:31], v[144:147], v[240:243]
    v_mfma_f32_16x16x32_bf16 v[12:15], v[236:239], v[148:151], v[12:15]
    v_mfma_f32_16x16x32_bf16 v[16:19], v[148:151], v[148:151], v[16:19]
    v_mfma_f32_16x16x32_bf16 v[240:243], v[32:35], v[148:151], v[240:243]
    v_mfma_f32_16x16x32_bf16 v[12:15], v[236:239], v[152:155], v[12:15]
    v_mfma_f32_16x16x32_bf16 v[16:19], v[152:155], v[152:155], v[16:19]
    v_mfma_f32_16x16x32_bf16 v[240:243], v[36:39], v[152:155], v[240:243]
    v_mfma_f32_16x16x32_bf16 v[12:15], v[236:239], v[156:159], v[12:15]
    v_mfma_f32_16x16x32_bf16 v[16:19], v[156:159], v[156:159], v[16:19]
    v_mfma_f32_16x16x32_bf16 v[240:243], v[40:43], v[156:159], v[240:243]
    v_mfma_f32_16x16x32_bf16 v[12:15], v[236:239], v[160:163], v[12:15]
    v_mfma_f32_16x16x32_bf16 v[16:19], v[160:163], v[160:163], v[16:19]
    v_mfma_f32_16x16x32_bf16 v[240:243], v[44:47], v[160:163], v[240:243]
    v_mfma_f32_16x16x32_bf16 v[12:15], v[236:239], v[164:167], v[12:15]
    v_mfma_f32_16x16x32_bf16 v[16:19], v[164:167], v[164:167], v[16:19]
    v_mfma_f32_16x16x32_bf16 v[240:243], v[48:51], v[164:167], v[240:243]
    v_mfma_f32_16x16x32_bf16 v[12:15], v[236:239], v[168:171], v[12:15]
    v_mfma_f32_16x16x32_bf16 v[16:19], v[168:171], v[168:171], v[16:19]
    v_mfma_f32_16x16x32_bf16 v[240:243], v[52:55], v[168:171], v[240:243]
    v_mfma_f32_16x16x32_bf16 v[12:15], v[236:239], v[172:175], v[12:15]
    v_mfma_f32_16x16x32_bf16 v[16:19], v[172:175], v[172:175], v[16:19]
    v_mfma_f32_16x16x32_bf16 v[240:243], v[56:59], v[172:175], v[240:243]
    v_mfma_f32_16x16x32_bf16 v[12:15], v[236:239], v[176:179], v[12:15]
    v_mfma_f32_16x16x32_bf16 v[16:19], v[176:179], v[176:179], v[16:19]
    v_mfma_f32_16x16x32_bf16 v[240:243], v[60:63], v[176:179], v[240:243]
    v_mfma_f32_16x16x32_bf16 v[12:15], v[236:239], v[180:183], v[12:15]
    v_mfma_f32_16x16x32_bf16 v[16:19], v[180:183], v[180:183], v[16:19]
    v_mfma_f32_16x16x32_bf16 v[240:243], v[64:67], v[180:183], v[240:243]
    v_mfma_f32_16x16x32_bf16 v[12:15], v[236:239], v[184:187], v[12:15]
    v_mfma_f32_16x16x32_bf16 v[16:19], v[184:187], v[184:187], v[16:19]
    v_mfma_f32_16x16x32_bf16 v[240:243], v[68:71], v[184:187], v[240:243]
    v_mfma_f32_16x16x32_bf16 v[12:15], v[236:239], v[188:191], v[12:15]
    v_mfma_f32_16x16x32_bf16 v[16:19], v[188:191], v[188:191], v[16:19]
    v_mfma_f32_16x16x32_bf16 v[240:243], v[72:75], v[188:191], v[240:243]
    v_mfma_f32_16x16x32_bf16 v[12:15], v[236:239], v[192:195], v[12:15]
    v_mfma_f32_16x16x32_bf16 v[16:19], v[192:195], v[192:195], v[16:19]
    v_mfma_f32_16x16x32_bf16 v[240:243], v[76:79], v[192:195], v[240:243]
    v_mfma_f32_16x16x32_bf16 v[12:15], v[236:239], v[196:199], v[12:15]
    v_mfma_f32_16x16x32_bf16 v[16:19], v[196:199], v[196:199], v[16:19]
    v_mfma_f32_16x16x32_bf16 v[240:243], v[80:83], v[196:199], v[240:243]
    v_mfma_f32_16x16x32_bf16 v[12:15], v[236:239], v[200:203], v[12:15]
    v_mfma_f32_16x16x32_bf16 v[16:19], v[200:203], v[200:203], v[16:19]
    v_mfma_f32_16x16x32_bf16 v[240:243], v[84:87], v[200:203], v[240:243]
    v_mfma_f32_16x16x32_bf16 v[12:15], v[236:239], v[204:207], v[12:15]
    v_mfma_f32_16x16x32_bf16 v[16:19], v[204:207], v[204:207], v[16:19]
    v_mfma_f32_16x16x32_bf16 v[240:243], v[88:91], v[204:207], v[240:243]
    v_mfma_f32_16x16x32_bf16 v[12:15], v[236:239], v[208:211], v[12:15]
    v_mfma_f32_16x16x32_bf16 v[16:19], v[208:211], v[208:211], v[16:19]
    v_mfma_f32_16x16x32_bf16 v[240:243], v[92:95], v[208:211], v[240:243]
    s_nop 5
    v_mul_f32 v13, 0x3ae38e39, v12
    v_mul_f32 v14, 0x3ae38e39, v16
    v_fma_f32 v14, -v13, v13, v14
    v_max_f32 v14, 0, v14
    v_cvt_pk_bf16_f32 v15, v13, v13
    v_and_b32 v15, 0xffff0000, v15
    v_cvt_pk_bf16_f32 v18, v14, v14
    v_and_b32 v18, 0xffff0000, v18
    v_add_f32 v18, 0x3727c5ac, v18
    v_cvt_pk_bf16_f32 v18, v18, v18
    v_and_b32 v18, 0xffff0000, v18
    v_sqrt_f32 v18, v18
    s_nop 0
    v_cvt_pk_bf16_f32 v17, v18, v18
    v_and_b32 v17, 0xffff0000, v17
    v_rcp_f32 v17, v17
    s_cmp_eq_u32 s50, 4
    s_cselect_b32 s24, 2, 4
    v_cmp_gt_u32 vcc, s24, v2
    v_mul_f32 v18, 0x3eae1a93, v17
    s_nop 0
    v_cndmask_b32 v17, v17, v18, vcc
    v_mul_f32 v15, v15, v17
    s_waitcnt lgkmcnt(0)
    v_mul_f32 v240, v17, v240
    v_fma_f32 v240, -v15, v232, v240
    v_mul_f32 v241, v17, v241
    v_fma_f32 v241, -v15, v233, v241
    v_mul_f32 v242, v17, v242
    v_fma_f32 v242, -v15, v234, v242
    v_mul_f32 v243, v17, v243
    v_fma_f32 v243, -v15, v235, v243
    v_cvt_pk_bf16_f32 v12, v240, v241
    v_cvt_pk_bf16_f32 v13, v242, v243
    s_mul_i32 s24, s4, 144
    s_lshl_b32 s25, s50, 5
    s_add_u32 s24, s24, s25
    s_add_u32 s24, s24, 3536896
    v_lshl_add_u32 v8, v2, 3, s24
    s_lshl_b32 s24, s4, 7
    s_add_u32 s24, s24, 3547120
    v_lshl_add_u32 v9, v2, 3, s24
    v_cndmask_b32 v8, v9, v8, vcc
    s_cmp_lg_u32 s50, 4
    s_cbranch_scc1 L_r3st
    s_cmp_ge_u32 s4, 6
    s_cbranch_scc1 L_r3st
    s_mul_i32 s24, s4, 11
    s_lshr_b32 s24, s24, 5
    s_mul_i32 s25, s24, 3
    s_sub_u32 s25, s4, s25
    s_lshl_b32 s25, s25, 3
    s_min_u32 s25, s25, 10
    v_and_b32 v9, 1, v2
    v_and_b32 v10, 3, v3
    v_lshl_add_u32 v9, v9, 2, v10
    v_add_u32 v9, s25, v9
    v_cmp_lt_u32 vcc, 1, v10
    s_nop 1
    v_cndmask_b32 v14, v12, v13, vcc
    v_and_b32 v10, 1, v10
    v_lshlrev_b32 v10, 4, v10
    v_lshrrev_b32 v14, v10, v14
    s_bfe_u32 s25, s31, 0x10002
    v_mov_b32 v10, v9
    v_mov_b32 v11, s25
    v_lshrrev_b32 v16, 3, v10
    v_cmp_gt_u32 vcc, 16, v10
    v_and_b32 v10, 7, v10
    v_lshlrev_b32 v10, 4, v10
    v_lshl_add_u32 v10, v16, 8, v10
    v_xor_b32 v16, v16, v11
    v_lshlrev_b32 v16, 7, v16
    v_lshlrev_b32 v17, 6, v11
    v_cndmask_b32 v16, v17, v16, vcc
    v_add_u32 v10, v10, v16
    v_add_u32 v10, s54, v10
    s_lshr_b32 s25, s56, 5
    s_and_b32 s26, s31, 31
    s_lshl_b32 s27, s25, 10
    s_lshl_b32 s28, s26, 4
    s_add_u32 s27, s27, s28
    v_lshrrev_b32 v11, 3, v9
    v_lshl_add_u32 v11, v11, 9, s27
    v_and_b32 v15, 7, v9
    v_lshl_add_u32 v11, v15, 1, v11
    s_lshl_b32 s27, s56, 2
    s_add_u32 s27, s27, 8192
    v_lshl_add_u32 v15, v15, 1, s27
    v_cmp_lt_u32 vcc, 15, v9
    s_nop 1
    v_cndmask_b32 v11, v11, v15, vcc
    s_cmp_eq_u32 s24, 1
    s_cselect_b64 vcc, -1, 0
    v_cndmask_b32 v10, v11, v10, vcc
    s_add_u32 s24, s53, 3551232
    v_add_u32 v10, s24, v10
    s_mov_b32 exec_lo, 0
    s_mov_b32 exec_hi, 0x000f000f
    global_store_short v10, v14, s[16:17] sc1
    s_waitcnt vmcnt(0)
L_r3st:
    s_mov_b32 exec_lo, 0x00010001
    s_mov_b32 exec_hi, 0x00010001
    global_store_dwordx2 v8, v[12:13], s[16:17] sc1
    s_branch L_back
L_r4:
    v_and_b32 v8, 31, v1
    v_lshrrev_b32 v4, 5, v1
    v_mul_u32_u24 v9, 36, v8
    v_add_u32 v9, 3536896, v9
    v_lshl_add_u32 v10, v4, 4, v9
    s_and_b32 s24, s3, 3
    s_lshl_b32 s24, s24, 3
    s_add_u32 s24, s24, s4
    s_mul_i32 s25, s24, 2560
    s_add_u32 s25, s25, 7745536
    v_mul_u32_u24 v11, 80, v8
    v_lshl_add_u32 v11, v4, 4, v11
    v_add_u32 v11, s25, v11
    s_lshr_b32 s25, s24, 2
    s_mul_i32 s25, s25, 19456
    s_add_u32 s25, s25, 3551232
    s_and_b32 s24, s24, 3
    s_lshl_b32 s26, s24, 11
    s_add_u32 s26, s26, s25
    v_lshl_add_u32 v12, v1, 4, s26
    s_lshl_b32 s26, s24, 8
    s_add_u32 s26, s26, s25
    s_add_u32 s26, s26, 8192
    v_lshl_add_u32 v13, v1, 2, s26
    s_mul_i32 s26, s24, 2560
    s_add_u32 s26, s26, s25
    s_add_u32 s26, s26, 11776
    v_mov_b32 v53, 0
    v_and_b32 v15, 4, v8
    v_cmp_gt_u32 vcc, 20, v8
    s_nop 1
    v_cndmask_b32 v14, v15, v8, vcc
    v_lshrrev_b32 v15, 3, v14
    v_cmp_gt_u32 vcc, 16, v14
    v_and_b32 v14, 7, v14
    v_lshlrev_b32 v14, 4, v14
    v_lshl_add_u32 v14, v15, 8, v14
    v_xor_b32 v15, v15, v4
    v_lshlrev_b32 v15, 7, v15
    v_lshlrev_b32 v16, 6, v4
    v_cndmask_b32 v15, v16, v15, vcc
    v_add_u32 v14, v14, v15
    v_add_u32 v14, s26, v14
    s_mov_b32 s40, 30000
L_pollq:
    s_sleep 2
    global_load_dwordx4 v[24:27], v10, s[16:17] sc1
    global_load_dword v28, v9, s[16:17] offset:32 sc1
    s_waitcnt vmcnt(0)
    v_max3_u32 v15, v24, v25, v26
    v_max3_u32 v15, v27, v28, v15
    v_cmp_eq_u32 vcc, -1, v15
    s_cmp_eq_u64 vcc, 0
    s_cbranch_scc1 L_pollq_ok
    s_sub_u32 s40, s40, 1
    s_cbranch_scc0 L_pollq
L_pollq_ok:
    global_load_dwordx4 v[36:39], v12, s[16:17] offset:0 sc1
    global_load_dwordx4 v[40:43], v12, s[16:17] offset:1024 sc1
    global_load_dword v52, v13, s[16:17] sc1
    global_load_dwordx4 v[56:59], v14, s[16:17] offset:-2560 sc1
    global_load_dwordx4 v[60:63], v14, s[16:17] offset:-1920 sc1
    global_load_dwordx4 v[64:67], v14, s[16:17] offset:-1280 sc1
    global_load_dwordx4 v[68:71], v14, s[16:17] offset:-640 sc1
    v_cmp_eq_u32 vcc, 0, v4
    s_nop 1
    v_cndmask_b32 v31, 0, v28, vcc
    v_cndmask_b32 v32, v28, 0, vcc
    v_mov_b32 v28, v31
    v_mov_b32 v29, 0
    v_mov_b32 v30, 0
    v_mov_b32 v35, v32
    v_mov_b32 v33, 0
    v_mov_b32 v34, 0
    s_waitcnt vmcnt(4)
    v_mfma_f32_32x32x16_bf16 v[96:111], v[36:39], v[24:27], 0
    v_mfma_f32_32x32x16_bf16 v[112:127], v[40:43], v[24:27], 0
    s_nop 7
    s_nop 3
    v_mfma_f32_32x32x8_bf16 v[96:111], v[52:53], v[28:29], v[96:111]
    v_mfma_f32_32x32x8_bf16 v[112:127], v[52:53], v[32:33], v[112:127]
    s_nop 10
    v_max_f32 v15, v96, v97
    v_max3_f32 v15, v98, v99, v15
    v_max3_f32 v15, v100, v101, v15
    v_max3_f32 v15, v102, v103, v15
    v_max3_f32 v15, v104, v105, v15
    v_max3_f32 v15, v106, v107, v15
    v_max3_f32 v15, v108, v109, v15
    v_max3_f32 v15, v110, v111, v15
    v_max3_f32 v15, v112, v113, v15
    v_max3_f32 v15, v114, v115, v15
    v_max3_f32 v15, v116, v117, v15
    v_max3_f32 v15, v118, v119, v15
    v_max3_f32 v15, v120, v121, v15
    v_max3_f32 v15, v122, v123, v15
    v_max3_f32 v15, v124, v125, v15
    v_max3_f32 v15, v126, v127, v15
    v_mov_b32 v16, v15
    s_nop 1
    v_permlane32_swap_b32 v15, v16
    v_max_f32 v15, v15, v16
    v_mov_b32 v16, v15
    s_waitcnt vmcnt(0)
    v_pk_add_f32 v[96:97], v[96:97], v[16:17] op_sel_hi:[1,0] neg_lo:[0,1] neg_hi:[0,1]
    v_pk_add_f32 v[98:99], v[98:99], v[16:17] op_sel_hi:[1,0] neg_lo:[0,1] neg_hi:[0,1]
    v_pk_add_f32 v[100:101], v[100:101], v[16:17] op_sel_hi:[1,0] neg_lo:[0,1] neg_hi:[0,1]
    v_pk_add_f32 v[102:103], v[102:103], v[16:17] op_sel_hi:[1,0] neg_lo:[0,1] neg_hi:[0,1]
    v_exp_f32 v96, v96
    v_exp_f32 v97, v97
    v_exp_f32 v98, v98
    v_exp_f32 v99, v99
    v_exp_f32 v100, v100
    v_exp_f32 v101, v101
    v_exp_f32 v102, v102
    v_exp_f32 v103, v103
    v_cvt_pk_bf16_f32 v160, v96, v97
    v_cvt_pk_bf16_f32 v161, v98, v99
    v_cvt_pk_bf16_f32 v162, v100, v101
    v_cvt_pk_bf16_f32 v163, v102, v103
    s_nop 1
    v_mfma_f32_32x32x16_bf16 v[192:207], v[56:59], v[160:163], 0
    v_pk_add_f32 v[104:105], v[104:105], v[16:17] op_sel_hi:[1,0] neg_lo:[0,1] neg_hi:[0,1]
    v_pk_add_f32 v[106:107], v[106:107], v[16:17] op_sel_hi:[1,0] neg_lo:[0,1] neg_hi:[0,1]
    v_pk_add_f32 v[108:109], v[108:109], v[16:17] op_sel_hi:[1,0] neg_lo:[0,1] neg_hi:[0,1]
    v_pk_add_f32 v[110:111], v[110:111], v[16:17] op_sel_hi:[1,0] neg_lo:[0,1] neg_hi:[0,1]
    v_exp_f32 v104, v104
    v_exp_f32 v105, v105
    v_exp_f32 v106, v106
    v_exp_f32 v107, v107
    v_exp_f32 v108, v108
    v_exp_f32 v109, v109
    v_exp_f32 v110, v110
    v_exp_f32 v111, v111
    v_cvt_pk_bf16_f32 v164, v104, v105
    v_cvt_pk_bf16_f32 v165, v106, v107
    v_cvt_pk_bf16_f32 v166, v108, v109
    v_cvt_pk_bf16_f32 v167, v110, v111
    s_nop 1
    v_mfma_f32_32x32x16_bf16 v[192:207], v[60:63], v[164:167], v[192:207]
    v_pk_add_f32 v[112:113], v[112:113], v[16:17] op_sel_hi:[1,0] neg_lo:[0,1] neg_hi:[0,1]
    v_pk_add_f32 v[114:115], v[114:115], v[16:17] op_sel_hi:[1,0] neg_lo:[0,1] neg_hi:[0,1]
    v_pk_add_f32 v[116:117], v[116:117], v[16:17] op_sel_hi:[1,0] neg_lo:[0,1] neg_hi:[0,1]
    v_pk_add_f32 v[118:119], v[118:119], v[16:17] op_sel_hi:[1,0] neg_lo:[0,1] neg_hi:[0,1]
    v_exp_f32 v112, v112
    v_exp_f32 v113, v113
    v_exp_f32 v114, v114
    v_exp_f32 v115, v115
    v_exp_f32 v116, v116
    v_exp_f32 v117, v117
    v_exp_f32 v118, v118
    v_exp_f32 v119, v119
    v_cvt_pk_bf16_f32 v168, v112, v113
    v_cvt_pk_bf16_f32 v169, v114, v115
    v_cvt_pk_bf16_f32 v170, v116, v117
    v_cvt_pk_bf16_f32 v171, v118, v119
    s_nop 1
    v_mfma_f32_32x32x16_bf16 v[192:207], v[64:67], v[168:171], v[192:207]
    v_pk_add_f32 v[120:121], v[120:121], v[16:17] op_sel_hi:[1,0] neg_lo:[0,1] neg_hi:[0,1]
    v_pk_add_f32 v[122:123], v[122:123], v[16:17] op_sel_hi:[1,0] neg_lo:[0,1] neg_hi:[0,1]
    v_pk_add_f32 v[124:125], v[124:125], v[16:17] op_sel_hi:[1,0] neg_lo:[0,1] neg_hi:[0,1]
    v_pk_add_f32 v[126:127], v[126:127], v[16:17] op_sel_hi:[1,0] neg_lo:[0,1] neg_hi:[0,1]
    v_exp_f32 v120, v120
    v_exp_f32 v121, v121
    v_exp_f32 v122, v122
    v_exp_f32 v123, v123
    v_exp_f32 v124, v124
    v_exp_f32 v125, v125
    v_exp_f32 v126, v126
    v_exp_f32 v127, v127
    v_cvt_pk_bf16_f32 v172, v120, v121
    v_cvt_pk_bf16_f32 v173, v122, v123
    v_cvt_pk_bf16_f32 v174, v124, v125
    v_cvt_pk_bf16_f32 v175, v126, v127
    s_nop 1
    v_mfma_f32_32x32x16_bf16 v[192:207], v[68:71], v[172:175], v[192:207]
    s_nop 11
    v_mov_b32 v203, v15
    global_store_dwordx4 v11, v[192:195], s[16:17] sc1
    global_store_dwordx4 v11, v[196:199], s[16:17] offset:32 sc1
    s_mov_b32 exec_hi, 0
    global_store_dwordx4 v11, v[200:203], s[16:17] offset:64 sc1
    s_branch L_back
L_r5:
    s_mul_i32 s24, s4, 320
    s_add_u32 s24, s24, 7745536
    v_mul_u32_u24 v8, 2560, v3
    v_mul_u32_u24 v9, 80, v2
    v_add3_u32 v8, v8, v9, s24
    v_add_u32 v14, 40960, v8
    s_lshr_b32 s24, s31, 4
    s_mul_i32 s24, s24, 18432
    s_mul_i32 s25, s4, 2304
    s_add_u32 s24, s24, s25
    s_and_b32 s25, s31, 15
    s_lshl_b32 s25, s25, 4
    s_add_u32 s24, s24, s25
    s_add_u32 s24, s24, 4194304
    v_lshl_add_u32 v9, v2, 9, s24
    v_lshl_add_u32 v10, v2, 2, s24
    s_mov_b32 s40, 30000
L_pollt:
    s_sleep 8
    global_load_dwordx4 v[140:143], v8, s[16:17] offset:0 sc1
    global_load_dwordx4 v[144:147], v8, s[16:17] offset:16 sc1
    global_load_dwordx4 v[148:151], v8, s[16:17] offset:32 sc1
    global_load_dwordx4 v[152:155], v8, s[16:17] offset:48 sc1
    global_load_dwordx4 v[156:159], v8, s[16:17] offset:64 sc1
    global_load_dwordx4 v[160:163], v14, s[16:17] offset:0 sc1
    global_load_dwordx4 v[164:167], v14, s[16:17] offset:16 sc1
    global_load_dwordx4 v[168:171], v14, s[16:17] offset:32 sc1
    global_load_dwordx4 v[172:175], v14, s[16:17] offset:48 sc1
    global_load_dwordx4 v[176:179], v14, s[16:17] offset:64 sc1
    s_waitcnt vmcnt(0)
    v_max3_u32 v11, v140, v141, v142
    v_max3_u32 v11, v143, v144, v11
    v_max3_u32 v11, v145, v146, v11
    v_max3_u32 v11, v147, v148, v11
    v_max3_u32 v11, v149, v150, v11
    v_max3_u32 v11, v151, v152, v11
    v_max3_u32 v11, v153, v154, v11
    v_max3_u32 v11, v155, v156, v11
    v_max3_u32 v11, v157, v158, v11
    v_max3_u32 v11, v159, v160, v11
    v_max3_u32 v11, v161, v162, v11
    v_max3_u32 v11, v163, v164, v11
    v_max3_u32 v11, v165, v166, v11
    v_max3_u32 v11, v167, v168, v11
    v_max3_u32 v11, v169, v170, v11
    v_max3_u32 v11, v171, v172, v11
    v_max3_u32 v11, v173, v174, v11
    v_max3_u32 v11, v175, v176, v11
    v_max3_u32 v11, v177, v178, v11
    v_max_u32 v11, v179, v11
    v_cmp_eq_u32 vcc, -1, v11
    s_cmp_eq_u64 vcc, 0
    s_cbranch_scc1 L_pollt_ok
    s_sub_u32 s40, s40, 1
    s_cbranch_scc0 L_pollt
L_pollt_ok:
    v_max_f32 v11, v159, v179
    s_nop 1
    v_max_f32_dpp v11, v11, v11 row_ror:8 row_mask:0xf bank_mask:0xf
    s_nop 1
    v_max_f32_dpp v11, v11, v11 row_ror:4 row_mask:0xf bank_mask:0xf
    s_nop 1
    v_max_f32_dpp v11, v11, v11 row_ror:2 row_mask:0xf bank_mask:0xf
    s_nop 1
    v_max_f32_dpp v11, v11, v11 row_ror:1 row_mask:0xf bank_mask:0xf
    v_sub_f32 v12, v159, v11
    v_sub_f32 v13, v179, v11
    v_exp_f32 v12, v12
    v_exp_f32 v13, v13
    s_nop 0
    v_pk_mul_f32 v[140:141], v[140:141], v[12:13] op_sel_hi:[1,0]
    v_pk_mul_f32 v[142:143], v[142:143], v[12:13] op_sel_hi:[1,0]
    v_pk_mul_f32 v[144:145], v[144:145], v[12:13] op_sel_hi:[1,0]
    v_pk_mul_f32 v[146:147], v[146:147], v[12:13] op_sel_hi:[1,0]
    v_pk_mul_f32 v[148:149], v[148:149], v[12:13] op_sel_hi:[1,0]
    v_pk_mul_f32 v[150:151], v[150:151], v[12:13] op_sel_hi:[1,0]
    v_pk_mul_f32 v[152:153], v[152:153], v[12:13] op_sel_hi:[1,0]
    v_pk_mul_f32 v[154:155], v[154:155], v[12:13] op_sel_hi:[1,0]
    v_pk_mul_f32 v[156:157], v[156:157], v[12:13] op_sel_hi:[1,0]
    v_pk_mul_f32 v[158:159], v[158:159], v[12:13] op_sel_hi:[1,0]
    v_pk_fma_f32 v[140:141], v[160:161], v[12:13], v[140:141] op_sel:[0,1,0]
    v_pk_fma_f32 v[142:143], v[162:163], v[12:13], v[142:143] op_sel:[0,1,0]
    v_pk_fma_f32 v[144:145], v[164:165], v[12:13], v[144:145] op_sel:[0,1,0]
    v_pk_fma_f32 v[146:147], v[166:167], v[12:13], v[146:147] op_sel:[0,1,0]
    v_pk_fma_f32 v[148:149], v[168:169], v[12:13], v[148:149] op_sel:[0,1,0]
    v_pk_fma_f32 v[150:151], v[170:171], v[12:13], v[150:151] op_sel:[0,1,0]
    v_pk_fma_f32 v[152:153], v[172:173], v[12:13], v[152:153] op_sel:[0,1,0]
    v_pk_fma_f32 v[154:155], v[174:175], v[12:13], v[154:155] op_sel:[0,1,0]
    v_pk_fma_f32 v[156:157], v[176:177], v[12:13], v[156:157] op_sel:[0,1,0]
    v_pk_fma_f32 v[158:159], v[178:179], v[12:13], v[158:159] op_sel:[0,1,0]
    v_add_f32_dpp v140, v140, v140 row_ror:8 row_mask:0xf bank_mask:0xf
    v_add_f32_dpp v141, v141, v141 row_ror:8 row_mask:0xf bank_mask:0xf
    v_add_f32_dpp v142, v142, v142 row_ror:8 row_mask:0xf bank_mask:0xf
    v_add_f32_dpp v143, v143, v143 row_ror:8 row_mask:0xf bank_mask:0xf
    v_add_f32_dpp v144, v144, v144 row_ror:8 row_mask:0xf bank_mask:0xf
    v_add_f32_dpp v145, v145, v145 row_ror:8 row_mask:0xf bank_mask:0xf
    v_add_f32_dpp v146, v146, v146 row_ror:8 row_mask:0xf bank_mask:0xf
    v_add_f32_dpp v147, v147, v147 row_ror:8 row_mask:0xf bank_mask:0xf
    v_add_f32_dpp v148, v148, v148 row_ror:8 row_mask:0xf bank_mask:0xf
    v_add_f32_dpp v149, v149, v149 row_ror:8 row_mask:0xf bank_mask:0xf
    v_add_f32_dpp v150, v150, v150 row_ror:8 row_mask:0xf bank_mask:0xf
    v_add_f32_dpp v151, v151, v151 row_ror:8 row_mask:0xf bank_mask:0xf
    v_add_f32_dpp v152, v152, v152 row_ror:8 row_mask:0xf bank_mask:0xf
    v_add_f32_dpp v153, v153, v153 row_ror:8 row_mask:0xf bank_mask:0xf
    v_add_f32_dpp v154, v154, v154 row_ror:8 row_mask:0xf bank_mask:0xf
    v_add_f32_dpp v155, v155, v155 row_ror:8 row_mask:0xf bank_mask:0xf
    v_add_f32_dpp v156, v156, v156 row_ror:8 row_mask:0xf bank_mask:0xf
    v_add_f32_dpp v157, v157, v157 row_ror:8 row_mask:0xf bank_mask:0xf
    v_add_f32_dpp v158, v158, v158 row_ror:8 row_mask:0xf bank_mask:0xf
    v_add_f32_dpp v140, v140, v140 row_ror:4 row_mask:0xf bank_mask:0xf
    v_add_f32_dpp v141, v141, v141 row_ror:4 row_mask:0xf bank_mask:0xf
    v_add_f32_dpp v142, v142, v142 row_ror:4 row_mask:0xf bank_mask:0xf
    v_add_f32_dpp v143, v143, v143 row_ror:4 row_mask:0xf bank_mask:0xf
    v_add_f32_dpp v144, v144, v144 row_ror:4 row_mask:0xf bank_mask:0xf
    v_add_f32_dpp v145, v145, v145 row_ror:4 row_mask:0xf bank_mask:0xf
    v_add_f32_dpp v146, v146, v146 row_ror:4 row_mask:0xf bank_mask:0xf
    v_add_f32_dpp v147, v147, v147 row_ror:4 row_mask:0xf bank_mask:0xf
    v_add_f32_dpp v148, v148, v148 row_ror:4 row_mask:0xf bank_mask:0xf
    v_add_f32_dpp v149, v149, v149 row_ror:4 row_mask:0xf bank_mask:0xf
    v_add_f32_dpp v150, v150, v150 row_ror:4 row_mask:0xf bank_mask:0xf
    v_add_f32_dpp v151, v151, v151 row_ror:4 row_mask:0xf bank_mask:0xf
    v_add_f32_dpp v152, v152, v152 row_ror:4 row_mask:0xf bank_mask:0xf
    v_add_f32_dpp v153, v153, v153 row_ror:4 row_mask:0xf bank_mask:0xf
    v_add_f32_dpp v154, v154, v154 row_ror:4 row_mask:0xf bank_mask:0xf
    v_add_f32_dpp v155, v155, v155 row_ror:4 row_mask:0xf bank_mask:0xf
    v_add_f32_dpp v156, v156, v156 row_ror:4 row_mask:0xf bank_mask:0xf
    v_add_f32_dpp v157, v157, v157 row_ror:4 row_mask:0xf bank_mask:0xf
    v_add_f32_dpp v158, v158, v158 row_ror:4 row_mask:0xf bank_mask:0xf
    v_add_f32_dpp v140, v140, v140 row_ror:2 row_mask:0xf bank_mask:0xf
    v_add_f32_dpp v141, v141, v141 row_ror:2 row_mask:0xf bank_mask:0xf
    v_add_f32_dpp v142, v142, v142 row_ror:2 row_mask:0xf bank_mask:0xf
    v_add_f32_dpp v143, v143, v143 row_ror:2 row_mask:0xf bank_mask:0xf
    v_add_f32_dpp v144, v144, v144 row_ror:2 row_mask:0xf bank_mask:0xf
    v_add_f32_dpp v145, v145, v145 row_ror:2 row_mask:0xf bank_mask:0xf
    v_add_f32_dpp v146, v146, v146 row_ror:2 row_mask:0xf bank_mask:0xf
    v_add_f32_dpp v147, v147, v147 row_ror:2 row_mask:0xf bank_mask:0xf
    v_add_f32_dpp v148, v148, v148 row_ror:2 row_mask:0xf bank_mask:0xf
    v_add_f32_dpp v149, v149, v149 row_ror:2 row_mask:0xf bank_mask:0xf
    v_add_f32_dpp v150, v150, v150 row_ror:2 row_mask:0xf bank_mask:0xf
    v_add_f32_dpp v151, v151, v151 row_ror:2 row_mask:0xf bank_mask:0xf
    v_add_f32_dpp v152, v152, v152 row_ror:2 row_mask:0xf bank_mask:0xf
    v_add_f32_dpp v153, v153, v153 row_ror:2 row_mask:0xf bank_mask:0xf
    v_add_f32_dpp v154, v154, v154 row_ror:2 row_mask:0xf bank_mask:0xf
    v_add_f32_dpp v155, v155, v155 row_ror:2 row_mask:0xf bank_mask:0xf
    v_add_f32_dpp v156, v156, v156 row_ror:2 row_mask:0xf bank_mask:0xf
    v_add_f32_dpp v157, v157, v157 row_ror:2 row_mask:0xf bank_mask:0xf
    v_add_f32_dpp v158, v158, v158 row_ror:2 row_mask:0xf bank_mask:0xf
    v_add_f32_dpp v140, v140, v140 row_ror:1 row_mask:0xf bank_mask:0xf
    v_add_f32_dpp v141, v141, v141 row_ror:1 row_mask:0xf bank_mask:0xf
    v_add_f32_dpp v142, v142, v142 row_ror:1 row_mask:0xf bank_mask:0xf
    v_add_f32_dpp v143, v143, v143 row_ror:1 row_mask:0xf bank_mask:0xf
    v_add_f32_dpp v144, v144, v144 row_ror:1 row_mask:0xf bank_mask:0xf
    v_add_f32_dpp v145, v145, v145 row_ror:1 row_mask:0xf bank_mask:0xf
    v_add_f32_dpp v146, v146, v146 row_ror:1 row_mask:0xf bank_mask:0xf
    v_add_f32_dpp v147, v147, v147 row_ror:1 row_mask:0xf bank_mask:0xf
    v_add_f32_dpp v148, v148, v148 row_ror:1 row_mask:0xf bank_mask:0xf
    v_add_f32_dpp v149, v149, v149 row_ror:1 row_mask:0xf bank_mask:0xf
    v_add_f32_dpp v150, v150, v150 row_ror:1 row_mask:0xf bank_mask:0xf
    v_add_f32_dpp v151, v151, v151 row_ror:1 row_mask:0xf bank_mask:0xf
    v_add_f32_dpp v152, v152, v152 row_ror:1 row_mask:0xf bank_mask:0xf
    v_add_f32_dpp v153, v153, v153 row_ror:1 row_mask:0xf bank_mask:0xf
    v_add_f32_dpp v154, v154, v154 row_ror:1 row_mask:0xf bank_mask:0xf
    v_add_f32_dpp v155, v155, v155 row_ror:1 row_mask:0xf bank_mask:0xf
    v_add_f32_dpp v156, v156, v156 row_ror:1 row_mask:0xf bank_mask:0xf
    v_add_f32_dpp v157, v157, v157 row_ror:1 row_mask:0xf bank_mask:0xf
    v_add_f32_dpp v158, v158, v158 row_ror:1 row_mask:0xf bank_mask:0xf
    v_rcp_f32 v12, v158
    s_nop 0
    v_pk_mul_f32 v[140:141], v[140:141], v[12:13] op_sel_hi:[1,0]
    v_pk_mul_f32 v[142:143], v[142:143], v[12:13] op_sel_hi:[1,0]
    v_pk_mul_f32 v[144:145], v[144:145], v[12:13] op_sel_hi:[1,0]
    v_pk_mul_f32 v[146:147], v[146:147], v[12:13] op_sel_hi:[1,0]
    v_pk_mul_f32 v[148:149], v[148:149], v[12:13] op_sel_hi:[1,0]
    v_pk_mul_f32 v[150:151], v[150:151], v[12:13] op_sel_hi:[1,0]
    v_pk_mul_f32 v[152:153], v[152:153], v[12:13] op_sel_hi:[1,0]
    v_pk_mul_f32 v[154:155], v[154:155], v[12:13] op_sel_hi:[1,0]
    v_pk_mul_f32 v[156:157], v[156:157], v[12:13] op_sel_hi:[1,0]
    v_cvt_pk_bf16_f32 v12, v140, v141
    v_cvt_pk_bf16_f32 v13, v142, v143
    v_cvt_pk_bf16_f32 v14, v148, v149
    v_cvt_pk_bf16_f32 v15, v150, v151
    v_cvt_pk_bf16_f32 v16, v144, v145
    v_cvt_pk_bf16_f32 v17, v146, v147
    v_cvt_pk_bf16_f32 v18, v152, v153
    v_cvt_pk_bf16_f32 v19, v154, v155
    v_cvt_pk_bf16_f32 v20, v156, v157
    s_mov_b32 exec_lo, 0x00010001
    s_mov_b32 exec_hi, 0x00010001
    s_cmp_eq_u32 s55, 1
    s_cbranch_scc1 L_r5f
    global_store_dwordx4 v9, v[12:15], s[16:17] sc1
    global_store_dwordx4 v9, v[16:19], s[16:17] offset:256 sc1
    global_store_dword v10, v20, s[16:17] offset:2048 sc1
    s_branch L_back5
L_r5f:
    global_store_dwordx4 v9, v[12:15], s[16:17]
    global_store_dwordx4 v9, v[16:19], s[16:17] offset:256
    global_store_dword v10, v20, s[16:17] offset:2048
    s_branch L_back5
L_kvx:
    v_min_u32 v8, 23, v1
    v_lshrrev_b32 v10, 2, v8
    v_lshlrev_b32 v8, 2, v8
    v_add_u32 v9, 162688, v8
    v_mul_u32_u24 v10, 112, v10
    v_add_u32 v8, 3547136, v8
    v_add_u32 v8, v8, v10
    s_mov_b32 s40, 30000
L_pollv:
    s_sleep 24
    global_load_dword v10, v8, s[16:17] sc1
    s_waitcnt vmcnt(0)
    v_cmp_eq_u32 vcc, -1, v10
    s_cmp_eq_u64 vcc, 0
    s_cbranch_scc1 L_pollv_ok
    s_sub_u32 s40, s40, 1
    s_cbranch_scc0 L_pollv
L_pollv_ok:
    ds_write_b32 v9, v10
    s_branch L_back2
L_agg:
    v_lshlrev_b32 v8, 7, v1
    v_add_u32 v8, 7733248, v8
    v_mov_b32 v9, 7743488
    s_mov_b32 s40, 30000
    global_load_dword v10, v8, s[16:17] sc1
    s_sleep 5
L_polla:
    global_load_dword v10, v8, s[16:17] sc1
    s_waitcnt vmcnt(1)
    v_add_u32 v11, 1, v10
    v_cmp_ne_u32 vcc, 0, v11
    s_or_b32 s24, vcc_lo, vcc_hi
    s_cmp_eq_u32 s24, -1
    s_cbranch_scc1 L_polla_ok
    s_sub_u32 s40, s40, 1
    s_cbranch_scc0 L_polla
L_polla_ok:
    v_max_u32_dpp v11, v11, v11 row_ror:8 row_mask:0xf bank_mask:0xf
    s_nop 1
    v_max_u32_dpp v11, v11, v11 row_ror:4 row_mask:0xf bank_mask:0xf
    s_nop 1
    v_max_u32_dpp v11, v11, v11 row_ror:2 row_mask:0xf bank_mask:0xf
    s_nop 1
    v_max_u32_dpp v11, v11, v11 row_ror:1 row_mask:0xf bank_mask:0xf
    v_mov_b32 v12, v11
    s_nop 1
    v_permlane16_swap_b32 v11, v12
    v_max_u32 v11, v11, v12
    v_mov_b32 v12, v11
    s_nop 1
    v_permlane32_swap_b32 v11, v12
    v_max_u32 v11, v11, v12
    v_subrev_u32 v11, 1, v11
    s_mov_b64 exec, 1
    global_store_dword v9, v11, s[16:17] sc1
    s_branch L_end
L_key:
    s_lshl_b32 s24, s3, 13
    s_add_u32 s24, s24, s44
    s_add_u32 s24, s24, 2363392
    v_lshl_add_u32 v8, v1, 4, s24
    s_lshl_b32 s24, s3, 7
    s_add_u32 s24, s24, s44
    s_add_u32 s24, s24, 3543040
    v_mov_b32 v9, s24
    s_lshl_b32 s32, s3, 6
    s_mov_b32 s40, 30000
L_polls:
    global_load_dwordx3 v[140:142], v8, s[16:17] offset:-4096 sc1
    global_load_dwordx3 v[144:146], v8, s[16:17] offset:-3072 sc1
    global_load_dwordx3 v[148:150], v8, s[16:17] offset:-2048 sc1
    global_load_dwordx3 v[152:154], v8, s[16:17] offset:-1024 sc1
    global_load_dwordx3 v[156:158], v8, s[16:17] offset:0 sc1
    global_load_dwordx3 v[160:162], v8, s[16:17] offset:1024 sc1
    global_load_dwordx3 v[164:166], v8, s[16:17] offset:2048 sc1
    global_load_dwordx3 v[168:170], v8, s[16:17] offset:3072 sc1
    s_waitcnt vmcnt(0)
    v_max3_u32 v11, v140, v141, v142
    v_max3_u32 v11, v144, v145, v11
    v_max3_u32 v11, v146, v148, v11
    v_max3_u32 v11, v149, v150, v11
    v_max3_u32 v11, v152, v153, v11
    v_max3_u32 v11, v154, v156, v11
    v_max3_u32 v11, v157, v158, v11
    v_max3_u32 v11, v160, v161, v11
    v_max3_u32 v11, v162, v164, v11
    v_max3_u32 v11, v165, v166, v11
    v_max3_u32 v11, v168, v169, v11
    v_max_u32 v11, v170, v11
    v_cmp_eq_u32 vcc, -1, v11
    s_cmp_eq_u64 vcc, 0
    s_cbranch_scc1 L_polls_ok
    s_sub_u32 s40, s40, 1
    s_cbranch_scc0 L_polls
L_polls_ok:
    v_add_f32 v140, v140, v156
    v_add_f32 v141, v141, v157
    v_add_f32 v142, v142, v158
    v_add_f32 v144, v144, v160
    v_add_f32 v145, v145, v161
    v_add_f32 v146, v146, v162
    v_add_f32 v148, v148, v164
    v_add_f32 v149, v149, v165
    v_add_f32 v150, v150, v166
    v_add_f32 v152, v152, v168
    v_add_f32 v153, v153, v169
    v_add_f32 v154, v154, v170
    v_add_f32 v140, v140, v144
    v_add_f32 v141, v141, v145
    v_add_f32 v142, v142, v146
    v_add_f32 v148, v148, v152
    v_add_f32 v149, v149, v153
    v_add_f32 v150, v150, v154
    v_add_f32 v140, v140, v148
    v_add_f32 v141, v141, v149
    v_add_f32 v142, v142, v150
    v_mul_f32 v10, 0x3ae38e39, v140
    v_mul_f32 v11, 0x3ae38e39, v142
    v_fma_f32 v11, -v10, v10, v11
    v_max_f32 v11, 0, v11
    v_cvt_pk_bf16_f32 v12, v10, v10
    v_and_b32 v12, 0xffff0000, v12
    v_cvt_pk_bf16_f32 v14, v11, v11
    v_and_b32 v14, 0xffff0000, v14
    v_add_f32 v14, 0x3727c5ac, v14
    v_cvt_pk_bf16_f32 v14, v14, v14
    v_and_b32 v14, 0xffff0000, v14
    v_sqrt_f32 v14, v14
    s_nop 0
    v_cvt_pk_bf16_f32 v13, v14, v14
    v_and_b32 v13, 0xffff0000, v13
    v_rcp_f32 v13, v13
    v_fma_f32 v14, -v12, s33, v141
    v_mul_f32 v14, v14, v13
    v_cvt_pk_bf16_f32 v14, v14, v14
    v_ashrrev_i32 v15, 31, v14
    v_or_b32 v15, 0x80000000, v15
    v_xor_b32 v14, v14, v15
    s_sub_u32 s24, 0xffff, s32
    v_sub_u32 v15, s24, v1
    s_mov_b32 s24, 0xffff0000
    v_and_or_b32 v14, v14, s24, v15
    s_nop 1
    v_max_u32_dpp v14, v14, v14 row_ror:8 row_mask:0xf bank_mask:0xf
    s_nop 1
    v_max_u32_dpp v14, v14, v14 row_ror:4 row_mask:0xf bank_mask:0xf
    s_nop 1
    v_max_u32_dpp v14, v14, v14 row_ror:2 row_mask:0xf bank_mask:0xf
    s_nop 1
    v_max_u32_dpp v14, v14, v14 row_ror:1 row_mask:0xf bank_mask:0xf
    v_mov_b32 v15, v14
    s_nop 1
    v_permlane16_swap_b32 v14, v15
    v_max_u32 v14, v14, v15
    v_mov_b32 v15, v14
    s_nop 1
    v_permlane32_swap_b32 v14, v15
    v_max_u32 v14, v14, v15
    s_mov_b64 exec, 1
    global_store_dword v9, v14, s[16:17] sc1
    s_mov_b64 exec, -1
    s_branch L_keyb
L_kv0_r1:
    s_sub_u32 s40, s40, 1
    s_cmp_lt_i32 s40, 0
    s_cbranch_scc1 L_kv0_b1
    s_mov_b32 s43, 0
    v_max3_u32 v5, v192, v193, v194
    v_max3_u32 v5, v195, v225, v5
    v_cmp_eq_u32 vcc, -1, v5
    s_cmp_eq_u64 vcc, 0
    s_cselect_b32 s24, 0, 4
    s_or_b32 s43, s43, s24
    s_mov_b32 s42, 1
L_kv0_f4:
    s_add_u32 s24, s38, s42
    s_sub_u32 s25, s24, 7
    s_cmp_gt_u32 s24, 7
    s_cselect_b32 s24, s25, s24
    s_add_u32 s24, s24, s34
    s_and_b32 s24, s24, 7
    s_mul_i32 s24, s24, 19456
    s_add_u32 s24, s24, 10485760
    s_add_u32 s18, s16, s24
    s_addc_u32 s19, s17, 0
    s_mul_i32 s24, s42, 19456
    s_lshl_b32 s25, s6, 10
    s_add_u32 m0, s24, s25
    s_add_u32 s42, s42, 1
    s_bitcmp0_b32 s43, s42
    s_cbranch_scc1 L_kv0_g4
    global_load_lds_dwordx4 v7, s[18:19] sc1
    s_add_u32 m0, m0, 4096
    s_add_u32 s18, s18, 4096
    s_addc_u32 s19, s19, 0
    global_load_lds_dwordx4 v7, s[18:19] sc1
    s_add_u32 m0, m0, 4096
    s_add_u32 s18, s18, 4096
    s_addc_u32 s19, s19, 0
    global_load_lds_dwordx4 v7, s[18:19] sc1
    s_add_u32 m0, m0, 4096
    s_add_u32 s18, s18, 4096
    s_addc_u32 s19, s19, 0
    global_load_lds_dwordx4 v7, s[18:19] sc1
    s_add_u32 m0, m0, s41
    s_add_u32 s18, s18, s41
    s_addc_u32 s19, s19, 0
    global_load_lds_dwordx4 v7, s[18:19] sc1
L_kv0_g4:
    s_waitcnt vmcnt(0)
    s_branch L_kv0_v1
L_kv0_r2:
    s_sub_u32 s40, s40, 1
    s_cmp_lt_i32 s40, 0
    s_cbranch_scc1 L_kv0_b2
    s_mov_b32 s43, 0
    v_max3_u32 v5, v192, v193, v194
    v_max3_u32 v5, v195, v226, v5
    v_cmp_eq_u32 vcc, -1, v5
    s_cmp_eq_u64 vcc, 0
    s_cselect_b32 s24, 0, 8
    s_or_b32 s43, s43, s24
    v_max3_u32 v5, v196, v197, v198
    v_max3_u32 v5, v199, v227, v5
    v_cmp_eq_u32 vcc, -1, v5
    s_cmp_eq_u64 vcc, 0
    s_cselect_b32 s24, 0, 16
    s_or_b32 s43, s43, s24
    s_mov_b32 s42, 2
L_kv0_f5:
    s_add_u32 s24, s38, s42
    s_sub_u32 s25, s24, 7
    s_cmp_gt_u32 s24, 7
    s_cselect_b32 s24, s25, s24
    s_add_u32 s24, s24, s34
    s_and_b32 s24, s24, 7
    s_mul_i32 s24, s24, 19456
    s_add_u32 s24, s24, 10485760
    s_add_u32 s18, s16, s24
    s_addc_u32 s19, s17, 0
    s_mul_i32 s24, s42, 19456
    s_lshl_b32 s25, s6, 10
    s_add_u32 m0, s24, s25
    s_add_u32 s42, s42, 1
    s_bitcmp0_b32 s43, s42
    s_cbranch_scc1 L_kv0_g5
    global_load_lds_dwordx4 v7, s[18:19] sc1
    s_add_u32 m0, m0, 4096
    s_add_u32 s18, s18, 4096
    s_addc_u32 s19, s19, 0
    global_load_lds_dwordx4 v7, s[18:19] sc1
    s_add_u32 m0, m0, 4096
    s_add_u32 s18, s18, 4096
    s_addc_u32 s19, s19, 0
    global_load_lds_dwordx4 v7, s[18:19] sc1
    s_add_u32 m0, m0, 4096
    s_add_u32 s18, s18, 4096
    s_addc_u32 s19, s19, 0
    global_load_lds_dwordx4 v7, s[18:19] sc1
    s_add_u32 m0, m0, s41
    s_add_u32 s18, s18, s41
    s_addc_u32 s19, s19, 0
    global_load_lds_dwordx4 v7, s[18:19] sc1
L_kv0_g5:
    s_cmp_lt_u32 s42, 4
    s_cbranch_scc1 L_kv0_f5
    s_waitcnt vmcnt(0)
    s_branch L_kv0_v2
L_kv0_r4:
    s_sub_u32 s40, s40, 1
    s_cmp_lt_i32 s40, 0
    s_cbranch_scc1 L_kv0_b4
    s_mov_b32 s43, 0
    v_max3_u32 v5, v192, v193, v194
    v_max3_u32 v5, v195, v228, v5
    v_cmp_eq_u32 vcc, -1, v5
    s_cmp_eq_u64 vcc, 0
    s_cselect_b32 s24, 0, 32
    s_or_b32 s43, s43, s24
    v_max3_u32 v5, v196, v197, v198
    v_max3_u32 v5, v199, v229, v5
    v_cmp_eq_u32 vcc, -1, v5
    s_cmp_eq_u64 vcc, 0
    s_cselect_b32 s24, 0, 64
    s_or_b32 s43, s43, s24
    v_max3_u32 v5, v200, v201, v202
    v_max3_u32 v5, v203, v230, v5
    v_cmp_eq_u32 vcc, -1, v5
    s_cmp_eq_u64 vcc, 0
    s_cselect_b32 s24, 0, 128
    s_or_b32 s43, s43, s24
    v_max3_u32 v5, v204, v205, v206
    v_max3_u32 v5, v207, v231, v5
    v_cmp_eq_u32 vcc, -1, v5
    s_cmp_eq_u64 vcc, 0
    s_cselect_b32 s24, 0, 256
    s_or_b32 s43, s43, s24
    s_mov_b32 s42, 4
L_kv0_f6:
    s_add_u32 s24, s38, s42
    s_sub_u32 s25, s24, 7
    s_cmp_gt_u32 s24, 7
    s_cselect_b32 s24, s25, s24
    s_add_u32 s24, s24, s34
    s_and_b32 s24, s24, 7
    s_mul_i32 s24, s24, 19456
    s_add_u32 s24, s24, 10485760
    s_add_u32 s18, s16, s24
    s_addc_u32 s19, s17, 0
    s_mul_i32 s24, s42, 19456
    s_lshl_b32 s25, s6, 10
    s_add_u32 m0, s24, s25
    s_add_u32 s42, s42, 1
    s_bitcmp0_b32 s43, s42
    s_cbranch_scc1 L_kv0_g6
    global_load_lds_dwordx4 v7, s[18:19] sc1
    s_add_u32 m0, m0, 4096
    s_add_u32 s18, s18, 4096
    s_addc_u32 s19, s19, 0
    global_load_lds_dwordx4 v7, s[18:19] sc1
    s_add_u32 m0, m0, 4096
    s_add_u32 s18, s18, 4096
    s_addc_u32 s19, s19, 0
    global_load_lds_dwordx4 v7, s[18:19] sc1
    s_add_u32 m0, m0, 4096
    s_add_u32 s18, s18, 4096
    s_addc_u32 s19, s19, 0
    global_load_lds_dwordx4 v7, s[18:19] sc1
    s_add_u32 m0, m0, s41
    s_add_u32 s18, s18, s41
    s_addc_u32 s19, s19, 0
    global_load_lds_dwordx4 v7, s[18:19] sc1
L_kv0_g6:
    s_cmp_lt_u32 s42, 8
    s_cbranch_scc1 L_kv0_f6
    global_load_dword v232, v8, s[28:29] offset:-4096 sc1
    global_load_dword v233, v8, s[28:29] offset:0 sc1
    global_load_dword v234, v9, s[28:29] offset:-4096 sc1
    global_load_dword v235, v9, s[28:29] offset:0 sc1
    global_load_dword v236, v10, s[28:29] offset:0 sc1
    s_waitcnt vmcnt(0)
    s_branch L_kv0_v4
L_kv1_own:
    s_bfe_u32 s24, s31, 0x30006
    s_mul_i32 s53, s24, 19456
    s_lshr_b32 s24, s31, 9
    s_lshl_b32 s24, s24, 6
    s_and_b32 s25, s31, 63
    s_add_u32 s56, s24, s25
    s_lshr_b32 s24, s56, 4
    s_mul_i32 s24, s24, 640
    s_and_b32 s25, s31, 3
    s_lshl_b32 s25, s25, 1
    s_add_u32 s24, s24, s25
    s_and_b32 s25, s31, 8
    s_add_u32 s24, s24, s25
    s_add_u32 s54, s24, 9216
    s_bfe_u32 s25, s31, 0x10002
    v_min_u32 v23, 19, v1
    v_mov_b32 v22, s25
    v_lshrrev_b32 v4, 3, v23
    v_cmp_gt_u32 vcc, 16, v23
    v_and_b32 v23, 7, v23
    v_lshlrev_b32 v23, 4, v23
    v_lshl_add_u32 v23, v4, 8, v23
    v_xor_b32 v4, v4, v22
    v_lshlrev_b32 v4, 7, v4
    v_lshlrev_b32 v5, 6, v22
    v_cndmask_b32 v4, v5, v4, vcc
    v_add_u32 v23, v23, v4
    v_add_u32 v23, s54, v23
    v_mov_b32 v22, 0
    v_mov_b32 v5, 160800
    s_mov_b32 s40, 524288
L_kv1_j:
    ds_read_b32 v11, v5
    s_waitcnt lgkmcnt(0)
    v_readfirstlane_b32 s24, v11
    s_cmp_eq_u32 s24, 4
    s_cbranch_scc1 L_kv1_j_ok
    s_sub_u32 s40, s40, 1
    s_cbranch_scc0 L_kv1_j
L_kv1_j_ok:
    ds_write_b16 v23, v22
    s_branch L_kv1_n0
L_kv1_r1:
    s_sub_u32 s40, s40, 1
    s_cmp_lt_i32 s40, 0
    s_cbranch_scc1 L_kv1_b1
    s_mov_b32 s43, 0
    v_max3_u32 v5, v192, v193, v194
    v_max3_u32 v5, v195, v225, v5
    v_cmp_eq_u32 vcc, -1, v5
    s_cmp_eq_u64 vcc, 0
    s_cselect_b32 s24, 0, 4
    s_or_b32 s43, s43, s24
    s_mov_b32 s42, 1
L_kv1_f3:
    s_add_u32 s24, s38, s42
    s_sub_u32 s25, s24, 7
    s_cmp_gt_u32 s24, 7
    s_cselect_b32 s24, s25, s24
    s_add_u32 s24, s24, s34
    s_and_b32 s24, s24, 7
    s_mul_i32 s24, s24, 19456
    s_add_u32 s24, s24, 3551232
    s_add_u32 s18, s16, s24
    s_addc_u32 s19, s17, 0
    s_mul_i32 s24, s42, 19456
    s_lshl_b32 s25, s6, 10
    s_add_u32 m0, s24, s25
    s_add_u32 s42, s42, 1
    s_bitcmp0_b32 s43, s42
    s_cbranch_scc1 L_kv1_g3
    global_load_lds_dwordx4 v7, s[18:19] sc1
    s_add_u32 m0, m0, 4096
    s_add_u32 s18, s18, 4096
    s_addc_u32 s19, s19, 0
    global_load_lds_dwordx4 v7, s[18:19] sc1
    s_add_u32 m0, m0, 4096
    s_add_u32 s18, s18, 4096
    s_addc_u32 s19, s19, 0
    global_load_lds_dwordx4 v7, s[18:19] sc1
    s_add_u32 m0, m0, 4096
    s_add_u32 s18, s18, 4096
    s_addc_u32 s19, s19, 0
    global_load_lds_dwordx4 v7, s[18:19] sc1
    s_add_u32 m0, m0, s41
    s_add_u32 s18, s18, s41
    s_addc_u32 s19, s19, 0
    global_load_lds_dwordx4 v7, s[18:19] sc1
L_kv1_g3:
    s_waitcnt vmcnt(0)
    s_branch L_kv1_v1
L_kv1_r2:
    s_sub_u32 s40, s40, 1
    s_cmp_lt_i32 s40, 0
    s_cbranch_scc1 L_kv1_b2
    s_mov_b32 s43, 0
    v_max3_u32 v5, v192, v193, v194
    v_max3_u32 v5, v195, v226, v5
    v_cmp_eq_u32 vcc, -1, v5
    s_cmp_eq_u64 vcc, 0
    s_cselect_b32 s24, 0, 8
    s_or_b32 s43, s43, s24
    v_max3_u32 v5, v196, v197, v198
    v_max3_u32 v5, v199, v227, v5
    v_cmp_eq_u32 vcc, -1, v5
    s_cmp_eq_u64 vcc, 0
    s_cselect_b32 s24, 0, 16
    s_or_b32 s43, s43, s24
    v_max3_u32 v5, v200, v201, v202
    v_max3_u32 v5, v203, v228, v5
    v_cmp_eq_u32 vcc, -1, v5
    s_cmp_eq_u64 vcc, 0
    s_cselect_b32 s24, 0, 32
    s_or_b32 s43, s43, s24
    v_max3_u32 v5, v204, v205, v206
    v_max3_u32 v5, v207, v229, v5
    v_cmp_eq_u32 vcc, -1, v5
    s_cmp_eq_u64 vcc, 0
    s_cselect_b32 s24, 0, 64
    s_or_b32 s43, s43, s24
    v_max3_u32 v5, v208, v209, v210
    v_max3_u32 v5, v211, v230, v5
    v_cmp_eq_u32 vcc, -1, v5
    s_cmp_eq_u64 vcc, 0
    s_cselect_b32 s24, 0, 128
    s_or_b32 s43, s43, s24
    v_max3_u32 v5, v212, v213, v214
    v_max3_u32 v5, v215, v231, v5
    v_cmp_eq_u32 vcc, -1, v5
    s_cmp_eq_u64 vcc, 0
    s_cselect_b32 s24, 0, 256
    s_or_b32 s43, s43, s24
    s_mov_b32 s42, 2
L_kv1_f4:
    s_add_u32 s24, s38, s42
    s_sub_u32 s25, s24, 7
    s_cmp_gt_u32 s24, 7
    s_cselect_b32 s24, s25, s24
    s_add_u32 s24, s24, s34
    s_and_b32 s24, s24, 7
    s_mul_i32 s24, s24, 19456
    s_add_u32 s24, s24, 3551232
    s_add_u32 s18, s16, s24
    s_addc_u32 s19, s17, 0
    s_mul_i32 s24, s42, 19456
    s_lshl_b32 s25, s6, 10
    s_add_u32 m0, s24, s25
    s_add_u32 s42, s42, 1
    s_bitcmp0_b32 s43, s42
    s_cbranch_scc1 L_kv1_g4
    global_load_lds_dwordx4 v7, s[18:19] sc1
    s_add_u32 m0, m0, 4096
    s_add_u32 s18, s18, 4096
    s_addc_u32 s19, s19, 0
    global_load_lds_dwordx4 v7, s[18:19] sc1
    s_add_u32 m0, m0, 4096
    s_add_u32 s18, s18, 4096
    s_addc_u32 s19, s19, 0
    global_load_lds_dwordx4 v7, s[18:19] sc1
    s_add_u32 m0, m0, 4096
    s_add_u32 s18, s18, 4096
    s_addc_u32 s19, s19, 0
    global_load_lds_dwordx4 v7, s[18:19] sc1
    s_add_u32 m0, m0, s41
    s_add_u32 s18, s18, s41
    s_addc_u32 s19, s19, 0
    global_load_lds_dwordx4 v7, s[18:19] sc1
L_kv1_g4:
    s_cmp_lt_u32 s42, 8
    s_cbranch_scc1 L_kv1_f4
    global_load_dword v232, v8, s[28:29] offset:-4096 sc1
    global_load_dword v233, v8, s[28:29] offset:0 sc1
    global_load_dword v234, v9, s[28:29] offset:-4096 sc1
    global_load_dword v235, v9, s[28:29] offset:0 sc1
    global_load_dword v236, v10, s[28:29] offset:0 sc1
    s_waitcnt vmcnt(0)
    s_branch L_kv1_v2
L_quit:
    s_endpgm
.section .rodata,"a"
.p2align 6
.amdhsa_kernel interleave_layers__grouped_kv_mqa__moe_arch_mod__prompt_kernel
  .amdhsa_next_free_vgpr 256
  .amdhsa_next_free_sgpr 64
  .amdhsa_accum_offset 256
  .amdhsa_group_segment_fixed_size 0
  .amdhsa_kernarg_size 104
  .amdhsa_user_sgpr_count 2
  .amdhsa_user_sgpr_kernarg_segment_ptr 1
  .amdhsa_system_sgpr_workgroup_id_x 1
  .amdhsa_float_denorm_mode_32 3
.end_amdhsa_kernel
```
